```python
import torch

def _softmax(x, axis=-1):
    return torch.softmax(x, dim=axis)
def _gelu(x):
    return torch.nn.functional.gelu(x, approximate="tanh")
def _silu(x):
    return torch.nn.functional.silu(x)
def _sigmoid(x):
    return torch.sigmoid(x)
def _layernorm(x, axis=-1, eps=1e-5):
    m = x.mean(dim=axis, keepdim=True)
    v = x.var(dim=axis, keepdim=True, unbiased=False)
    return (x - m) / torch.sqrt(v + eps)
def _scatter_add(tgt, idx, src, axis=0):
    return tgt.clone().index_add_(axis, idx, src)
def _segment_sum(src, seg, n):
    out = torch.zeros((n,) + src.shape[1:], dtype=src.dtype)
    return out.index_add_(0, seg, src)
def _pad(x, pw):
    flat = tuple(v for pair in reversed(pw) for v in pair)
    return torch.nn.functional.pad(x, flat)

kernel_name = 'sequential_preLN__mha_block__dense_activation_squared_relu__prompt'

def setup_inputs():

    _w = (lambda a: (lambda t: t.to(torch.bfloat16) if t.is_floating_point() else t)(torch.as_tensor(a)))
    def _A_setup():
        B, S, D, H = 1, 2048, 448, 16
        return {
            "x": _w((lambda *s: torch.randn(*s, dtype=torch.bfloat16) * 0.05)(B, S, D)),
            "wqkv": _w((lambda *s: torch.randn(*s, dtype=torch.bfloat16) * 0.05)(D, 3 * D)),
            "wo": _w((lambda *s: torch.randn(*s, dtype=torch.bfloat16) * 0.05)(D, D)),
        }
    _A_in = _A_setup()

    def _B_setup():
        B, S, D, F = 1, 2048, 448, 1792
        return {
            "x": _w((lambda *s: torch.randn(*s, dtype=torch.bfloat16) * 0.05)(B, S, D)),
            "w1": _w((lambda *s: torch.randn(*s, dtype=torch.bfloat16) * 0.05)(D, F)),
            "b1": _w((lambda *s: torch.randn(*s, dtype=torch.bfloat16) * 0.2)(F)),
            "w2": _w((lambda *s: torch.randn(*s, dtype=torch.bfloat16) * 0.05)(F, D)),
            "b2": _w((lambda *s: torch.randn(*s, dtype=torch.bfloat16) * 0.8)(D)),
        }
    _B_in = _B_setup()

    return {
        "A_x": _A_in["x"],
        "A_wqkv": _A_in["wqkv"],
        "A_wo": _A_in["wo"],
        "B_x": _B_in["x"],
        "B_w1": _B_in["w1"],
        "B_b1": _B_in["b1"],
        "B_w2": _B_in["w2"],
        "B_b2": _B_in["b2"],
    }

def reference(A_x, A_wqkv, A_wo, B_x, B_w1, B_b1, B_w2, B_b2):
    def _A_ref(x, wqkv, wo):
        B, S, D = x.shape
        H = 16
        Dh = D // H
        qkv = (lambda x, *d: x.permute(*d))((x @ wqkv).reshape(B, S, 3, H, Dh), 2, 0, 3, 1, 4)
        q, k, v = qkv[0], qkv[1], qkv[2]
        scores = torch.einsum("bhqd,bhkd->bhqk", q, k) * (Dh ** -0.5)
        p = _softmax(scores, axis=-1)
        o = torch.einsum("bhqk,bhkd->bhqd", p, v)
        return (lambda x, *d: x.permute(*d))(o, 0, 2, 1, 3).reshape(B, S, D) @ wo

    def _B_ref(x, w1, b1, w2, b2):
        h = torch.einsum("bsd,df->bsf", x, w1) + b1
        zero = torch.zeros_like(h)
        r = torch.where(h > zero, h, zero)
        h = r * r
        out = torch.einsum("bsf,fd->bsd", h, w2) + b2
        return out

    x = A_x
    h = x + _A_ref(_layernorm(x, axis=-1), A_wqkv, A_wo)
    h2 = h + _B_ref(_layernorm(h, axis=-1), B_w1, B_b1, B_w2, B_b2)
    return h2
```

```asm
; @launch grid=(256,1,1) block=(256,1,1) lds=163840
.amdgcn_target "amdgcn-amd-amdhsa--gfx950"
.text
.globl sequential_preLN__mha_block__dense_activation_squared_relu__prompt_kernel
.p2align 12
.p2align 8
.type sequential_preLN__mha_block__dense_activation_squared_relu__prompt_kernel,@function
sequential_preLN__mha_block__dense_activation_squared_relu__prompt_kernel:
    s_getpc_b64 s[80:81]
L_pc0:
    s_lshr_b32 s76, s2, 3
    v_lshrrev_b32 v10, 4, v0
    v_lshl_add_u32 v10, s76, 4, v10
    v_min_u32 v10, (L_fallback-L_pc0)/128, v10
    v_lshlrev_b32 v10, 7, v10
    global_load_dword v31, v10, s[80:81]
    s_load_dwordx4 s[4:7], s[0:1], 0
    s_load_dwordx2 s[12:13], s[0:1], 80
    s_cmp_ge_u32 s76, 32
    s_cbranch_scc1 L_end
    v_lshrrev_b32 v2, 6, v0
    v_and_b32 v1, 63, v0
    v_readfirstlane_b32 s16, v2
    s_and_b32 s51, s2, 7
    s_lshr_b32 s17, s51, 2
    s_lshl_b32 s17, s17, 3
    s_lshr_b32 s77, s76, 2
    s_add_u32 s17, s17, s77
    s_and_b32 s18, s51, 3
    s_lshl_b32 s18, s18, 2
    s_and_b32 s77, s76, 3
    s_add_u32 s18, s18, s77
    s_lshl2_add_u32 s79, s17, s16
    s_lshr_b32 s48, s17, 1
    s_add_u32 s48, s48, s18
    s_and_b32 s48, s48, 1
    s_mul_i32 s55, s79, 28672
    s_mul_i32 s54, s16, 43008
    s_and_b32 s77, s17, 1
    s_lshl2_add_u32 s77, s77, 1
    s_cmp_gt_u32 s18, s77
    s_subb_u32 s30, s18, 0
    s_sub_u32 s78, s18, s77
    s_cmp_gt_i32 s78, 7
    s_subb_u32 s30, s30, 0
    s_bitcmp1_b32 0x81, s78
    s_cselect_b32 s30, 15, s30
    s_lshl_b32 s56, s30, 7
    s_add_u32 s56, s56, s54
    s_add_u32 s56, s56, 896
    s_mul_i32 s49, s48, 172032
    s_lshl_b32 s48, s48, 7
    s_mov_b32 s50, s49
    s_mul_i32 s52, s16, 12288
    s_add_u32 s52, s52, 65536
    s_lshl_b32 s53, s16, 11
    v_lshrrev_b32 v64, 3, v1
    v_lshrrev_b32 v65, 4, v1
    v_and_b32 v66, 7, v1
    v_xor_b32 v67, v65, v66
    v_mul_u32_u24 v68, 896, v64
    v_lshl_add_u32 v2, v67, 4, v68
    v_add_u32 v2, s55, v2
    v_xor_b32 v3, 64, v2
    v_add_u32 v3, 6144, v3
    v_add_u32 v4, 12288, v2
    v_add_u32 v5, 12288, v3
    v_and_b32 v67, 1, v65
    v_lshlrev_b32 v67, 2, v67
    v_xor_b32 v69, v67, v66
    v_mul_u32_u24 v67, 2688, v64
    v_lshl_add_u32 v6, v69, 4, v67
    v_add_u32 v6, s56, v6
    v_add_u32 v7, 20480, v6
    s_mov_b32 s11, 0x00020000
    s_mov_b32 m0, s53
    s_waitcnt lgkmcnt(0)
    s_cmp_lt_u32 s30, 14
    s_cselect_b32 s10, 1204224, 0
    s_mov_b64 s[8:9], s[6:7]
    s_mov_b32 s6, 1835008
    s_mov_b32 s7, s11
    s_cbranch_scc0 L_light
    buffer_load_dwordx4 v6, s[8:11], s49 offen offset:0 lds
    buffer_load_dwordx4 v7, s[8:11], s49 offen offset:1024 lds
    s_add_u32 m0, s52, 0
    s_nop 0
    buffer_load_dwordx4 v2, s[4:7], s48 offen offset:0 lds
    buffer_load_dwordx4 v3, s[4:7], s48 offen offset:1024 lds
    buffer_load_dwordx4 v4, s[4:7], s48 offen offset:2048 lds
    buffer_load_dwordx4 v5, s[4:7], s48 offen offset:3072 lds
    s_min_u32 s77, s2, 223
    s_mul_i32 s77, s77, 5376
    v_lshrrev_b32 v70, 7, v0
    v_mul_u32_u24 v70, 2688, v70
    v_bfe_u32 v71, v0, 4, 3
    v_min_u32 v71, 6, v71
    v_lshl_add_u32 v70, v71, 7, v70
    v_add_u32 v70, s77, v70
    global_load_dword v31, v70, s[8:9]
    s_lshl4_add_u32 s77, s17, s18
    s_lshl2_add_u32 s77, s77, s16
    s_mul_i32 s77, s77, 1792
    v_min_u32 v70, 4, v66
    v_lshlrev_b32 v70, 7, v70
    v_and_b32 v71, 1, v64
    v_mul_u32_u24 v71, 896, v71
    v_add_u32 v70, v70, v71
    s_mul_i32 s78, s79, 13440
    s_lshl_b32 s57, s30, 7
    s_add_u32 s78, s78, s57
    s_add_u32 s78, s78, 344960
    v_min_u32 v71, 4, v64
    v_mul_u32_u24 v71, 2688, v71
    s_mov_b64 exec, 0xffff
    buffer_load_dword v31, v70, s[4:7], s77 offen offset:256
    s_mov_b64 exec, -1
    buffer_load_dword v31, v71, s[8:11], s78 offen
    s_min_u32 s77, s76, 10
    s_lshl_b32 s77, s77, 3
    s_load_dwordx2 s[82:83], s[0:1], s77
    s_sub_u32 s31, s76, 10
    s_mul_i32 s31, s31, 1036800
    s_add_u32 s31, s31, 57472
    s_cmp_lt_u32 s76, 10
    s_cselect_b32 s31, 0x80, s31
    s_load_dwordx2 s[40:41], s[0:1], 16
    s_load_dwordx2 s[42:43], s[0:1], 48
    s_load_dwordx2 s[60:61], s[0:1], 32
    s_load_dwordx2 s[100:101], s[0:1], 72
    s_mov_b32 s14, 23068672
    s_mov_b32 s15, 0x00020000
    v_mov_b32 v219, 0
    v_mov_b32 v70, s31
    s_waitcnt lgkmcnt(0)
    global_load_dword v31, v70, s[82:83]
    s_waitcnt lgkmcnt(0)
    v_and_b32 v73, 31, v1
    v_lshrrev_b32 v71, 1, v73
    v_lshrrev_b32 v72, 5, v1
    v_xor_b32 v71, v71, v72
    v_and_b32 v71, 7, v71
    v_lshlrev_b32 v71, 4, v71
    v_lshl_add_u32 v71, v73, 7, v71
    v_add_u32 v71, s52, v71
    s_lshl_b32 s77, s16, 5
    v_xor_b32 v9, s77, v71
    v_xor_b32 v10, 32, v9
    v_xor_b32 v11, 64, v9
    v_xor_b32 v12, 0x60, v9
    v_bfe_u32 v76, v1, 2, 2
    v_lshl_add_u32 v74, v72, 3, v76
    v_and_b32 v75, 16, v1
    v_lshlrev_b32 v75, 1, v75
    v_and_b32 v71, 1, v1
    v_lshl_add_u32 v75, v71, 4, v75
    v_bfe_u32 v71, v1, 1, 1
    v_lshl_add_u32 v75, v71, 3, v75
    v_lshl_add_u32 v13, v74, 7, v75
    v_bfe_u32 v71, v1, 3, 1
    v_lshl_add_u32 v13, v71, 6, v13
    v_add_u32 v13, s53, v13
    v_xor_b32 v14, 64, v13
    v_xor_b32 v15, 2048, v13
    v_xor_b32 v16, 2112, v13
    v_xor_b32 v17, 4096, v13
    v_xor_b32 v18, 4160, v13
    v_xor_b32 v19, 6144, v13
    v_xor_b32 v20, 6208, v13
    v_mov_b32 v25, 0x3f803f80
    v_mov_b32 v26, 0
    v_mov_b32 v27, 0
    v_mov_b32 v28, 0
    v_mov_b32 v29, 0
    s_mov_b32 s36, s8
    s_mov_b32 s37, s9
    s_mov_b32 s38, 1204224
    s_mov_b32 s39, 0x00020000
    s_and_b32 s28, s18, 1
    s_lshr_b32 s77, s18, 1
    s_mul_i32 s77, s77, 7
    s_mul_i32 s78, s28, 3
    s_add_u32 s78, s78, s77
    s_lshl4_add_u32 s77, s78, s54
    s_lshr_b32 s54, s53, 1
    s_add_u32 s54, s54, 114688
    v_lshrrev_b32 v70, 2, v1
    v_mul_u32_u24 v71, 2688, v70
    v_and_b32 v77, 3, v1
    v_lshl_add_u32 v8, v77, 4, v71
    v_add_u32 v8, s77, v8
    v_and_b32 v64, 0x33, v73
    v_and_b32 v71, 4, v73
    v_lshl_or_b32 v64, v71, 1, v64
    v_lshrrev_b32 v71, 1, v73
    v_and_or_b32 v64, v71, 4, v64
    v_lshlrev_b32 v254, 4, v1
    v_lshlrev_b32 v71, 4, v64
    v_lshl_add_u32 v71, v72, 9, v71
    s_lshl_b32 s77, s78, 9
    v_add_u32 v71, s77, v71
    v_accvgpr_write_b32 a0, v71
    s_mul_i32 s77, s18, 28
    s_add_u32 s77, s77, 448
    s_lshl_b32 s76, s78, 3
    v_mov_b32 v66, s76
    v_mov_b32 v67, s77
    v_cmp_gt_u32 vcc, 2, v77
    s_nop 1
    v_cndmask_b32 v66, v67, v66, vcc
    v_cndmask_b32 v67, 27, 31, vcc
    v_and_b32 v71, 1, v1
    v_mad_u32_u24 v66, v71, v67, v66
    v_lshrrev_b32 v66, 6, v66
    v_lshlrev_b32 v66, 7, v66
    v_accvgpr_write_b32 a1, v66
    v_mul_u32_u24 v71, 7168, v72
    v_lshl_add_u32 v240, v64, 4, v71
    v_add_u32 v241, 14336, v240
    s_mul_i32 s77, s18, 448
    s_add_u32 s77, s77, 28672
    v_add_u32 v66, s77, v240
    v_add_u32 v67, s77, v241
    v_mov_b32 v78, 23068672
    v_mov_b32 v71, 57344
    v_cmp_eq_u32 vcc, 28, v73
    s_nop 1
    v_cndmask_b32 v71, v78, v71, vcc
    v_cmp_gt_u32 vcc, 28, v73
    s_nop 1
    v_cndmask_b32 v66, v71, v66, vcc
    v_cndmask_b32 v67, v71, v67, vcc
    v_accvgpr_write_b32 a2, v66
    v_accvgpr_write_b32 a3, v67
    v_lshlrev_b32 v242, 3, v73
    v_add_u32 v242, 143360, v242
    s_lshl_b32 s77, s16, 8
    v_add_u32 v243, s77, v242
    s_mul_i32 s58, s79, 57600
    s_lshl_b32 s57, s30, 12
    s_lshl_b32 s77, s30, 10
    s_add_u32 s77, s77, 21504
    s_cmp_lt_u32 s30, 7
    s_cselect_b32 s57, s57, s77
    s_add_u32 s57, s57, s58
    s_add_u32 s58, s58, 57344
    s_cmp_ge_u32 s30, 7
    s_cselect_b32 s58, s58, 23068672
    v_min_u32 v244, 0x70, v254
    s_lshl_b32 s3, s79, 5
    s_add_u32 s3, s3, s18
    s_lshl_b32 s3, s3, 10
    s_add_u32 s3, s3, 6291456
    v_lshl_add_u32 v21, v74, 6, v75
    v_add_u32 v21, s54, v21
    v_xor_b32 v22, 1024, v21
    v_xor_b32 v23, 2048, v21
    v_xor_b32 v24, 3072, v21
    v_mov_b32 v30, 0
    v_mov_b32 v218, 0
    v_mov_b32 v221, 0
    v_mov_b32 v222, 0
    v_mov_b32 v223, 0
    v_mov_b32 v226, 0
    v_mov_b32 v227, 0
    v_mov_b32 v230, 0
    v_mov_b32 v231, 0
    v_mov_b32 v234, 0
    v_mov_b32 v235, 0
    v_mov_b32 v236, v25
    v_mov_b32 v237, v25
    v_mov_b32 v238, v25
    v_mov_b32 v239, v25
    s_bfe_u32 s20, s2, 0x40003
    s_lshr_b32 s19, s2, 7
    s_lshl1_add_u32 s19, s51, s19
    s_lshl_b32 s25, s19, 12
    s_add_u32 s25, s25, 20971520
    s_getreg_b32 s76, hwreg(HW_REG_XCC_ID, 0, 4)
    s_lshl_b32 s77, s76, 2
    s_lshl_b32 s29, 14, s77
    s_lshl_b32 s77, 1, s77
    s_cmp_lt_u32 s76, 8
    s_cselect_b32 s77, s77, 0
    s_cmp_lt_u32 s20, 14
    s_cselect_b32 s77, s77, 0
    v_lshlrev_b32 v79, 7, v1
    s_lshl_b32 s78, s17, 7
    s_add_u32 s78, s78, 21053440
    s_lshl_b32 s76, s30, 7
    s_add_u32 s76, s76, 21037056
    s_cmp_lt_u32 s30, 14
    s_cselect_b32 s76, s76, s78
    v_lshl_add_u32 v255, v79, 4, s76
    s_add_u32 s78, s25, 3072
    v_writelane_b32 v255, s78, 8
    s_cmp_eq_u32 s16, 0
    s_cselect_b32 s76, 9, 0
    v_cmp_gt_u32 vcc, s76, v1
    s_nop 1
    v_cndmask_b32 v255, v78, v255, vcc
    v_mov_b32 v253, 1
    v_writelane_b32 v253, s77, 8
    s_and_b32 s21, s20, 1
    s_lshr_b32 s22, s20, 1
    s_lshl1_add_u32 s23, s19, s21
    s_lshr_b32 s76, s16, 1
    s_and_b32 s77, s22, 1
    s_xor_b32 s76, s76, s77
    s_lshl1_add_u32 s23, s23, s76
    s_and_b32 s76, s16, 1
    s_lshl1_add_u32 s24, s22, s76
    s_lshl_b32 s65, s23, 12
    s_lshr_b32 s77, s22, 1
    s_lshl_b32 s77, s77, 9
    s_add_u32 s65, s65, s77
    s_add_u32 s65, s65, 10354688
    s_mul_i32 s27, s23, 28672
    s_lshl_b32 s77, s24, 11
    s_add_u32 s64, s27, s77
    s_add_u32 s64, s64, 8388608
    s_mul_i32 s77, s76, 14336
    s_add_u32 s27, s27, s77
    s_lshl_b32 s76, s22, 7
    s_add_u32 s27, s27, s76
    v_and_b32 v66, 15, v1
    v_mul_u32_u24 v67, 896, v66
    v_lshlrev_b32 v71, 4, v65
    v_add_u32 v67, v67, v71
    v_lshlrev_b32 v66, 4, v66
    v_lshl_add_u32 v66, v72, 8, v66
    v_and_b32 v246, 16, v1
    v_lshl_add_u32 v66, v246, 10, v66
    v_accvgpr_write_b32 a4, v66
    v_add_u32 v71, s76, v71
    s_lshl_b32 s76, s20, 8
    s_lshl_b32 s77, s16, 6
    s_add_u32 s77, s77, s76
    v_lshl_add_u32 v66, v64, 1, s76
    v_accvgpr_write_b32 a5, v67
    v_accvgpr_write_b32 a6, v71
    v_accvgpr_write_b32 a7, v66
    s_mov_b32 s31, s77
    s_lshl2_add_u32 s77, s2, s16
    s_mul_i32 s77, s77, 1664
    s_min_u32 s77, s77, 1603968
    v_min_u32 v249, 12, v70
    v_lshlrev_b32 v249, 7, v249
    v_accvgpr_write_b32 a8, v249
    s_add_u32 s82, s60, s77
    s_addc_u32 s83, s61, 0
    s_mul_i32 s77, s16, 57344
    s_add_u32 s77, s77, s76
    s_add_u32 s60, s60, s77
    s_addc_u32 s61, s61, 0
    s_lshl_b32 s59, s16, 12
    v_cmp_gt_u32 vcc, 32, v1
    s_cmp_eq_u32 s28, 0
    s_cselect_b32 s76, -1, 0
    v_cndmask_b32 v66, 0, -1, vcc
    v_not_b32 v67, v66
    v_or_b32 v67, s76, v67
    s_not_b32 s76, s76
    v_or_b32 v71, s76, v66
    v_accvgpr_write_b32 a9, v66
    v_accvgpr_write_b32 a10, v67
    v_accvgpr_write_b32 a11, v71
    s_add_u32 s76, s53, 147456
    v_add_u32 v66, s76, v254
    v_accvgpr_write_b32 a12, v66
    s_xor_b32 s76, s16, 3
    s_mul_i32 s76, s76, 12288
    s_add_u32 s76, s76, 114688
    v_add_u32 v66, s76, v254
    v_accvgpr_write_b32 a13, v66
    s_xor_b32 s76, s16, 2
    s_mul_i32 s76, s76, 12288
    s_add_u32 s76, s76, 114688
    v_add_u32 v66, s76, v254
    v_accvgpr_write_b32 a14, v66
    s_xor_b32 s76, s16, 1
    s_mul_i32 s76, s76, 12288
    s_add_u32 s76, s76, 114688
    v_add_u32 v66, s76, v254
    v_accvgpr_write_b32 a15, v66
    s_xor_b32 s76, s16, 0
    s_mul_i32 s76, s76, 12288
    s_add_u32 m0, s53, 8192
    s_sub_u32 s49, 172032, s49
    buffer_load_dwordx4 v6, s[8:11], s49 offen offset:0 lds
    buffer_load_dwordx4 v7, s[8:11], s49 offen offset:1024 lds
    s_add_u32 m0, s52, 4096
    s_sub_u32 s48, 128, s48
    buffer_load_dwordx4 v2, s[4:7], s48 offen offset:0 lds
    buffer_load_dwordx4 v3, s[4:7], s48 offen offset:1024 lds
    buffer_load_dwordx4 v4, s[4:7], s48 offen offset:2048 lds
    buffer_load_dwordx4 v5, s[4:7], s48 offen offset:3072 lds
    s_mov_b64 exec, 0
    s_cmp_eq_u32 s16, 0
    s_cbranch_scc1 L_w0_0
    s_cmp_eq_u32 s16, 1
    s_cbranch_scc1 L_w0_1
    s_cmp_eq_u32 s16, 2
    s_cbranch_scc1 L_w0_2
    s_cmp_eq_u32 s16, 3
    s_cbranch_scc1 L_w0_3
L_w0_r:
    s_mov_b64 exec, -1
    s_cmp_lt_u32 s30, 7
    s_cbranch_scc1 L_kk
    s_waitcnt vmcnt(10)
    s_barrier
    ds_read_b128 v[104:107], v9 offset:0
    ds_read_b64_tr_b16 v[80:81], v13 offset:0
    ds_read_b64_tr_b16 v[82:83], v13 offset:512
    ds_read_b64_tr_b16 v[84:85], v14 offset:0
    ds_read_b64_tr_b16 v[86:87], v14 offset:512
    ds_read_b128 v[108:111], v10 offset:0
    ds_read_b64_tr_b16 v[88:89], v15 offset:0
    ds_read_b64_tr_b16 v[90:91], v15 offset:512
    ds_read_b64_tr_b16 v[92:93], v16 offset:0
    ds_read_b64_tr_b16 v[94:95], v16 offset:512
    s_add_u32 m0, s53, 16384
    s_mov_b32 s49, 344064
    buffer_load_dwordx4 v6, s[8:11], s49 offen offset:0 lds
    buffer_load_dwordx4 v7, s[8:11], s49 offen offset:1024 lds
    s_waitcnt lgkmcnt(5)
    v_mfma_f32_32x32x16_bf16 v[32:47], v[104:107], v[80:83], 0
    s_add_u32 m0, s52, 8192
    ds_read_b128 v[112:115], v11 offset:0
    ds_read_b64_tr_b16 v[96:97], v17 offset:0
    ds_read_b64_tr_b16 v[98:99], v17 offset:512
    s_mov_b32 s48, 256
    buffer_load_dwordx4 v2, s[4:7], s48 offen offset:0 lds
    s_add_u32 s76, s76, 114688
    v_mfma_f32_32x32x16_bf16 v[48:63], v[104:107], v[84:87], 0
    ds_read_b64_tr_b16 v[100:101], v18 offset:0
    ds_read_b64_tr_b16 v[102:103], v18 offset:512
    buffer_load_dwordx4 v3, s[4:7], s48 offen offset:1024 lds
    v_add_u32 v66, s76, v254
    v_accvgpr_write_b32 a16, v66
    s_waitcnt lgkmcnt(5)
    v_mfma_f32_32x32x16_bf16 v[32:47], v[108:111], v[88:91], v[32:47]
    ds_read_b128 v[116:119], v12 offset:0
    ds_read_b64_tr_b16 v[80:81], v19 offset:0
    ds_read_b64_tr_b16 v[82:83], v19 offset:512
    buffer_load_dwordx4 v4, s[4:7], s48 offen offset:2048 lds
    v_lshlrev_b32 v66, 2, v65
    v_and_b32 v67, 15, v1
    v_mfma_f32_32x32x16_bf16 v[48:63], v[108:111], v[92:95], v[48:63]
    ds_read_b64_tr_b16 v[84:85], v20 offset:0
    ds_read_b64_tr_b16 v[86:87], v20 offset:512
    buffer_load_dwordx4 v5, s[4:7], s48 offen offset:3072 lds
    v_xor_b32 v66, v66, v67
    v_mul_u32_u24 v67, 3584, v65
    s_waitcnt lgkmcnt(5)
    v_dot2c_f32_bf16 v28, v96, v25
    v_dot2c_f32_bf16 v29, v100, v25
    v_dot2c_f32_bf16 v28, v97, v25
    v_dot2c_f32_bf16 v29, v101, v25
    v_dot2c_f32_bf16 v28, v98, v25
    v_dot2c_f32_bf16 v29, v102, v25
    v_dot2c_f32_bf16 v28, v99, v25
    v_dot2c_f32_bf16 v29, v103, v25
    v_dot2c_f32_bf16 v26, v104, v25
    v_dot2c_f32_bf16 v27, v104, v104
    v_dot2c_f32_bf16 v26, v105, v25
    v_dot2c_f32_bf16 v27, v105, v105
    v_dot2c_f32_bf16 v26, v106, v25
    v_dot2c_f32_bf16 v27, v106, v106
    v_dot2c_f32_bf16 v26, v107, v25
    v_dot2c_f32_bf16 v27, v107, v107
    v_dot2c_f32_bf16 v26, v108, v25
    v_dot2c_f32_bf16 v27, v108, v108
    v_dot2c_f32_bf16 v26, v109, v25
    v_dot2c_f32_bf16 v27, v109, v109
    v_dot2c_f32_bf16 v26, v110, v25
    v_dot2c_f32_bf16 v27, v110, v110
    v_dot2c_f32_bf16 v26, v111, v25
    v_dot2c_f32_bf16 v27, v111, v111
    v_dot2c_f32_bf16 v26, v112, v25
    v_dot2c_f32_bf16 v27, v112, v112
    v_dot2c_f32_bf16 v26, v113, v25
    v_dot2c_f32_bf16 v27, v113, v113
    v_dot2c_f32_bf16 v26, v114, v25
    v_dot2c_f32_bf16 v27, v114, v114
    v_dot2c_f32_bf16 v26, v115, v25
    v_dot2c_f32_bf16 v27, v115, v115
    s_waitcnt vmcnt(6)
    s_barrier
    v_mfma_f32_32x32x16_bf16 v[32:47], v[112:115], v[96:99], v[32:47]
    ds_read_b128 v[120:123], v9 offset:4096
    ds_read_b64_tr_b16 v[88:89], v13 offset:8192
    ds_read_b64_tr_b16 v[90:91], v13 offset:8704
    v_lshl_add_u32 v66, v66, 4, v67
    v_accvgpr_write_b32 a17, v66
    v_lshl_add_u32 v66, v74, 8, v75
    v_xor_b32 v67, s16, v76
    v_mfma_f32_32x32x16_bf16 v[48:63], v[112:115], v[100:103], v[48:63]
    s_add_u32 m0, s53, 24576
    ds_read_b64_tr_b16 v[92:93], v14 offset:8192
    ds_read_b64_tr_b16 v[94:95], v14 offset:8704
    s_add_u32 s49, s49, 172032
    buffer_load_dwordx4 v6, s[8:11], s49 offen offset:0 lds
    v_lshl_add_u32 v66, v67, 6, v66
    s_waitcnt lgkmcnt(5)
    v_mfma_f32_32x32x16_bf16 v[32:47], v[116:119], v[80:83], v[32:47]
    ds_read_b128 v[124:127], v10 offset:4096
    ds_read_b64_tr_b16 v[96:97], v15 offset:8192
    ds_read_b64_tr_b16 v[98:99], v15 offset:8704
    buffer_load_dwordx4 v7, s[8:11], s49 offen offset:1024 lds
    v_accvgpr_write_b32 a18, v66
    v_add_u32 v66, s64, v79
    v_mfma_f32_32x32x16_bf16 v[48:63], v[116:119], v[84:87], v[48:63]
    ds_read_b64_tr_b16 v[100:101], v16 offset:8192
    ds_read_b64_tr_b16 v[102:103], v16 offset:8704
    s_and_b32 s76, s65, 0xffffff80
    s_sub_u32 s76, s76, 2048
    v_add_u32 v67, s76, v79
    v_cmp_gt_u32 vcc, 16, v1
    s_waitcnt lgkmcnt(5)
    v_mfma_f32_32x32x16_bf16 v[32:47], v[120:123], v[88:91], v[32:47]
    s_add_u32 m0, s52, 0
    ds_read_b128 v[128:131], v11 offset:4096
    ds_read_b64_tr_b16 v[80:81], v17 offset:8192
    ds_read_b64_tr_b16 v[82:83], v17 offset:8704
    s_add_u32 s48, s48, 128
    buffer_load_dwordx4 v2, s[4:7], s48 offen offset:0 lds
    v_cndmask_b32 v66, v67, v66, vcc
    v_mfma_f32_32x32x16_bf16 v[48:63], v[120:123], v[92:95], v[48:63]
    ds_read_b64_tr_b16 v[84:85], v18 offset:8192
    ds_read_b64_tr_b16 v[86:87], v18 offset:8704
    buffer_load_dwordx4 v3, s[4:7], s48 offen offset:1024 lds
    v_cmp_gt_u32 vcc, 20, v1
    s_nop 1
    v_cndmask_b32 v66, v78, v66, vcc
    s_waitcnt lgkmcnt(5)
    v_mfma_f32_32x32x16_bf16 v[32:47], v[124:127], v[96:99], v[32:47]
    ds_read_b128 v[132:135], v12 offset:4096
    ds_read_b64_tr_b16 v[88:89], v19 offset:8192
    ds_read_b64_tr_b16 v[90:91], v19 offset:8704
    buffer_load_dwordx4 v4, s[4:7], s48 offen offset:2048 lds
    s_lshl_b32 s51, s51, 11
    s_add_u32 s76, s51, 21047296
    v_mfma_f32_32x32x16_bf16 v[48:63], v[124:127], v[100:103], v[48:63]
    ds_read_b64_tr_b16 v[92:93], v20 offset:8192
    ds_read_b64_tr_b16 v[94:95], v20 offset:8704
    buffer_load_dwordx4 v5, s[4:7], s48 offen offset:3072 lds
    v_add_u32 v67, s76, v79
    v_cmp_gt_u32 vcc, 48, v1
    s_waitcnt lgkmcnt(5)
    v_dot2c_f32_bf16 v28, v80, v25
    v_dot2c_f32_bf16 v29, v84, v25
    v_dot2c_f32_bf16 v28, v81, v25
    v_dot2c_f32_bf16 v29, v85, v25
    v_dot2c_f32_bf16 v28, v82, v25
    v_dot2c_f32_bf16 v29, v86, v25
    v_dot2c_f32_bf16 v28, v83, v25
    v_dot2c_f32_bf16 v29, v87, v25
    v_dot2c_f32_bf16 v26, v116, v25
    v_dot2c_f32_bf16 v27, v116, v116
    v_dot2c_f32_bf16 v26, v117, v25
    v_dot2c_f32_bf16 v27, v117, v117
    v_dot2c_f32_bf16 v26, v118, v25
    v_dot2c_f32_bf16 v27, v118, v118
    v_dot2c_f32_bf16 v26, v119, v25
    v_dot2c_f32_bf16 v27, v119, v119
    v_dot2c_f32_bf16 v26, v120, v25
    v_dot2c_f32_bf16 v27, v120, v120
    v_dot2c_f32_bf16 v26, v121, v25
    v_dot2c_f32_bf16 v27, v121, v121
    v_dot2c_f32_bf16 v26, v122, v25
    v_dot2c_f32_bf16 v27, v122, v122
    v_dot2c_f32_bf16 v26, v123, v25
    v_dot2c_f32_bf16 v27, v123, v123
    v_dot2c_f32_bf16 v26, v124, v25
    v_dot2c_f32_bf16 v27, v124, v124
    v_dot2c_f32_bf16 v26, v125, v25
    v_dot2c_f32_bf16 v27, v125, v125
    v_dot2c_f32_bf16 v26, v126, v25
    v_dot2c_f32_bf16 v27, v126, v126
    v_dot2c_f32_bf16 v26, v127, v25
    v_dot2c_f32_bf16 v27, v127, v127
    v_dot2c_f32_bf16 v26, v128, v25
    v_dot2c_f32_bf16 v27, v128, v128
    v_dot2c_f32_bf16 v26, v129, v25
    v_dot2c_f32_bf16 v27, v129, v129
    v_dot2c_f32_bf16 v26, v130, v25
    v_dot2c_f32_bf16 v27, v130, v130
    v_dot2c_f32_bf16 v26, v131, v25
    v_dot2c_f32_bf16 v27, v131, v131
    s_waitcnt vmcnt(6)
    s_barrier
    v_mfma_f32_32x32x16_bf16 v[32:47], v[128:131], v[80:83], v[32:47]
    ds_read_b128 v[136:139], v9 offset:8192
    ds_read_b64_tr_b16 v[96:97], v13 offset:16384
    ds_read_b64_tr_b16 v[98:99], v13 offset:16896
    v_cndmask_b32 v66, v67, v66, vcc
    v_writelane_b32 v66, s78, 20
    s_add_u32 s51, s51, 21037056
L_w0_0:
    s_cbranch_execz L_w0_r
    s_bfe_u32 s76, s2, 0x20003
    v_mfma_f32_32x32x16_bf16 v[48:63], v[128:131], v[84:87], v[48:63]
    s_add_u32 m0, s53, 32768
    ds_read_b64_tr_b16 v[100:101], v14 offset:16384
    ds_read_b64_tr_b16 v[102:103], v14 offset:16896
    s_add_u32 s49, s49, 172032
    buffer_load_dwordx4 v6, s[8:11], s49 offen offset:0 lds
    s_lshl2_add_u32 s76, s76, s16
    s_waitcnt lgkmcnt(5)
    v_mfma_f32_32x32x16_bf16 v[32:47], v[132:135], v[88:91], v[32:47]
    ds_read_b128 v[140:143], v10 offset:8192
    ds_read_b64_tr_b16 v[80:81], v15 offset:16384
    ds_read_b64_tr_b16 v[82:83], v15 offset:16896
    buffer_load_dwordx4 v7, s[8:11], s49 offen offset:1024 lds
    s_lshl_b32 s76, s76, 11
    v_and_b32 v67, 0x780, v79
    v_mfma_f32_32x32x16_bf16 v[48:63], v[132:135], v[92:95], v[48:63]
    ds_read_b64_tr_b16 v[84:85], v16 offset:16384
    ds_read_b64_tr_b16 v[86:87], v16 offset:16896
    v_add_u32 v71, s76, v67
    v_min_u32 v71, L_fallback-L_pc1, v71
    v_accvgpr_write_b32 a19, v66
    v_accvgpr_write_b32 a20, v71
    s_add_u32 m0, s54, 0
    s_nop 0
    buffer_load_dwordx4 v8, s[36:39], s50 offen lds
    s_waitcnt lgkmcnt(5)
    v_mfma_f32_32x32x16_bf16 v[32:47], v[136:139], v[96:99], v[32:47]
    s_add_u32 m0, s52, 4096
    ds_read_b128 v[144:147], v11 offset:8192
    ds_read_b64_tr_b16 v[88:89], v17 offset:16384
    ds_read_b64_tr_b16 v[90:91], v17 offset:16896
    s_add_u32 s48, s48, 128
    buffer_load_dwordx4 v2, s[4:7], s48 offen offset:0 lds
    v_mul_u32_u24 v66, 53248, v72
    v_mfma_f32_32x32x16_bf16 v[48:63], v[136:139], v[100:103], v[48:63]
    ds_read_b64_tr_b16 v[92:93], v18 offset:16384
    ds_read_b64_tr_b16 v[94:95], v18 offset:16896
    buffer_load_dwordx4 v3, s[4:7], s48 offen offset:1024 lds
    v_add_u32 v66, v66, v79
    v_accvgpr_write_b32 a21, v66
    s_waitcnt lgkmcnt(5)
    v_mfma_f32_32x32x16_bf16 v[32:47], v[140:143], v[80:83], v[32:47]
    ds_read_b128 v[148:151], v12 offset:8192
    ds_read_b64_tr_b16 v[96:97], v19 offset:16384
    ds_read_b64_tr_b16 v[98:99], v19 offset:16896
    buffer_load_dwordx4 v4, s[4:7], s48 offen offset:2048 lds
    s_lshl_b32 s76, s17, 12
    s_add_u32 s76, s76, 20971520
    v_mfma_f32_32x32x16_bf16 v[48:63], v[140:143], v[84:87], v[48:63]
    ds_read_b64_tr_b16 v[100:101], v20 offset:16384
    ds_read_b64_tr_b16 v[102:103], v20 offset:16896
    buffer_load_dwordx4 v5, s[4:7], s48 offen offset:3072 lds
    s_cmp_eq_u32 s16, 0
    s_cselect_b32 s76, s76, 23068672
    v_writelane_b32 v78, s76, 0
    s_waitcnt lgkmcnt(5)
    v_dot2c_f32_bf16 v28, v88, v25
    v_dot2c_f32_bf16 v29, v92, v25
    v_dot2c_f32_bf16 v28, v89, v25
    v_dot2c_f32_bf16 v29, v93, v25
    v_dot2c_f32_bf16 v28, v90, v25
    v_dot2c_f32_bf16 v29, v94, v25
    v_dot2c_f32_bf16 v28, v91, v25
    v_dot2c_f32_bf16 v29, v95, v25
    v_dot2c_f32_bf16 v26, v132, v25
    v_dot2c_f32_bf16 v27, v132, v132
    v_dot2c_f32_bf16 v26, v133, v25
    v_dot2c_f32_bf16 v27, v133, v133
    v_dot2c_f32_bf16 v26, v134, v25
    v_dot2c_f32_bf16 v27, v134, v134
    v_dot2c_f32_bf16 v26, v135, v25
    v_dot2c_f32_bf16 v27, v135, v135
    v_dot2c_f32_bf16 v26, v136, v25
    v_dot2c_f32_bf16 v27, v136, v136
    v_dot2c_f32_bf16 v26, v137, v25
    v_dot2c_f32_bf16 v27, v137, v137
    v_dot2c_f32_bf16 v26, v138, v25
    v_dot2c_f32_bf16 v27, v138, v138
    v_dot2c_f32_bf16 v26, v139, v25
    v_dot2c_f32_bf16 v27, v139, v139
    v_dot2c_f32_bf16 v26, v140, v25
    v_dot2c_f32_bf16 v27, v140, v140
    v_dot2c_f32_bf16 v26, v141, v25
    v_dot2c_f32_bf16 v27, v141, v141
    v_dot2c_f32_bf16 v26, v142, v25
    v_dot2c_f32_bf16 v27, v142, v142
    v_dot2c_f32_bf16 v26, v143, v25
    v_dot2c_f32_bf16 v27, v143, v143
    v_dot2c_f32_bf16 v26, v144, v25
    v_dot2c_f32_bf16 v27, v144, v144
    v_dot2c_f32_bf16 v26, v145, v25
    v_dot2c_f32_bf16 v27, v145, v145
    v_dot2c_f32_bf16 v26, v146, v25
    v_dot2c_f32_bf16 v27, v146, v146
    v_dot2c_f32_bf16 v26, v147, v25
    v_dot2c_f32_bf16 v27, v147, v147
    s_waitcnt vmcnt(7)
    s_barrier
    v_mfma_f32_32x32x16_bf16 v[32:47], v[144:147], v[88:91], v[32:47]
    ds_read_b128 v[152:155], v9 offset:0
    ds_read_b64_tr_b16 v[80:81], v13 offset:24576
    ds_read_b64_tr_b16 v[82:83], v13 offset:25088
    v_mul_u32_u24 v66, 12288, v77
    v_add_u32 v66, 114688, v66
    v_lshlrev_b32 v67, 2, v73
    v_sub_u32 v67, v67, v254
    v_mfma_f32_32x32x16_bf16 v[48:63], v[144:147], v[92:95], v[48:63]
    s_add_u32 m0, s53, 40960
    ds_read_b64_tr_b16 v[84:85], v14 offset:24576
    ds_read_b64_tr_b16 v[86:87], v14 offset:25088
    s_add_u32 s49, s49, 172032
    buffer_load_dwordx4 v6, s[8:11], s49 offen offset:0 lds
    v_accvgpr_write_b32 a22, v78
    s_waitcnt lgkmcnt(5)
    v_mfma_f32_32x32x16_bf16 v[32:47], v[148:151], v[96:99], v[32:47]
    ds_read_b128 v[156:159], v10 offset:0
    ds_read_b64_tr_b16 v[88:89], v15 offset:24576
    ds_read_b64_tr_b16 v[90:91], v15 offset:25088
    buffer_load_dwordx4 v7, s[8:11], s49 offen offset:1024 lds
    v_accvgpr_write_b32 a23, v66
    v_accvgpr_write_b32 a24, v67
    v_mfma_f32_32x32x16_bf16 v[48:63], v[148:151], v[100:103], v[48:63]
    ds_read_b64_tr_b16 v[92:93], v16 offset:24576
    ds_read_b64_tr_b16 v[94:95], v16 offset:25088
    s_and_b32 s76, s17, 1
    s_lshl1_add_u32 s76, s16, s76
    s_mul_i32 s46, s76, 460800
    s_xor_b32 s76, s76, 1
    s_waitcnt lgkmcnt(5)
    v_mfma_f32_32x32x16_bf16 v[32:47], v[152:155], v[80:83], v[32:47]
    s_add_u32 m0, s52, 8192
    ds_read_b128 v[160:163], v11 offset:0
    ds_read_b64_tr_b16 v[96:97], v17 offset:24576
    ds_read_b64_tr_b16 v[98:99], v17 offset:25088
    s_add_u32 s48, s48, 128
    buffer_load_dwordx4 v2, s[4:7], s48 offen offset:0 lds
    s_mul_i32 s47, s76, 460800
    v_mfma_f32_32x32x16_bf16 v[48:63], v[152:155], v[84:87], v[48:63]
    ds_read_b64_tr_b16 v[100:101], v18 offset:24576
    ds_read_b64_tr_b16 v[102:103], v18 offset:25088
    buffer_load_dwordx4 v3, s[4:7], s48 offen offset:1024 lds
    s_mul_i32 s44, s22, 294912
    s_add_u32 s44, s44, 18874368
    s_waitcnt lgkmcnt(5)
    v_mfma_f32_32x32x16_bf16 v[32:47], v[156:159], v[88:91], v[32:47]
    ds_read_b128 v[164:167], v12 offset:0
    ds_read_b64_tr_b16 v[80:81], v19 offset:24576
    ds_read_b64_tr_b16 v[82:83], v19 offset:25088
    buffer_load_dwordx4 v4, s[4:7], s48 offen offset:2048 lds
    s_cmp_lt_u32 s20, 14
    s_cselect_b32 s44, s44, 23068672
    s_mul_i32 s45, s16, 57344
    v_mfma_f32_32x32x16_bf16 v[48:63], v[156:159], v[92:95], v[48:63]
    ds_read_b64_tr_b16 v[84:85], v20 offset:24576
    ds_read_b64_tr_b16 v[86:87], v20 offset:25088
    buffer_load_dwordx4 v5, s[4:7], s48 offen offset:3072 lds
    s_add_u32 s45, s45, s44
    s_lshl2_add_u32 s44, s59, s44
    s_waitcnt lgkmcnt(5)
    v_dot2c_f32_bf16 v28, v96, v25
    v_dot2c_f32_bf16 v29, v100, v25
    v_dot2c_f32_bf16 v28, v97, v25
    v_dot2c_f32_bf16 v29, v101, v25
    v_dot2c_f32_bf16 v28, v98, v25
    v_dot2c_f32_bf16 v29, v102, v25
    v_dot2c_f32_bf16 v28, v99, v25
    v_dot2c_f32_bf16 v29, v103, v25
    v_dot2c_f32_bf16 v26, v148, v25
    v_dot2c_f32_bf16 v27, v148, v148
    v_dot2c_f32_bf16 v26, v149, v25
    v_dot2c_f32_bf16 v27, v149, v149
    v_dot2c_f32_bf16 v26, v150, v25
    v_dot2c_f32_bf16 v27, v150, v150
    v_dot2c_f32_bf16 v26, v151, v25
    v_dot2c_f32_bf16 v27, v151, v151
    v_dot2c_f32_bf16 v26, v152, v25
    v_dot2c_f32_bf16 v27, v152, v152
    v_dot2c_f32_bf16 v26, v153, v25
    v_dot2c_f32_bf16 v27, v153, v153
    v_dot2c_f32_bf16 v26, v154, v25
    v_dot2c_f32_bf16 v27, v154, v154
    v_dot2c_f32_bf16 v26, v155, v25
    v_dot2c_f32_bf16 v27, v155, v155
    v_dot2c_f32_bf16 v26, v156, v25
    v_dot2c_f32_bf16 v27, v156, v156
    v_dot2c_f32_bf16 v26, v157, v25
    v_dot2c_f32_bf16 v27, v157, v157
    v_dot2c_f32_bf16 v26, v158, v25
    v_dot2c_f32_bf16 v27, v158, v158
    v_dot2c_f32_bf16 v26, v159, v25
    v_dot2c_f32_bf16 v27, v159, v159
    v_dot2c_f32_bf16 v26, v160, v25
    v_dot2c_f32_bf16 v27, v160, v160
    v_dot2c_f32_bf16 v26, v161, v25
    v_dot2c_f32_bf16 v27, v161, v161
    v_dot2c_f32_bf16 v26, v162, v25
    v_dot2c_f32_bf16 v27, v162, v162
    v_dot2c_f32_bf16 v26, v163, v25
    v_dot2c_f32_bf16 v27, v163, v163
    s_waitcnt vmcnt(6)
    s_barrier
    v_mfma_f32_32x32x16_bf16 v[32:47], v[160:163], v[96:99], v[32:47]
    ds_read_b128 v[168:171], v9 offset:4096
    ds_read_b64_tr_b16 v[88:89], v13 offset:32768
    ds_read_b64_tr_b16 v[90:91], v13 offset:33280
    s_add_u32 s44, s44, 229376
    s_and_b32 s76, s16, 1
    s_lshl1_add_u32 s63, s23, s76
    s_lshl_b32 s62, s63, 14
    v_mfma_f32_32x32x16_bf16 v[48:63], v[160:163], v[100:103], v[48:63]
    s_add_u32 m0, s53, 49152
    ds_read_b64_tr_b16 v[92:93], v14 offset:32768
    ds_read_b64_tr_b16 v[94:95], v14 offset:33280
    s_add_u32 s49, s49, 172032
    buffer_load_dwordx4 v6, s[8:11], s49 offen offset:0 lds
    s_add_u32 s62, s59, s62
    s_waitcnt lgkmcnt(5)
    v_mfma_f32_32x32x16_bf16 v[32:47], v[164:167], v[80:83], v[32:47]
    ds_read_b128 v[172:175], v10 offset:4096
    ds_read_b64_tr_b16 v[96:97], v15 offset:32768
    ds_read_b64_tr_b16 v[98:99], v15 offset:33280
    buffer_load_dwordx4 v7, s[8:11], s49 offen offset:1024 lds
    s_add_u32 s62, s62, 6291456
    s_mul_i32 s77, s76, 1792
    v_mfma_f32_32x32x16_bf16 v[48:63], v[164:167], v[84:87], v[48:63]
    ds_read_b64_tr_b16 v[100:101], v16 offset:32768
    ds_read_b64_tr_b16 v[102:103], v16 offset:33280
    s_sub_u32 s64, s64, s77
    s_lshl_b32 s77, s76, 8
    s_add_u32 s65, s65, s77
    s_and_b32 s77, s22, 1
    s_add_u32 m0, s54, 4096
    s_sub_u32 s50, 172032, s50
    buffer_load_dwordx4 v8, s[36:39], s50 offen lds
    s_waitcnt lgkmcnt(5)
    v_mfma_f32_32x32x16_bf16 v[32:47], v[168:171], v[88:91], v[32:47]
    s_add_u32 m0, s52, 0
    ds_read_b128 v[176:179], v11 offset:4096
    ds_read_b64_tr_b16 v[80:81], v17 offset:32768
    ds_read_b64_tr_b16 v[82:83], v17 offset:33280
    s_add_u32 s48, s48, 128
    buffer_load_dwordx4 v2, s[4:7], s48 offen offset:0 lds
    s_lshl3_add_u32 s65, s77, s65
    v_mfma_f32_32x32x16_bf16 v[48:63], v[168:171], v[92:95], v[48:63]
    ds_read_b64_tr_b16 v[84:85], v18 offset:32768
    ds_read_b64_tr_b16 v[86:87], v18 offset:33280
    buffer_load_dwordx4 v3, s[4:7], s48 offen offset:1024 lds
    s_lshl_b32 s66, s16, 7
    s_add_u32 s66, s66, s25
    s_waitcnt lgkmcnt(5)
    v_mfma_f32_32x32x16_bf16 v[32:47], v[172:175], v[96:99], v[32:47]
    ds_read_b128 v[180:183], v12 offset:4096
    ds_read_b64_tr_b16 v[88:89], v19 offset:32768
    ds_read_b64_tr_b16 v[90:91], v19 offset:33280
    buffer_load_dwordx4 v4, s[4:7], s48 offen offset:2048 lds
    s_lshl2_add_u32 s76, s19, s16
    s_mul_i32 s67, s76, 28672
    v_mfma_f32_32x32x16_bf16 v[48:63], v[172:175], v[100:103], v[48:63]
    ds_read_b64_tr_b16 v[92:93], v20 offset:32768
    ds_read_b64_tr_b16 v[94:95], v20 offset:33280
    buffer_load_dwordx4 v5, s[4:7], s48 offen offset:3072 lds
    s_add_u32 s67, s67, 8388608
    s_lshl_b32 s68, s76, 12
    global_load_dword v245, v219, s[100:101] sc1
    s_waitcnt lgkmcnt(5)
    v_dot2c_f32_bf16 v28, v80, v25
    v_dot2c_f32_bf16 v29, v84, v25
    v_dot2c_f32_bf16 v28, v81, v25
    v_dot2c_f32_bf16 v29, v85, v25
    v_dot2c_f32_bf16 v28, v82, v25
    v_dot2c_f32_bf16 v29, v86, v25
    v_dot2c_f32_bf16 v28, v83, v25
    v_dot2c_f32_bf16 v29, v87, v25
    v_dot2c_f32_bf16 v26, v164, v25
    v_dot2c_f32_bf16 v27, v164, v164
    v_dot2c_f32_bf16 v26, v165, v25
    v_dot2c_f32_bf16 v27, v165, v165
    v_dot2c_f32_bf16 v26, v166, v25
    v_dot2c_f32_bf16 v27, v166, v166
    v_dot2c_f32_bf16 v26, v167, v25
    v_dot2c_f32_bf16 v27, v167, v167
    v_dot2c_f32_bf16 v26, v168, v25
    v_dot2c_f32_bf16 v27, v168, v168
    v_dot2c_f32_bf16 v26, v169, v25
    v_dot2c_f32_bf16 v27, v169, v169
    v_dot2c_f32_bf16 v26, v170, v25
    v_dot2c_f32_bf16 v27, v170, v170
    v_dot2c_f32_bf16 v26, v171, v25
    v_dot2c_f32_bf16 v27, v171, v171
    v_dot2c_f32_bf16 v26, v172, v25
    v_dot2c_f32_bf16 v27, v172, v172
    v_dot2c_f32_bf16 v26, v173, v25
    v_dot2c_f32_bf16 v27, v173, v173
    v_dot2c_f32_bf16 v26, v174, v25
    v_dot2c_f32_bf16 v27, v174, v174
    v_dot2c_f32_bf16 v26, v175, v25
    v_dot2c_f32_bf16 v27, v175, v175
    v_dot2c_f32_bf16 v26, v176, v25
    v_dot2c_f32_bf16 v27, v176, v176
    v_dot2c_f32_bf16 v26, v177, v25
    v_dot2c_f32_bf16 v27, v177, v177
    v_dot2c_f32_bf16 v26, v178, v25
    v_dot2c_f32_bf16 v27, v178, v178
    v_dot2c_f32_bf16 v26, v179, v25
    v_dot2c_f32_bf16 v27, v179, v179
    s_waitcnt vmcnt(8)
    s_barrier
    v_mfma_f32_32x32x16_bf16 v[32:47], v[176:179], v[80:83], v[32:47]
    ds_read_b128 v[184:187], v9 offset:8192
    ds_read_b64_tr_b16 v[96:97], v13 offset:40960
    ds_read_b64_tr_b16 v[98:99], v13 offset:41472
    s_add_u32 s68, s68, 10354688
    s_mul_i32 s28, s76, 114688
    s_lshl_b32 s77, s20, 12
    s_add_u32 s28, s28, s77
    v_mfma_f32_32x32x16_bf16 v[48:63], v[176:179], v[84:87], v[48:63]
    s_add_u32 m0, s54, 8192
    ds_read_b64_tr_b16 v[100:101], v14 offset:40960
    ds_read_b64_tr_b16 v[102:103], v14 offset:41472
    s_mov_b32 s50, 344064
    buffer_load_dwordx4 v8, s[36:39], s50 offen lds
    s_add_u32 s28, s28, 10747904
    s_waitcnt lgkmcnt(5)
    v_mfma_f32_32x32x16_bf16 v[32:47], v[180:183], v[88:91], v[32:47]
    ds_read_b128 v[188:191], v10 offset:8192
    ds_read_b64_tr_b16 v[80:81], v15 offset:40960
    ds_read_b64_tr_b16 v[82:83], v15 offset:41472
    s_and_b32 s74, s53, 2048
    s_lshl2_add_u32 s72, s74, s45
    s_lshl_b32 s77, s74, 2
    s_sub_u32 s73, s45, s77
    v_mfma_f32_32x32x16_bf16 v[48:63], v[180:183], v[92:95], v[48:63]
    s_add_u32 m0, s54, 12288
    ds_read_b64_tr_b16 v[84:85], v16 offset:40960
    ds_read_b64_tr_b16 v[86:87], v16 offset:41472
    s_add_u32 s50, s50, 172032
    buffer_load_dwordx4 v8, s[36:39], s50 offen lds
    s_lshl_b32 s69, s21, 8
    s_waitcnt lgkmcnt(5)
    v_mfma_f32_32x32x16_bf16 v[32:47], v[184:187], v[96:99], v[32:47]
    ds_read_b128 v[192:195], v11 offset:8192
    ds_read_b64_tr_b16 v[88:89], v17 offset:40960
    ds_read_b64_tr_b16 v[90:91], v17 offset:41472
    s_add_u32 s69, s69, s25
    s_mul_i32 s75, s16, 14336
    s_add_u32 s75, s75, 10747904
    v_mfma_f32_32x32x16_bf16 v[48:63], v[184:187], v[100:103], v[48:63]
    s_add_u32 m0, s54, 16384
    ds_read_b64_tr_b16 v[92:93], v18 offset:40960
    ds_read_b64_tr_b16 v[94:95], v18 offset:41472
    s_add_u32 s50, s50, 172032
    buffer_load_dwordx4 v8, s[36:39], s50 offen lds
    s_waitcnt lgkmcnt(5)
    v_mfma_f32_32x32x16_bf16 v[32:47], v[188:191], v[80:83], v[32:47]
    ds_read_b128 v[196:199], v12 offset:8192
    ds_read_b64_tr_b16 v[96:97], v19 offset:40960
    ds_read_b64_tr_b16 v[98:99], v19 offset:41472
    v_mfma_f32_32x32x16_bf16 v[48:63], v[188:191], v[84:87], v[48:63]
    s_add_u32 m0, s54, 20480
    ds_read_b64_tr_b16 v[100:101], v20 offset:40960
    ds_read_b64_tr_b16 v[102:103], v20 offset:41472
    s_add_u32 s50, s50, 172032
    buffer_load_dwordx4 v8, s[36:39], s50 offen lds
    s_waitcnt lgkmcnt(5)
    v_dot2c_f32_bf16 v28, v88, v25
    v_dot2c_f32_bf16 v29, v92, v25
    v_dot2c_f32_bf16 v28, v89, v25
    v_dot2c_f32_bf16 v29, v93, v25
    v_dot2c_f32_bf16 v28, v90, v25
    v_dot2c_f32_bf16 v29, v94, v25
    v_dot2c_f32_bf16 v28, v91, v25
    v_dot2c_f32_bf16 v29, v95, v25
    v_dot2c_f32_bf16 v26, v180, v25
    v_dot2c_f32_bf16 v27, v180, v180
    v_dot2c_f32_bf16 v26, v181, v25
    v_dot2c_f32_bf16 v27, v181, v181
    v_dot2c_f32_bf16 v26, v182, v25
    v_dot2c_f32_bf16 v27, v182, v182
    v_dot2c_f32_bf16 v26, v183, v25
    v_dot2c_f32_bf16 v27, v183, v183
    v_dot2c_f32_bf16 v26, v184, v25
    v_dot2c_f32_bf16 v27, v184, v184
    v_dot2c_f32_bf16 v26, v185, v25
    v_dot2c_f32_bf16 v27, v185, v185
    v_dot2c_f32_bf16 v26, v186, v25
    v_dot2c_f32_bf16 v27, v186, v186
    v_dot2c_f32_bf16 v26, v187, v25
    v_dot2c_f32_bf16 v27, v187, v187
    v_dot2c_f32_bf16 v26, v188, v25
    v_dot2c_f32_bf16 v27, v188, v188
    v_dot2c_f32_bf16 v26, v189, v25
    v_dot2c_f32_bf16 v27, v189, v189
    v_dot2c_f32_bf16 v26, v190, v25
    v_dot2c_f32_bf16 v27, v190, v190
    v_dot2c_f32_bf16 v26, v191, v25
    v_dot2c_f32_bf16 v27, v191, v191
    v_dot2c_f32_bf16 v26, v192, v25
    v_dot2c_f32_bf16 v27, v192, v192
    v_dot2c_f32_bf16 v26, v193, v25
    v_dot2c_f32_bf16 v27, v193, v193
    v_dot2c_f32_bf16 v26, v194, v25
    v_dot2c_f32_bf16 v27, v194, v194
    v_dot2c_f32_bf16 v26, v195, v25
    v_dot2c_f32_bf16 v27, v195, v195
    s_waitcnt vmcnt(5)
    s_barrier
    v_mfma_f32_32x32x16_bf16 v[32:47], v[192:195], v[88:91], v[32:47]
    ds_read_b128 v[200:203], v9 offset:0
    ds_read_b64_tr_b16 v[80:81], v13 offset:49152
    ds_read_b64_tr_b16 v[82:83], v13 offset:49664
    v_mfma_f32_32x32x16_bf16 v[48:63], v[192:195], v[92:95], v[48:63]
    s_add_u32 m0, s54, 24576
    ds_read_b64_tr_b16 v[84:85], v14 offset:49152
    ds_read_b64_tr_b16 v[86:87], v14 offset:49664
    s_add_u32 s50, s50, 172032
    buffer_load_dwordx4 v8, s[36:39], s50 offen lds
    s_waitcnt lgkmcnt(5)
    v_mfma_f32_32x32x16_bf16 v[32:47], v[196:199], v[96:99], v[32:47]
    ds_read_b128 v[204:207], v10 offset:0
    ds_read_b64_tr_b16 v[88:89], v15 offset:49152
    ds_read_b64_tr_b16 v[90:91], v15 offset:49664
    v_mfma_f32_32x32x16_bf16 v[48:63], v[196:199], v[100:103], v[48:63]
    ds_read_b64_tr_b16 v[92:93], v16 offset:49152
    ds_read_b64_tr_b16 v[94:95], v16 offset:49664
    s_waitcnt lgkmcnt(5)
    v_mfma_f32_32x32x16_bf16 v[32:47], v[200:203], v[80:83], v[32:47]
    ds_read_b128 v[208:211], v11 offset:0
    ds_read_b64_tr_b16 v[96:97], v17 offset:49152
    ds_read_b64_tr_b16 v[98:99], v17 offset:49664
    v_mfma_f32_32x32x16_bf16 v[48:63], v[200:203], v[84:87], v[48:63]
    ds_read_b64_tr_b16 v[100:101], v18 offset:49152
    ds_read_b64_tr_b16 v[102:103], v18 offset:49664
    s_waitcnt lgkmcnt(5)
    v_mfma_f32_32x32x16_bf16 v[32:47], v[204:207], v[88:91], v[32:47]
    ds_read_b128 v[212:215], v12 offset:0
    ds_read_b64_tr_b16 v[80:81], v19 offset:49152
    ds_read_b64_tr_b16 v[82:83], v19 offset:49664
    v_mfma_f32_32x32x16_bf16 v[48:63], v[204:207], v[92:95], v[48:63]
    ds_read_b64_tr_b16 v[84:85], v20 offset:49152
    ds_read_b64_tr_b16 v[86:87], v20 offset:49664
    s_waitcnt lgkmcnt(0)
    v_dot2c_f32_bf16 v28, v96, v25
    v_dot2c_f32_bf16 v29, v100, v25
    v_dot2c_f32_bf16 v28, v97, v25
    v_dot2c_f32_bf16 v29, v101, v25
    v_dot2c_f32_bf16 v28, v98, v25
    v_dot2c_f32_bf16 v29, v102, v25
    v_dot2c_f32_bf16 v28, v99, v25
    v_dot2c_f32_bf16 v29, v103, v25
    v_dot2c_f32_bf16 v26, v196, v25
    v_dot2c_f32_bf16 v27, v196, v196
    v_dot2c_f32_bf16 v26, v197, v25
    v_dot2c_f32_bf16 v27, v197, v197
    v_dot2c_f32_bf16 v26, v198, v25
    v_dot2c_f32_bf16 v27, v198, v198
    v_dot2c_f32_bf16 v26, v199, v25
    v_dot2c_f32_bf16 v27, v199, v199
    v_dot2c_f32_bf16 v26, v200, v25
    v_dot2c_f32_bf16 v27, v200, v200
    v_dot2c_f32_bf16 v26, v201, v25
    v_dot2c_f32_bf16 v27, v201, v201
    v_dot2c_f32_bf16 v26, v202, v25
    v_dot2c_f32_bf16 v27, v202, v202
    v_dot2c_f32_bf16 v26, v203, v25
    v_dot2c_f32_bf16 v27, v203, v203
    v_dot2c_f32_bf16 v26, v204, v25
    v_dot2c_f32_bf16 v27, v204, v204
    v_dot2c_f32_bf16 v26, v205, v25
    v_dot2c_f32_bf16 v27, v205, v205
    v_dot2c_f32_bf16 v26, v206, v25
    v_dot2c_f32_bf16 v27, v206, v206
    v_dot2c_f32_bf16 v26, v207, v25
    v_dot2c_f32_bf16 v27, v207, v207
    v_dot2c_f32_bf16 v26, v208, v25
    v_dot2c_f32_bf16 v27, v208, v208
    v_dot2c_f32_bf16 v26, v209, v25
    v_dot2c_f32_bf16 v27, v209, v209
    v_dot2c_f32_bf16 v26, v210, v25
    v_dot2c_f32_bf16 v27, v210, v210
    v_dot2c_f32_bf16 v26, v211, v25
    v_dot2c_f32_bf16 v27, v211, v211
    v_dot2c_f32_bf16 v26, v212, v25
    v_dot2c_f32_bf16 v27, v212, v212
    v_dot2c_f32_bf16 v26, v213, v25
    v_dot2c_f32_bf16 v27, v213, v213
    v_dot2c_f32_bf16 v26, v214, v25
    v_dot2c_f32_bf16 v27, v214, v214
    v_dot2c_f32_bf16 v26, v215, v25
    v_dot2c_f32_bf16 v27, v215, v215
    v_mov_b32 v246, v28
    v_mov_b32 v247, v29
    s_nop 0
    v_permlane32_swap_b32 v28, v246
    v_permlane32_swap_b32 v29, v247
    v_add_f32 v28, v28, v246
    v_add_f32 v29, v29, v247
    ds_write_b64 v243, v[28:29]
    v_mfma_f32_32x32x16_bf16 v[32:47], v[208:211], v[96:99], v[32:47]
    v_mov_b32 v246, v26
    v_mov_b32 v247, v27
    s_nop 0
    v_permlane32_swap_b32 v26, v246
    v_permlane32_swap_b32 v27, v247
    v_add_f32 v26, v26, v246
    v_add_f32 v27, v27, v247
    v_mul_f32 v247, 0x3b124925, v26
    v_mul_f32 v246, v247, v247
    v_mov_b32 v248, 0x3b124925
    v_fma_f32 v246, v27, v248, -v246
    v_max_f32 v246, 0, v246
    v_add_f32 v246, 0x3727c5ac, v246
    v_rsq_f32 v248, v246
    v_mfma_f32_32x32x16_bf16 v[48:63], v[208:211], v[100:103], v[48:63]
    s_waitcnt lgkmcnt(0)
    s_barrier
    ds_read_b64 v[64:65], v242 offset:0
    ds_read_b64 v[66:67], v242 offset:256
    ds_read_b64 v[68:69], v242 offset:512
    ds_read_b64 v[70:71], v242 offset:768
    v_mfma_f32_32x32x16_bf16 v[32:47], v[212:215], v[80:83], v[32:47]
    v_cmp_gt_u32 vcc, 32, v1
    v_sub_f32 v247, 0, v247
    s_nop 0
    v_cndmask_b32 v247, 0, v247, vcc
    v_and_b32 v26, 0xffff0000, v247
    v_sub_f32 v27, v247, v26
    v_cvt_pk_bf16_f32 v216, v26, v26
    v_cvt_pk_bf16_f32 v217, v27, 0
    v_mfma_f32_32x32x16_bf16 v[48:63], v[212:215], v[84:87], v[48:63]
    v_cndmask_b32 v246, 0, v248, vcc
    v_and_b32 v26, 0xffff0000, v246
    v_sub_f32 v27, v246, v26
    v_cvt_pk_bf16_f32 v220, v26, v27
    s_nop 1
    v_mfma_f32_32x32x16_bf16 v[88:103], v[220:223], v[236:239], 0
    s_waitcnt lgkmcnt(0)
    v_add_f32 v64, v64, v66
    v_add_f32 v68, v68, v70
    v_add_f32 v64, v64, v68
    v_and_b32 v26, 0xffff0000, v64
    v_sub_f32 v27, v64, v26
    v_cvt_pk_bf16_f32 v224, v26, v27
    v_lshrrev_b32 v225, 16, v64
    s_nop 1
    v_mfma_f32_32x32x16_bf16 v[32:47], v[216:219], v[224:227], v[32:47]
    v_add_f32 v65, v65, v67
    v_add_f32 v69, v69, v71
    v_add_f32 v65, v65, v69
    v_and_b32 v26, 0xffff0000, v65
    v_sub_f32 v27, v65, v26
    v_cvt_pk_bf16_f32 v228, v26, v27
    v_lshrrev_b32 v229, 16, v65
    s_nop 1
    v_mfma_f32_32x32x16_bf16 v[48:63], v[216:219], v[228:231], v[48:63]
    buffer_store_dwordx4 v[236:239], v244, s[12:15], s58 offen sc1
    s_nop 0
    v_pk_mul_f32 v[32:33], v[32:33], v[88:89]
    v_cvt_pk_bf16_f32 v32, v32, v33
    v_pk_mul_f32 v[34:35], v[34:35], v[90:91]
    v_cvt_pk_bf16_f32 v33, v34, v35
    v_pk_mul_f32 v[36:37], v[36:37], v[92:93]
    v_cvt_pk_bf16_f32 v34, v36, v37
    v_pk_mul_f32 v[38:39], v[38:39], v[94:95]
    v_cvt_pk_bf16_f32 v35, v38, v39
    buffer_store_dwordx4 v[32:35], v240, s[12:15], s57 offen offset:0 sc1
    v_pk_mul_f32 v[40:41], v[40:41], v[96:97]
    v_cvt_pk_bf16_f32 v36, v40, v41
    v_pk_mul_f32 v[42:43], v[42:43], v[98:99]
    v_cvt_pk_bf16_f32 v37, v42, v43
    v_pk_mul_f32 v[44:45], v[44:45], v[100:101]
    v_cvt_pk_bf16_f32 v38, v44, v45
    v_pk_mul_f32 v[46:47], v[46:47], v[102:103]
    v_cvt_pk_bf16_f32 v39, v46, v47
    buffer_store_dwordx4 v[36:39], v241, s[12:15], s57 offen offset:0 sc1
    v_pk_mul_f32 v[48:49], v[48:49], v[88:89]
    v_cvt_pk_bf16_f32 v48, v48, v49
    v_pk_mul_f32 v[50:51], v[50:51], v[90:91]
    v_cvt_pk_bf16_f32 v49, v50, v51
    v_pk_mul_f32 v[52:53], v[52:53], v[92:93]
    v_cvt_pk_bf16_f32 v50, v52, v53
    v_pk_mul_f32 v[54:55], v[54:55], v[94:95]
    v_cvt_pk_bf16_f32 v51, v54, v55
    buffer_store_dwordx4 v[48:51], v240, s[12:15], s57 offen offset:512 sc1
    v_pk_mul_f32 v[56:57], v[56:57], v[96:97]
    v_cvt_pk_bf16_f32 v52, v56, v57
    v_pk_mul_f32 v[58:59], v[58:59], v[98:99]
    v_cvt_pk_bf16_f32 v53, v58, v59
    v_pk_mul_f32 v[60:61], v[60:61], v[100:101]
    v_cvt_pk_bf16_f32 v54, v60, v61
    v_pk_mul_f32 v[62:63], v[62:63], v[102:103]
    v_cvt_pk_bf16_f32 v55, v62, v63
    buffer_store_dwordx4 v[52:55], v241, s[12:15], s57 offen offset:512 sc1
    s_branch L_q
L_light:
    s_mov_b32 s14, 23068672
    s_mov_b32 s15, 0x00020000
    s_lshr_b32 s55, s18, 3
    s_lshl1_add_u32 s55, s17, s55
    s_lshl_b32 s77, s55, 12
    s_add_u32 s77, s77, 20971520
    v_lshlrev_b32 v70, 4, v0
    v_mov_b32 v216, 0
    v_mov_b32 v217, 0
    v_mov_b32 v218, 0
    v_mov_b32 v219, 0
    buffer_store_dwordx4 v[216:219], v70, s[12:15], s77 offen sc1
    s_min_u32 s77, s2, 223
    s_mul_i32 s77, s77, 5376
    v_lshrrev_b32 v70, 7, v0
    v_mul_u32_u24 v70, 2688, v70
    v_bfe_u32 v71, v0, 4, 3
    v_min_u32 v71, 6, v71
    v_lshl_add_u32 v70, v71, 7, v70
    v_add_u32 v70, s77, v70
    global_load_dword v31, v70, s[8:9]
    s_lshl4_add_u32 s77, s17, s18
    s_lshl2_add_u32 s77, s77, s16
    s_mul_i32 s77, s77, 1792
    v_min_u32 v70, 4, v66
    v_lshlrev_b32 v70, 7, v70
    v_and_b32 v71, 1, v64
    v_mul_u32_u24 v71, 896, v71
    v_add_u32 v70, v70, v71
    s_mul_i32 s78, s79, 13440
    s_lshl_b32 s57, s30, 7
    s_add_u32 s78, s78, s57
    s_add_u32 s78, s78, 344960
    v_min_u32 v71, 4, v64
    v_mul_u32_u24 v71, 2688, v71
    s_mov_b64 exec, 0xffff
    buffer_load_dword v31, v70, s[4:7], s77 offen offset:256
    s_mov_b64 exec, -1
    buffer_load_dword v31, v71, s[8:11], s78 offen
    s_min_u32 s77, s76, 10
    s_lshl_b32 s77, s77, 3
    s_load_dwordx2 s[82:83], s[0:1], s77
    s_sub_u32 s31, s76, 10
    s_mul_i32 s31, s31, 1036800
    s_add_u32 s31, s31, 57472
    s_cmp_lt_u32 s76, 10
    s_cselect_b32 s31, 0x80, s31
    s_load_dwordx2 s[40:41], s[0:1], 16
    s_load_dwordx2 s[42:43], s[0:1], 48
    s_load_dwordx2 s[60:61], s[0:1], 32
    s_load_dwordx2 s[100:101], s[0:1], 72
    s_mov_b32 s14, 23068672
    s_mov_b32 s15, 0x00020000
    v_mov_b32 v219, 0
    v_mov_b32 v70, s31
    s_waitcnt lgkmcnt(0)
    global_load_dword v31, v70, s[82:83]
    s_waitcnt lgkmcnt(0)
    s_lshl2_add_u32 s76, s55, s16
    s_mul_i32 s77, s76, 147
    s_lshr_b32 s77, s77, 10
    s_mul_i32 s78, s77, 7
    s_sub_u32 s78, s76, s78
    s_mul_i32 s56, s78, 294912
    s_lshl_b32 s76, s77, 14
    s_add_u32 s56, s56, s76
    s_add_u32 s56, s56, 18874368
    s_cmp_lt_u32 s77, 18
    s_cselect_b32 s56, s56, 23068672
    s_sub_u32 s76, s77, 14
    s_mov_b32 s34, 401408
    s_mov_b32 s35, 0x00020000
    s_mov_b32 s49, 25088
    s_cmp_lt_u32 s77, 14
    s_cselect_b32 s76, s77, s76
    s_cselect_b32 s32, s42, s40
    s_cselect_b32 s33, s43, s41
    s_cselect_b32 s34, 1605632, s34
    s_cselect_b32 s49, 28672, s49
    s_mul_i32 s55, s76, s49
    s_lshl_b32 s78, s78, 7
    s_lshl2_add_u32 s55, s55, s78
    s_lshl_b32 s26, s16, 14
    v_lshl_add_u32 v32, v69, 4, v68
    v_add_u32 v33, 6144, v32
    v_add_u32 v34, 12288, v32
    v_add_u32 v35, 18432, v32
    s_add_u32 m0, s26, 0
    s_nop 0
    buffer_load_dwordx4 v32, s[32:35], s55 offen offset:0 lds
    buffer_load_dwordx4 v33, s[32:35], s55 offen offset:1024 lds
    buffer_load_dwordx4 v34, s[32:35], s55 offen offset:2048 lds
    buffer_load_dwordx4 v35, s[32:35], s55 offen offset:3072 lds
    s_add_u32 m0, s26, 4096
    s_add_u32 s55, s55, s49
    buffer_load_dwordx4 v32, s[32:35], s55 offen offset:0 lds
    buffer_load_dwordx4 v33, s[32:35], s55 offen offset:1024 lds
    buffer_load_dwordx4 v34, s[32:35], s55 offen offset:2048 lds
    buffer_load_dwordx4 v35, s[32:35], s55 offen offset:3072 lds
    v_and_b32 v73, 31, v1
    v_lshrrev_b32 v71, 1, v73
    v_lshrrev_b32 v72, 5, v1
    v_xor_b32 v71, v71, v72
    v_and_b32 v71, 7, v71
    v_lshlrev_b32 v71, 4, v71
    v_lshl_add_u32 v71, v73, 7, v71
    v_add_u32 v71, s52, v71
    s_lshl_b32 s77, s16, 5
    v_xor_b32 v9, s77, v71
    v_xor_b32 v10, 32, v9
    v_xor_b32 v11, 64, v9
    v_xor_b32 v12, 0x60, v9
    v_bfe_u32 v76, v1, 2, 2
    v_lshl_add_u32 v74, v72, 3, v76
    v_and_b32 v75, 16, v1
    v_lshlrev_b32 v75, 1, v75
    v_and_b32 v71, 1, v1
    v_lshl_add_u32 v75, v71, 4, v75
    v_bfe_u32 v71, v1, 1, 1
    v_lshl_add_u32 v75, v71, 3, v75
    v_lshl_add_u32 v13, v74, 7, v75
    v_bfe_u32 v71, v1, 3, 1
    v_lshl_add_u32 v13, v71, 6, v13
    v_add_u32 v13, s53, v13
    v_xor_b32 v14, 64, v13
    v_xor_b32 v15, 2048, v13
    v_xor_b32 v16, 2112, v13
    v_xor_b32 v17, 4096, v13
    v_xor_b32 v18, 4160, v13
    v_xor_b32 v19, 6144, v13
    v_xor_b32 v20, 6208, v13
    v_mov_b32 v25, 0x3f803f80
    v_mov_b32 v26, 0
    v_mov_b32 v27, 0
    v_mov_b32 v28, 0
    v_mov_b32 v29, 0
    s_mov_b32 s36, s8
    s_mov_b32 s37, s9
    s_mov_b32 s38, 1204224
    s_mov_b32 s39, 0x00020000
    s_and_b32 s28, s18, 1
    s_lshr_b32 s77, s18, 1
    s_mul_i32 s77, s77, 7
    s_mul_i32 s78, s28, 3
    s_add_u32 s78, s78, s77
    s_lshl4_add_u32 s77, s78, s54
    s_lshr_b32 s54, s53, 1
    s_add_u32 s54, s54, 114688
    v_lshrrev_b32 v70, 2, v1
    v_mul_u32_u24 v71, 2688, v70
    v_and_b32 v77, 3, v1
    v_lshl_add_u32 v8, v77, 4, v71
    v_add_u32 v8, s77, v8
    v_and_b32 v64, 0x33, v73
    v_and_b32 v71, 4, v73
    v_lshl_or_b32 v64, v71, 1, v64
    v_lshrrev_b32 v71, 1, v73
    v_and_or_b32 v64, v71, 4, v64
    v_lshlrev_b32 v254, 4, v1
    v_lshlrev_b32 v71, 4, v64
    v_lshl_add_u32 v71, v72, 9, v71
    s_lshl_b32 s77, s78, 9
    v_add_u32 v71, s77, v71
    v_accvgpr_write_b32 a0, v71
    s_mul_i32 s77, s18, 28
    s_add_u32 s77, s77, 448
    s_lshl_b32 s76, s78, 3
    v_mov_b32 v66, s76
    v_mov_b32 v67, s77
    v_cmp_gt_u32 vcc, 2, v77
    s_nop 1
    v_cndmask_b32 v66, v67, v66, vcc
    v_cndmask_b32 v67, 27, 31, vcc
    v_and_b32 v71, 1, v1
    v_mad_u32_u24 v66, v71, v67, v66
    v_lshrrev_b32 v66, 6, v66
    v_lshlrev_b32 v66, 7, v66
    v_accvgpr_write_b32 a1, v66
    v_mul_u32_u24 v71, 7168, v72
    v_lshl_add_u32 v240, v64, 4, v71
    v_add_u32 v241, 14336, v240
    s_mul_i32 s77, s18, 448
    s_add_u32 s77, s77, 28672
    v_add_u32 v66, s77, v240
    v_add_u32 v67, s77, v241
    v_mov_b32 v78, 23068672
    v_mov_b32 v71, 57344
    v_cmp_eq_u32 vcc, 28, v73
    s_nop 1
    v_cndmask_b32 v71, v78, v71, vcc
    v_cmp_gt_u32 vcc, 28, v73
    s_nop 1
    v_cndmask_b32 v66, v71, v66, vcc
    v_cndmask_b32 v67, v71, v67, vcc
    v_accvgpr_write_b32 a2, v66
    v_accvgpr_write_b32 a3, v67
    v_lshlrev_b32 v242, 3, v73
    v_add_u32 v242, 143360, v242
    s_lshl_b32 s77, s16, 8
    v_add_u32 v243, s77, v242
    s_mul_i32 s58, s79, 57600
    s_lshl_b32 s57, s30, 12
    s_lshl_b32 s77, s30, 10
    s_add_u32 s77, s77, 21504
    s_cmp_lt_u32 s30, 7
    s_cselect_b32 s57, s57, s77
    s_add_u32 s57, s57, s58
    s_add_u32 s58, s58, 57344
    s_cmp_ge_u32 s30, 7
    s_cselect_b32 s58, s58, 23068672
    v_min_u32 v244, 0x70, v254
    s_lshl_b32 s3, s79, 5
    s_add_u32 s3, s3, s18
    s_lshl_b32 s3, s3, 10
    s_add_u32 s3, s3, 6291456
    v_lshl_add_u32 v21, v74, 6, v75
    v_add_u32 v21, s54, v21
    v_xor_b32 v22, 1024, v21
    v_xor_b32 v23, 2048, v21
    v_xor_b32 v24, 3072, v21
    v_mov_b32 v30, 0
    v_mov_b32 v218, 0
    v_mov_b32 v221, 0
    v_mov_b32 v222, 0
    v_mov_b32 v223, 0
    v_mov_b32 v226, 0
    v_mov_b32 v227, 0
    v_mov_b32 v230, 0
    v_mov_b32 v231, 0
    v_mov_b32 v234, 0
    v_mov_b32 v235, 0
    v_mov_b32 v236, v25
    v_mov_b32 v237, v25
    v_mov_b32 v238, v25
    v_mov_b32 v239, v25
    s_bfe_u32 s20, s2, 0x40003
    s_lshr_b32 s19, s2, 7
    s_lshl1_add_u32 s19, s51, s19
    s_lshl_b32 s25, s19, 12
    s_add_u32 s25, s25, 20971520
    s_getreg_b32 s76, hwreg(HW_REG_XCC_ID, 0, 4)
    s_lshl_b32 s77, s76, 2
    s_lshl_b32 s29, 14, s77
    s_lshl_b32 s77, 1, s77
    s_cmp_lt_u32 s76, 8
    s_cselect_b32 s77, s77, 0
    s_cmp_lt_u32 s20, 14
    s_cselect_b32 s77, s77, 0
    v_lshlrev_b32 v79, 7, v1
    s_lshl_b32 s78, s17, 7
    s_add_u32 s78, s78, 21053440
    s_lshl_b32 s76, s30, 7
    s_add_u32 s76, s76, 21037056
    s_cmp_lt_u32 s30, 14
    s_cselect_b32 s76, s76, s78
    v_lshl_add_u32 v255, v79, 4, s76
    s_add_u32 s78, s25, 3072
    v_writelane_b32 v255, s78, 8
    s_cmp_eq_u32 s16, 0
    s_cselect_b32 s76, 9, 0
    v_cmp_gt_u32 vcc, s76, v1
    s_nop 1
    v_cndmask_b32 v255, v78, v255, vcc
    v_mov_b32 v253, 1
    v_writelane_b32 v253, s77, 8
    s_and_b32 s21, s20, 1
    s_lshr_b32 s22, s20, 1
    s_lshl1_add_u32 s23, s19, s21
    s_lshr_b32 s76, s16, 1
    s_and_b32 s77, s22, 1
    s_xor_b32 s76, s76, s77
    s_lshl1_add_u32 s23, s23, s76
    s_and_b32 s76, s16, 1
    s_lshl1_add_u32 s24, s22, s76
    s_lshl_b32 s65, s23, 12
    s_lshr_b32 s77, s22, 1
    s_lshl_b32 s77, s77, 9
    s_add_u32 s65, s65, s77
    s_add_u32 s65, s65, 10354688
    s_mul_i32 s27, s23, 28672
    s_lshl_b32 s77, s24, 11
    s_add_u32 s64, s27, s77
    s_add_u32 s64, s64, 8388608
    s_mul_i32 s77, s76, 14336
    s_add_u32 s27, s27, s77
    s_lshl_b32 s76, s22, 7
    s_add_u32 s27, s27, s76
    v_and_b32 v66, 15, v1
    v_mul_u32_u24 v67, 896, v66
    v_lshlrev_b32 v71, 4, v65
    v_add_u32 v67, v67, v71
    v_lshlrev_b32 v66, 4, v66
    v_lshl_add_u32 v66, v72, 8, v66
    v_and_b32 v246, 16, v1
    v_lshl_add_u32 v66, v246, 10, v66
    v_accvgpr_write_b32 a4, v66
    s_waitcnt vmcnt(12)
    s_barrier
    s_cmp_lg_u32 s16, 0
    s_cbranch_scc1 L_light2
    v_mov_b32 v38, 1
    s_mov_b64 exec, 1
    global_atomic_add v219, v38, s[100:101] sc1
    s_mov_b64 exec, -1
L_light2:
    s_add_u32 m0, s26, 8192
    s_add_u32 s55, s55, s49
    buffer_load_dwordx4 v32, s[32:35], s55 offen offset:0 lds
    buffer_load_dwordx4 v33, s[32:35], s55 offen offset:1024 lds
    buffer_load_dwordx4 v34, s[32:35], s55 offen offset:2048 lds
    buffer_load_dwordx4 v35, s[32:35], s55 offen offset:3072 lds
    s_add_u32 m0, s26, 12288
    s_add_u32 s55, s55, s49
    buffer_load_dwordx4 v32, s[32:35], s55 offen offset:0 lds
    buffer_load_dwordx4 v33, s[32:35], s55 offen offset:1024 lds
    buffer_load_dwordx4 v34, s[32:35], s55 offen offset:2048 lds
    buffer_load_dwordx4 v35, s[32:35], s55 offen offset:3072 lds
    s_add_u32 m0, s52, 0
    s_nop 0
    buffer_load_dwordx4 v2, s[4:7], s48 offen offset:0 lds
    buffer_load_dwordx4 v3, s[4:7], s48 offen offset:1024 lds
    buffer_load_dwordx4 v4, s[4:7], s48 offen offset:2048 lds
    buffer_load_dwordx4 v5, s[4:7], s48 offen offset:3072 lds
    v_add_u32 v71, s76, v71
    s_lshl_b32 s76, s20, 8
    s_lshl_b32 s77, s16, 6
    s_add_u32 s77, s77, s76
    v_lshl_add_u32 v66, v64, 1, s76
    v_accvgpr_write_b32 a5, v67
    v_accvgpr_write_b32 a6, v71
    v_accvgpr_write_b32 a7, v66
    s_mov_b32 s31, s77
    s_lshl2_add_u32 s77, s2, s16
    s_mul_i32 s77, s77, 1664
    s_min_u32 s77, s77, 1603968
    v_min_u32 v249, 12, v70
    v_lshlrev_b32 v249, 7, v249
    v_accvgpr_write_b32 a8, v249
    s_add_u32 s82, s60, s77
    s_addc_u32 s83, s61, 0
    s_mul_i32 s77, s16, 57344
    s_add_u32 s77, s77, s76
    s_add_u32 s60, s60, s77
    s_addc_u32 s61, s61, 0
    s_lshl_b32 s59, s16, 12
    v_cmp_gt_u32 vcc, 32, v1
    s_cmp_eq_u32 s28, 0
    s_cselect_b32 s76, -1, 0
    v_cndmask_b32 v66, 0, -1, vcc
    v_not_b32 v67, v66
    v_or_b32 v67, s76, v67
    s_not_b32 s76, s76
    v_or_b32 v71, s76, v66
    v_accvgpr_write_b32 a9, v66
    v_accvgpr_write_b32 a10, v67
    v_accvgpr_write_b32 a11, v71
    s_add_u32 s76, s53, 147456
    v_add_u32 v66, s76, v254
    v_accvgpr_write_b32 a12, v66
    s_xor_b32 s76, s16, 3
    s_mul_i32 s76, s76, 12288
    s_add_u32 s76, s76, 114688
    v_add_u32 v66, s76, v254
    v_accvgpr_write_b32 a13, v66
    s_xor_b32 s76, s16, 2
    s_mul_i32 s76, s76, 12288
    s_add_u32 s76, s76, 114688
    v_add_u32 v66, s76, v254
    v_accvgpr_write_b32 a14, v66
    s_xor_b32 s76, s16, 1
    s_mul_i32 s76, s76, 12288
    s_add_u32 s76, s76, 114688
    v_add_u32 v66, s76, v254
    v_accvgpr_write_b32 a15, v66
    s_xor_b32 s76, s16, 0
    s_mul_i32 s76, s76, 12288
    s_add_u32 s76, s76, 114688
    v_add_u32 v66, s76, v254
    v_accvgpr_write_b32 a16, v66
    v_lshlrev_b32 v66, 2, v65
    v_and_b32 v67, 15, v1
    v_xor_b32 v66, v66, v67
    v_mul_u32_u24 v67, 3584, v65
    v_lshl_add_u32 v66, v66, 4, v67
    v_accvgpr_write_b32 a17, v66
    v_lshl_add_u32 v66, v74, 8, v75
    v_xor_b32 v67, s16, v76
    v_lshl_add_u32 v66, v67, 6, v66
    v_accvgpr_write_b32 a18, v66
    v_add_u32 v66, s64, v79
    s_and_b32 s76, s65, 0xffffff80
    s_sub_u32 s76, s76, 2048
    v_add_u32 v67, s76, v79
    v_cmp_gt_u32 vcc, 16, v1
    s_nop 1
    v_cndmask_b32 v66, v67, v66, vcc
    v_cmp_gt_u32 vcc, 20, v1
    s_nop 1
    v_cndmask_b32 v66, v78, v66, vcc
    s_lshl_b32 s51, s51, 11
    s_add_u32 s76, s51, 21047296
    v_add_u32 v67, s76, v79
    v_cmp_gt_u32 vcc, 48, v1
    s_nop 1
    v_cndmask_b32 v66, v67, v66, vcc
    v_writelane_b32 v66, s78, 20
    s_add_u32 s51, s51, 21037056
    s_bfe_u32 s76, s2, 0x20003
    s_lshl2_add_u32 s76, s76, s16
    s_lshl_b32 s76, s76, 11
    v_and_b32 v67, 0x780, v79
    v_add_u32 v71, s76, v67
    v_min_u32 v71, L_fallback-L_pc1, v71
    v_accvgpr_write_b32 a19, v66
    v_accvgpr_write_b32 a20, v71
    v_mul_u32_u24 v66, 53248, v72
    v_add_u32 v66, v66, v79
    v_accvgpr_write_b32 a21, v66
    s_lshl_b32 s76, s17, 12
    s_add_u32 s76, s76, 20971520
    s_cmp_eq_u32 s16, 0
    s_cselect_b32 s76, s76, 23068672
    v_writelane_b32 v78, s76, 0
    v_mul_u32_u24 v66, 12288, v77
    v_add_u32 v66, 114688, v66
    v_lshlrev_b32 v67, 2, v73
    v_sub_u32 v67, v67, v254
    v_accvgpr_write_b32 a22, v78
    v_accvgpr_write_b32 a23, v66
    v_accvgpr_write_b32 a24, v67
    s_and_b32 s76, s17, 1
    s_lshl1_add_u32 s76, s16, s76
    s_mul_i32 s46, s76, 460800
    s_xor_b32 s76, s76, 1
    s_mul_i32 s47, s76, 460800
    s_mul_i32 s44, s22, 294912
    s_add_u32 s44, s44, 18874368
    s_cmp_lt_u32 s20, 14
    s_cselect_b32 s44, s44, 23068672
    s_mul_i32 s45, s16, 57344
    s_add_u32 s45, s45, s44
    s_lshl2_add_u32 s44, s59, s44
    s_add_u32 s44, s44, 229376
    s_and_b32 s76, s16, 1
    s_lshl1_add_u32 s63, s23, s76
    s_lshl_b32 s62, s63, 14
    s_add_u32 s62, s59, s62
    s_add_u32 s62, s62, 6291456
    s_mul_i32 s77, s76, 1792
    s_sub_u32 s64, s64, s77
    s_lshl_b32 s77, s76, 8
    s_add_u32 s65, s65, s77
    s_and_b32 s77, s22, 1
    s_lshl3_add_u32 s65, s77, s65
    s_lshl_b32 s66, s16, 7
    s_add_u32 s66, s66, s25
    s_lshl2_add_u32 s76, s19, s16
    s_mul_i32 s67, s76, 28672
    s_add_u32 s67, s67, 8388608
    s_lshl_b32 s68, s76, 12
    s_add_u32 s68, s68, 10354688
    s_mul_i32 s28, s76, 114688
    s_lshl_b32 s77, s20, 12
    s_add_u32 s28, s28, s77
    s_add_u32 s28, s28, 10747904
    s_and_b32 s74, s53, 2048
    s_lshl2_add_u32 s72, s74, s45
    s_lshl_b32 s77, s74, 2
    s_sub_u32 s73, s45, s77
    s_lshl_b32 s69, s21, 8
    s_add_u32 s69, s69, s25
    s_mul_i32 s75, s16, 14336
    s_add_u32 s75, s75, 10747904
    v_lshl_add_u32 v36, v65, 3, v76
    v_lshlrev_b32 v36, 7, v36
    v_lshl_add_u32 v36, v77, 4, v36
    v_bfe_u32 v37, v1, 3, 1
    v_lshl_add_u32 v36, v37, 6, v36
    v_add_u32 v36, s26, v36
    v_xor_b32 v37, 64, v36
    s_add_u32 m0, s52, 4096
    s_sub_u32 s48, 128, s48
    buffer_load_dwordx4 v2, s[4:7], s48 offen offset:0 lds
    buffer_load_dwordx4 v3, s[4:7], s48 offen offset:1024 lds
    buffer_load_dwordx4 v4, s[4:7], s48 offen offset:2048 lds
    buffer_load_dwordx4 v5, s[4:7], s48 offen offset:3072 lds
    s_waitcnt vmcnt(4)
    ds_read_b128 v[104:107], v9 offset:0
    ds_read_b128 v[108:111], v10 offset:0
    ds_read_b128 v[112:115], v11 offset:0
    ds_read_b128 v[116:119], v12 offset:0
    s_add_u32 m0, s52, 8192
    s_mov_b32 s48, 256
    buffer_load_dwordx4 v2, s[4:7], s48 offen offset:0 lds
    buffer_load_dwordx4 v3, s[4:7], s48 offen offset:1024 lds
    buffer_load_dwordx4 v4, s[4:7], s48 offen offset:2048 lds
    buffer_load_dwordx4 v5, s[4:7], s48 offen offset:3072 lds
    s_waitcnt lgkmcnt(0)
    ds_read_b64_tr_b16 a[64:65], v36 offset:0
    ds_read_b64_tr_b16 a[66:67], v36 offset:512
    ds_read_b64_tr_b16 a[68:69], v36 offset:8
    ds_read_b64_tr_b16 a[70:71], v36 offset:520
    ds_read_b64_tr_b16 a[72:73], v37 offset:0
    ds_read_b64_tr_b16 a[74:75], v37 offset:512
    ds_read_b64_tr_b16 a[76:77], v37 offset:8
    ds_read_b64_tr_b16 a[78:79], v37 offset:520
    v_dot2c_f32_bf16 v26, v104, v25
    v_dot2c_f32_bf16 v27, v104, v104
    v_dot2c_f32_bf16 v26, v105, v25
    v_dot2c_f32_bf16 v27, v105, v105
    v_dot2c_f32_bf16 v26, v106, v25
    v_dot2c_f32_bf16 v27, v106, v106
    v_dot2c_f32_bf16 v26, v107, v25
    v_dot2c_f32_bf16 v27, v107, v107
    v_dot2c_f32_bf16 v26, v108, v25
    v_dot2c_f32_bf16 v27, v108, v108
    v_dot2c_f32_bf16 v26, v109, v25
    v_dot2c_f32_bf16 v27, v109, v109
    v_dot2c_f32_bf16 v26, v110, v25
    v_dot2c_f32_bf16 v27, v110, v110
    v_dot2c_f32_bf16 v26, v111, v25
    v_dot2c_f32_bf16 v27, v111, v111
    v_dot2c_f32_bf16 v26, v112, v25
    v_dot2c_f32_bf16 v27, v112, v112
    v_dot2c_f32_bf16 v26, v113, v25
    v_dot2c_f32_bf16 v27, v113, v113
    v_dot2c_f32_bf16 v26, v114, v25
    v_dot2c_f32_bf16 v27, v114, v114
    v_dot2c_f32_bf16 v26, v115, v25
    v_dot2c_f32_bf16 v27, v115, v115
    v_dot2c_f32_bf16 v26, v116, v25
    v_dot2c_f32_bf16 v27, v116, v116
    v_dot2c_f32_bf16 v26, v117, v25
    v_dot2c_f32_bf16 v27, v117, v117
    v_dot2c_f32_bf16 v26, v118, v25
    v_dot2c_f32_bf16 v27, v118, v118
    v_dot2c_f32_bf16 v26, v119, v25
    v_dot2c_f32_bf16 v27, v119, v119
    s_waitcnt vmcnt(4)
    ds_read_b128 v[120:123], v9 offset:4096
    ds_read_b128 v[124:127], v10 offset:4096
    ds_read_b128 v[128:131], v11 offset:4096
    ds_read_b128 v[132:135], v12 offset:4096
    s_add_u32 m0, s52, 0
    s_add_u32 s48, s48, 128
    buffer_load_dwordx4 v2, s[4:7], s48 offen offset:0 lds
    buffer_load_dwordx4 v3, s[4:7], s48 offen offset:1024 lds
    buffer_load_dwordx4 v4, s[4:7], s48 offen offset:2048 lds
    buffer_load_dwordx4 v5, s[4:7], s48 offen offset:3072 lds
    s_waitcnt lgkmcnt(0)
    ds_read_b64_tr_b16 a[80:81], v36 offset:4096
    ds_read_b64_tr_b16 a[82:83], v36 offset:4608
    ds_read_b64_tr_b16 a[84:85], v36 offset:4104
    ds_read_b64_tr_b16 a[86:87], v36 offset:4616
    ds_read_b64_tr_b16 a[88:89], v37 offset:4096
    ds_read_b64_tr_b16 a[90:91], v37 offset:4608
    ds_read_b64_tr_b16 a[92:93], v37 offset:4104
    ds_read_b64_tr_b16 a[94:95], v37 offset:4616
    v_dot2c_f32_bf16 v26, v120, v25
    v_dot2c_f32_bf16 v27, v120, v120
    v_dot2c_f32_bf16 v26, v121, v25
    v_dot2c_f32_bf16 v27, v121, v121
    v_dot2c_f32_bf16 v26, v122, v25
    v_dot2c_f32_bf16 v27, v122, v122
    v_dot2c_f32_bf16 v26, v123, v25
    v_dot2c_f32_bf16 v27, v123, v123
    v_dot2c_f32_bf16 v26, v124, v25
    v_dot2c_f32_bf16 v27, v124, v124
    v_dot2c_f32_bf16 v26, v125, v25
    v_dot2c_f32_bf16 v27, v125, v125
    v_dot2c_f32_bf16 v26, v126, v25
    v_dot2c_f32_bf16 v27, v126, v126
    v_dot2c_f32_bf16 v26, v127, v25
    v_dot2c_f32_bf16 v27, v127, v127
    v_dot2c_f32_bf16 v26, v128, v25
    v_dot2c_f32_bf16 v27, v128, v128
    v_dot2c_f32_bf16 v26, v129, v25
    v_dot2c_f32_bf16 v27, v129, v129
    v_dot2c_f32_bf16 v26, v130, v25
    v_dot2c_f32_bf16 v27, v130, v130
    v_dot2c_f32_bf16 v26, v131, v25
    v_dot2c_f32_bf16 v27, v131, v131
    v_dot2c_f32_bf16 v26, v132, v25
    v_dot2c_f32_bf16 v27, v132, v132
    v_dot2c_f32_bf16 v26, v133, v25
    v_dot2c_f32_bf16 v27, v133, v133
    v_dot2c_f32_bf16 v26, v134, v25
    v_dot2c_f32_bf16 v27, v134, v134
    v_dot2c_f32_bf16 v26, v135, v25
    v_dot2c_f32_bf16 v27, v135, v135
    s_waitcnt vmcnt(4)
    ds_read_b128 v[136:139], v9 offset:8192
    ds_read_b128 v[140:143], v10 offset:8192
    ds_read_b128 v[144:147], v11 offset:8192
    ds_read_b128 v[148:151], v12 offset:8192
    s_add_u32 m0, s52, 4096
    s_add_u32 s48, s48, 128
    buffer_load_dwordx4 v2, s[4:7], s48 offen offset:0 lds
    buffer_load_dwordx4 v3, s[4:7], s48 offen offset:1024 lds
    buffer_load_dwordx4 v4, s[4:7], s48 offen offset:2048 lds
    buffer_load_dwordx4 v5, s[4:7], s48 offen offset:3072 lds
    s_waitcnt lgkmcnt(0)
    ds_read_b64_tr_b16 a[96:97], v36 offset:8192
    ds_read_b64_tr_b16 a[98:99], v36 offset:8704
    ds_read_b64_tr_b16 a[100:101], v36 offset:8200
    ds_read_b64_tr_b16 a[102:103], v36 offset:8712
    ds_read_b64_tr_b16 a[104:105], v37 offset:8192
    ds_read_b64_tr_b16 a[106:107], v37 offset:8704
    ds_read_b64_tr_b16 a[108:109], v37 offset:8200
    ds_read_b64_tr_b16 a[110:111], v37 offset:8712
    v_dot2c_f32_bf16 v26, v136, v25
    v_dot2c_f32_bf16 v27, v136, v136
    v_dot2c_f32_bf16 v26, v137, v25
    v_dot2c_f32_bf16 v27, v137, v137
    v_dot2c_f32_bf16 v26, v138, v25
    v_dot2c_f32_bf16 v27, v138, v138
    v_dot2c_f32_bf16 v26, v139, v25
    v_dot2c_f32_bf16 v27, v139, v139
    v_dot2c_f32_bf16 v26, v140, v25
    v_dot2c_f32_bf16 v27, v140, v140
    v_dot2c_f32_bf16 v26, v141, v25
    v_dot2c_f32_bf16 v27, v141, v141
    v_dot2c_f32_bf16 v26, v142, v25
    v_dot2c_f32_bf16 v27, v142, v142
    v_dot2c_f32_bf16 v26, v143, v25
    v_dot2c_f32_bf16 v27, v143, v143
    v_dot2c_f32_bf16 v26, v144, v25
    v_dot2c_f32_bf16 v27, v144, v144
    v_dot2c_f32_bf16 v26, v145, v25
    v_dot2c_f32_bf16 v27, v145, v145
    v_dot2c_f32_bf16 v26, v146, v25
    v_dot2c_f32_bf16 v27, v146, v146
    v_dot2c_f32_bf16 v26, v147, v25
    v_dot2c_f32_bf16 v27, v147, v147
    v_dot2c_f32_bf16 v26, v148, v25
    v_dot2c_f32_bf16 v27, v148, v148
    v_dot2c_f32_bf16 v26, v149, v25
    v_dot2c_f32_bf16 v27, v149, v149
    v_dot2c_f32_bf16 v26, v150, v25
    v_dot2c_f32_bf16 v27, v150, v150
    v_dot2c_f32_bf16 v26, v151, v25
    v_dot2c_f32_bf16 v27, v151, v151
    s_waitcnt vmcnt(4)
    ds_read_b128 v[152:155], v9 offset:0
    ds_read_b128 v[156:159], v10 offset:0
    ds_read_b128 v[160:163], v11 offset:0
    ds_read_b128 v[164:167], v12 offset:0
    s_add_u32 m0, s52, 8192
    s_add_u32 s48, s48, 128
    buffer_load_dwordx4 v2, s[4:7], s48 offen offset:0 lds
    buffer_load_dwordx4 v3, s[4:7], s48 offen offset:1024 lds
    buffer_load_dwordx4 v4, s[4:7], s48 offen offset:2048 lds
    buffer_load_dwordx4 v5, s[4:7], s48 offen offset:3072 lds
    s_waitcnt lgkmcnt(0)
    ds_read_b64_tr_b16 a[112:113], v36 offset:12288
    ds_read_b64_tr_b16 a[114:115], v36 offset:12800
    ds_read_b64_tr_b16 a[116:117], v36 offset:12296
    ds_read_b64_tr_b16 a[118:119], v36 offset:12808
    ds_read_b64_tr_b16 a[120:121], v37 offset:12288
    ds_read_b64_tr_b16 a[122:123], v37 offset:12800
    ds_read_b64_tr_b16 a[124:125], v37 offset:12296
    ds_read_b64_tr_b16 a[126:127], v37 offset:12808
    v_dot2c_f32_bf16 v26, v152, v25
    v_dot2c_f32_bf16 v27, v152, v152
    v_dot2c_f32_bf16 v26, v153, v25
    v_dot2c_f32_bf16 v27, v153, v153
    v_dot2c_f32_bf16 v26, v154, v25
    v_dot2c_f32_bf16 v27, v154, v154
    v_dot2c_f32_bf16 v26, v155, v25
    v_dot2c_f32_bf16 v27, v155, v155
    v_dot2c_f32_bf16 v26, v156, v25
    v_dot2c_f32_bf16 v27, v156, v156
    v_dot2c_f32_bf16 v26, v157, v25
    v_dot2c_f32_bf16 v27, v157, v157
    v_dot2c_f32_bf16 v26, v158, v25
    v_dot2c_f32_bf16 v27, v158, v158
    v_dot2c_f32_bf16 v26, v159, v25
    v_dot2c_f32_bf16 v27, v159, v159
    v_dot2c_f32_bf16 v26, v160, v25
    v_dot2c_f32_bf16 v27, v160, v160
    v_dot2c_f32_bf16 v26, v161, v25
    v_dot2c_f32_bf16 v27, v161, v161
    v_dot2c_f32_bf16 v26, v162, v25
    v_dot2c_f32_bf16 v27, v162, v162
    v_dot2c_f32_bf16 v26, v163, v25
    v_dot2c_f32_bf16 v27, v163, v163
    v_dot2c_f32_bf16 v26, v164, v25
    v_dot2c_f32_bf16 v27, v164, v164
    v_dot2c_f32_bf16 v26, v165, v25
    v_dot2c_f32_bf16 v27, v165, v165
    v_dot2c_f32_bf16 v26, v166, v25
    v_dot2c_f32_bf16 v27, v166, v166
    v_dot2c_f32_bf16 v26, v167, v25
    v_dot2c_f32_bf16 v27, v167, v167
    s_waitcnt vmcnt(4)
    ds_read_b128 v[168:171], v9 offset:4096
    ds_read_b128 v[172:175], v10 offset:4096
    ds_read_b128 v[176:179], v11 offset:4096
    ds_read_b128 v[180:183], v12 offset:4096
    s_add_u32 m0, s52, 0
    s_add_u32 s48, s48, 128
    buffer_load_dwordx4 v2, s[4:7], s48 offen offset:0 lds
    buffer_load_dwordx4 v3, s[4:7], s48 offen offset:1024 lds
    buffer_load_dwordx4 v4, s[4:7], s48 offen offset:2048 lds
    buffer_load_dwordx4 v5, s[4:7], s48 offen offset:3072 lds
    s_waitcnt lgkmcnt(0)
    v_dot2c_f32_bf16 v26, v168, v25
    v_dot2c_f32_bf16 v27, v168, v168
    v_dot2c_f32_bf16 v26, v169, v25
    v_dot2c_f32_bf16 v27, v169, v169
    v_dot2c_f32_bf16 v26, v170, v25
    v_dot2c_f32_bf16 v27, v170, v170
    v_dot2c_f32_bf16 v26, v171, v25
    v_dot2c_f32_bf16 v27, v171, v171
    v_dot2c_f32_bf16 v26, v172, v25
    v_dot2c_f32_bf16 v27, v172, v172
    v_dot2c_f32_bf16 v26, v173, v25
    v_dot2c_f32_bf16 v27, v173, v173
    v_dot2c_f32_bf16 v26, v174, v25
    v_dot2c_f32_bf16 v27, v174, v174
    v_dot2c_f32_bf16 v26, v175, v25
    v_dot2c_f32_bf16 v27, v175, v175
    v_dot2c_f32_bf16 v26, v176, v25
    v_dot2c_f32_bf16 v27, v176, v176
    v_dot2c_f32_bf16 v26, v177, v25
    v_dot2c_f32_bf16 v27, v177, v177
    v_dot2c_f32_bf16 v26, v178, v25
    v_dot2c_f32_bf16 v27, v178, v178
    v_dot2c_f32_bf16 v26, v179, v25
    v_dot2c_f32_bf16 v27, v179, v179
    v_dot2c_f32_bf16 v26, v180, v25
    v_dot2c_f32_bf16 v27, v180, v180
    v_dot2c_f32_bf16 v26, v181, v25
    v_dot2c_f32_bf16 v27, v181, v181
    v_dot2c_f32_bf16 v26, v182, v25
    v_dot2c_f32_bf16 v27, v182, v182
    v_dot2c_f32_bf16 v26, v183, v25
    v_dot2c_f32_bf16 v27, v183, v183
    s_waitcnt vmcnt(4)
    ds_read_b128 v[184:187], v9 offset:8192
    ds_read_b128 v[188:191], v10 offset:8192
    ds_read_b128 v[192:195], v11 offset:8192
    ds_read_b128 v[196:199], v12 offset:8192
    s_add_u32 m0, s54, 0
    s_nop 0
    buffer_load_dwordx4 v8, s[36:39], s50 offen lds
    s_add_u32 m0, s54, 4096
    s_sub_u32 s50, 172032, s50
    buffer_load_dwordx4 v8, s[36:39], s50 offen lds
    s_add_u32 m0, s54, 8192
    s_mov_b32 s50, 344064
    buffer_load_dwordx4 v8, s[36:39], s50 offen lds
    s_add_u32 m0, s54, 12288
    s_add_u32 s50, s50, 172032
    buffer_load_dwordx4 v8, s[36:39], s50 offen lds
    s_add_u32 m0, s54, 16384
    s_add_u32 s50, s50, 172032
    buffer_load_dwordx4 v8, s[36:39], s50 offen lds
    s_add_u32 m0, s54, 20480
    s_add_u32 s50, s50, 172032
    buffer_load_dwordx4 v8, s[36:39], s50 offen lds
    s_add_u32 m0, s54, 24576
    s_add_u32 s50, s50, 172032
    buffer_load_dwordx4 v8, s[36:39], s50 offen lds
    global_load_dword v245, v219, s[100:101] sc1
    s_waitcnt lgkmcnt(0)
    v_dot2c_f32_bf16 v26, v184, v25
    v_dot2c_f32_bf16 v27, v184, v184
    v_dot2c_f32_bf16 v26, v185, v25
    v_dot2c_f32_bf16 v27, v185, v185
    v_dot2c_f32_bf16 v26, v186, v25
    v_dot2c_f32_bf16 v27, v186, v186
    v_dot2c_f32_bf16 v26, v187, v25
    v_dot2c_f32_bf16 v27, v187, v187
    v_dot2c_f32_bf16 v26, v188, v25
    v_dot2c_f32_bf16 v27, v188, v188
    v_dot2c_f32_bf16 v26, v189, v25
    v_dot2c_f32_bf16 v27, v189, v189
    v_dot2c_f32_bf16 v26, v190, v25
    v_dot2c_f32_bf16 v27, v190, v190
    v_dot2c_f32_bf16 v26, v191, v25
    v_dot2c_f32_bf16 v27, v191, v191
    v_dot2c_f32_bf16 v26, v192, v25
    v_dot2c_f32_bf16 v27, v192, v192
    v_dot2c_f32_bf16 v26, v193, v25
    v_dot2c_f32_bf16 v27, v193, v193
    v_dot2c_f32_bf16 v26, v194, v25
    v_dot2c_f32_bf16 v27, v194, v194
    v_dot2c_f32_bf16 v26, v195, v25
    v_dot2c_f32_bf16 v27, v195, v195
    v_dot2c_f32_bf16 v26, v196, v25
    v_dot2c_f32_bf16 v27, v196, v196
    v_dot2c_f32_bf16 v26, v197, v25
    v_dot2c_f32_bf16 v27, v197, v197
    v_dot2c_f32_bf16 v26, v198, v25
    v_dot2c_f32_bf16 v27, v198, v198
    v_dot2c_f32_bf16 v26, v199, v25
    v_dot2c_f32_bf16 v27, v199, v199
    s_waitcnt vmcnt(8)
    ds_read_b128 v[200:203], v9 offset:0
    ds_read_b128 v[204:207], v10 offset:0
    ds_read_b128 v[208:211], v11 offset:0
    ds_read_b128 v[212:215], v12 offset:0
    s_waitcnt lgkmcnt(0)
    v_dot2c_f32_bf16 v26, v200, v25
    v_dot2c_f32_bf16 v27, v200, v200
    v_dot2c_f32_bf16 v26, v201, v25
    v_dot2c_f32_bf16 v27, v201, v201
    v_dot2c_f32_bf16 v26, v202, v25
    v_dot2c_f32_bf16 v27, v202, v202
    v_dot2c_f32_bf16 v26, v203, v25
    v_dot2c_f32_bf16 v27, v203, v203
    v_dot2c_f32_bf16 v26, v204, v25
    v_dot2c_f32_bf16 v27, v204, v204
    v_dot2c_f32_bf16 v26, v205, v25
    v_dot2c_f32_bf16 v27, v205, v205
    v_dot2c_f32_bf16 v26, v206, v25
    v_dot2c_f32_bf16 v27, v206, v206
    v_dot2c_f32_bf16 v26, v207, v25
    v_dot2c_f32_bf16 v27, v207, v207
    v_dot2c_f32_bf16 v26, v208, v25
    v_dot2c_f32_bf16 v27, v208, v208
    v_dot2c_f32_bf16 v26, v209, v25
    v_dot2c_f32_bf16 v27, v209, v209
    v_dot2c_f32_bf16 v26, v210, v25
    v_dot2c_f32_bf16 v27, v210, v210
    v_dot2c_f32_bf16 v26, v211, v25
    v_dot2c_f32_bf16 v27, v211, v211
    v_dot2c_f32_bf16 v26, v212, v25
    v_dot2c_f32_bf16 v27, v212, v212
    v_dot2c_f32_bf16 v26, v213, v25
    v_dot2c_f32_bf16 v27, v213, v213
    v_dot2c_f32_bf16 v26, v214, v25
    v_dot2c_f32_bf16 v27, v214, v214
    v_dot2c_f32_bf16 v26, v215, v25
    v_dot2c_f32_bf16 v27, v215, v215
    s_nop 1
    v_mov_b32 v246, v26
    v_mov_b32 v247, v27
    s_nop 0
    v_permlane32_swap_b32 v26, v246
    v_permlane32_swap_b32 v27, v247
    v_add_f32 v26, v26, v246
    v_add_f32 v27, v27, v247
    v_mul_f32 v247, 0x3b124925, v26
    v_mul_f32 v246, v247, v247
    v_mov_b32 v248, 0x3b124925
    v_fma_f32 v246, v27, v248, -v246
    v_max_f32 v246, 0, v246
    v_add_f32 v246, 0x3727c5ac, v246
    v_rsq_f32 v248, v246
    v_cmp_gt_u32 vcc, 32, v1
    v_sub_f32 v247, 0, v247
    s_nop 0
    v_cndmask_b32 v247, 0, v247, vcc
    v_and_b32 v26, 0xffff0000, v247
    v_sub_f32 v27, v247, v26
    v_cvt_pk_bf16_f32 v216, v26, v26
    v_cvt_pk_bf16_f32 v217, v27, 0
    s_add_u32 m0, s56, 0
    s_nop 0
    buffer_store_dwordx4 a[64:67], v254, s[12:15], m0 offen offset:0 sc1
    buffer_store_dwordx4 a[68:71], v254, s[12:15], m0 offen offset:1024 sc1
    buffer_store_dwordx4 a[72:75], v254, s[12:15], m0 offen offset:2048 sc1
    buffer_store_dwordx4 a[76:79], v254, s[12:15], m0 offen offset:3072 sc1
    s_waitcnt vmcnt(4)
    v_cmp_gt_u32 vcc, 32, v245
    s_cbranch_vccnz L_rlp
L_rld:
    s_barrier
    ds_read_b64_tr_b16 v[76:77], v21 offset:0
    ds_read_b64_tr_b16 v[78:79], v21 offset:256
    ds_read_b64_tr_b16 v[80:81], v21 offset:4096
    ds_read_b64_tr_b16 v[82:83], v21 offset:4352
    ds_read_b64_tr_b16 v[84:85], v21 offset:8192
    ds_read_b64_tr_b16 v[86:87], v21 offset:8448
    ds_read_b64_tr_b16 v[88:89], v21 offset:12288
    ds_read_b64_tr_b16 v[90:91], v21 offset:12544
    ds_read_b64_tr_b16 v[92:93], v21 offset:16384
    ds_read_b64_tr_b16 v[94:95], v21 offset:16640
    ds_read_b64_tr_b16 v[96:97], v21 offset:20480
    ds_read_b64_tr_b16 v[98:99], v21 offset:20736
    ds_read_b64_tr_b16 v[100:101], v21 offset:24576
    ds_read_b64_tr_b16 v[102:103], v21 offset:24832
    s_waitcnt lgkmcnt(6)
    ds_read_b64_tr_b16 v[32:33], v21 offset:0
    ds_read_b64_tr_b16 v[34:35], v21 offset:256
    ds_read_b64_tr_b16 v[36:37], v22 offset:0
    ds_read_b64_tr_b16 v[38:39], v22 offset:256
    ds_read_b64_tr_b16 v[40:41], v23 offset:0
    ds_read_b64_tr_b16 v[42:43], v23 offset:256
    ds_read_b64_tr_b16 v[44:45], v24 offset:0
    ds_read_b64_tr_b16 v[46:47], v24 offset:256
    v_dot2c_f32_bf16 v30, v76, v25
    v_dot2c_f32_bf16 v30, v77, v25
    v_dot2c_f32_bf16 v30, v78, v25
    v_dot2c_f32_bf16 v30, v79, v25
    v_dot2c_f32_bf16 v30, v80, v25
    v_dot2c_f32_bf16 v30, v81, v25
    v_dot2c_f32_bf16 v30, v82, v25
    v_dot2c_f32_bf16 v30, v83, v25
    v_dot2c_f32_bf16 v30, v84, v25
    v_dot2c_f32_bf16 v30, v85, v25
    v_dot2c_f32_bf16 v30, v86, v25
    v_dot2c_f32_bf16 v30, v87, v25
    v_dot2c_f32_bf16 v30, v88, v25
    v_dot2c_f32_bf16 v30, v89, v25
    v_dot2c_f32_bf16 v30, v90, v25
    v_dot2c_f32_bf16 v30, v91, v25
    s_waitcnt lgkmcnt(8)
    v_dot2c_f32_bf16 v30, v92, v25
    v_dot2c_f32_bf16 v30, v93, v25
    v_dot2c_f32_bf16 v30, v94, v25
    v_dot2c_f32_bf16 v30, v95, v25
    v_dot2c_f32_bf16 v30, v96, v25
    v_dot2c_f32_bf16 v30, v97, v25
    v_dot2c_f32_bf16 v30, v98, v25
    v_dot2c_f32_bf16 v30, v99, v25
    v_dot2c_f32_bf16 v30, v100, v25
    v_dot2c_f32_bf16 v30, v101, v25
    v_dot2c_f32_bf16 v30, v102, v25
    v_dot2c_f32_bf16 v30, v103, v25
    s_nop 2
    v_mov_b32 v246, v30
    s_nop 1
    v_permlane32_swap_b32 v30, v246
    v_add_f32 v30, v30, v246
    ds_write_b32 v243, v30
    s_waitcnt lgkmcnt(6)
    v_mfma_f32_32x32x16_bf16 v[64:79], v[32:35], v[104:107], 0
    s_add_u32 m0, s56, 4096
    s_nop 0
    buffer_store_dwordx4 a[80:83], v254, s[12:15], m0 offen offset:0 sc1
    ds_read_b64_tr_b16 v[48:49], v21 offset:4096
    ds_read_b64_tr_b16 v[50:51], v21 offset:4352
    v_mul_f32 v26, 0x3e8b97f6, v248
    v_mov_b32 v2, v254
    v_accvgpr_read_b32 v3, a0
    s_waitcnt lgkmcnt(6)
    v_mfma_f32_32x32x16_bf16 v[64:79], v[36:39], v[108:111], v[64:79]
    ds_read_b64_tr_b16 v[52:53], v22 offset:4096
    ds_read_b64_tr_b16 v[54:55], v22 offset:4352
    v_accvgpr_read_b32 v4, a2
    v_accvgpr_read_b32 v248, a3
    v_accvgpr_read_b32 v0, a5
    s_waitcnt lgkmcnt(6)
    v_mfma_f32_32x32x16_bf16 v[64:79], v[40:43], v[112:115], v[64:79]
    buffer_store_dwordx4 a[84:87], v254, s[12:15], m0 offen offset:1024 sc1
    ds_read_b64_tr_b16 v[56:57], v23 offset:4096
    ds_read_b64_tr_b16 v[58:59], v23 offset:4352
    v_accvgpr_read_b32 v6, a9
    v_accvgpr_read_b32 v13, a10
    v_accvgpr_read_b32 v5, a11
    s_waitcnt lgkmcnt(6)
    v_mfma_f32_32x32x16_bf16 v[64:79], v[44:47], v[116:119], v[64:79]
    ds_read_b64_tr_b16 v[60:61], v24 offset:4096
    ds_read_b64_tr_b16 v[62:63], v24 offset:4352
    v_accvgpr_read_b32 v15, a12
    v_accvgpr_read_b32 v9, a13
    v_accvgpr_read_b32 v10, a14
    s_waitcnt lgkmcnt(6)
    v_mfma_f32_32x32x16_bf16 v[64:79], v[48:51], v[120:123], v[64:79]
    buffer_store_dwordx4 a[88:91], v254, s[12:15], m0 offen offset:2048 sc1
    ds_read_b64_tr_b16 v[32:33], v21 offset:8192
    ds_read_b64_tr_b16 v[34:35], v21 offset:8448
    v_accvgpr_read_b32 v11, a15
    v_accvgpr_read_b32 v12, a16
    v_accvgpr_read_b32 v241, a19
    s_waitcnt lgkmcnt(6)
    v_mfma_f32_32x32x16_bf16 v[64:79], v[52:55], v[124:127], v[64:79]
    ds_read_b64_tr_b16 v[36:37], v22 offset:8192
    ds_read_b64_tr_b16 v[38:39], v22 offset:8448
    v_accvgpr_read_b32 v240, a21
    v_xor_b32 v249, 6144, v15
    v_xor_b32 v250, 4096, v15
    s_waitcnt lgkmcnt(6)
    v_mfma_f32_32x32x16_bf16 v[64:79], v[56:59], v[128:131], v[64:79]
    buffer_store_dwordx4 a[92:95], v254, s[12:15], m0 offen offset:3072 sc1
    ds_read_b64_tr_b16 v[40:41], v23 offset:8192
    ds_read_b64_tr_b16 v[42:43], v23 offset:8448
    v_xor_b32 v251, 2048, v15
    v_mov_b32 v220, 0
    v_mov_b32 v7, 0xdddd
    s_waitcnt lgkmcnt(6)
    v_mfma_f32_32x32x16_bf16 v[64:79], v[60:63], v[132:135], v[64:79]
    ds_read_b64_tr_b16 v[44:45], v24 offset:8192
    ds_read_b64_tr_b16 v[46:47], v24 offset:8448
    s_mov_b32 s30, 0
    s_mov_b32 s34, 3584
    s_mov_b32 s35, 0x00020000
    s_barrier
    ds_read_b32 v96, v242 offset:0
    ds_read_b32 v97, v242 offset:256
    ds_read_b32 v98, v242 offset:512
    ds_read_b32 v99, v242 offset:768
    s_waitcnt lgkmcnt(6)
    v_mfma_f32_32x32x16_bf16 v[64:79], v[32:35], v[136:139], v[64:79]
    s_add_u32 m0, s56, 8192
    s_nop 0
    buffer_store_dwordx4 a[96:99], v254, s[12:15], m0 offen offset:0 sc1
    ds_read_b64_tr_b16 v[48:49], v21 offset:12288
    ds_read_b64_tr_b16 v[50:51], v21 offset:12544
    s_mov_b32 s38, 896
    s_mov_b32 s42, 1835008
    s_mov_b32 s43, 0x00020000
    s_waitcnt lgkmcnt(6)
    v_mfma_f32_32x32x16_bf16 v[64:79], v[36:39], v[140:143], v[64:79]
    ds_read_b64_tr_b16 v[52:53], v22 offset:12288
    ds_read_b64_tr_b16 v[54:55], v22 offset:12544
    s_mov_b32 s8, s60
    s_mov_b32 s9, s61
    s_cmp_lt_u32 s20, 14
    s_cselect_b32 s10, 57344, 0
    s_waitcnt lgkmcnt(6)
    v_mfma_f32_32x32x16_bf16 v[64:79], v[40:43], v[144:147], v[64:79]
    buffer_store_dwordx4 a[100:103], v254, s[12:15], m0 offen offset:1024 sc1
    ds_read_b64_tr_b16 v[56:57], v23 offset:12288
    ds_read_b64_tr_b16 v[58:59], v23 offset:12544
    s_waitcnt lgkmcnt(6)
    v_mfma_f32_32x32x16_bf16 v[64:79], v[44:47], v[148:151], v[64:79]
    ds_read_b64_tr_b16 v[60:61], v24 offset:12288
    ds_read_b64_tr_b16 v[62:63], v24 offset:12544
    s_waitcnt lgkmcnt(6)
    v_mfma_f32_32x32x16_bf16 v[64:79], v[48:51], v[152:155], v[64:79]
    buffer_store_dwordx4 a[104:107], v254, s[12:15], m0 offen offset:2048 sc1
    ds_read_b64_tr_b16 v[32:33], v21 offset:16384
    ds_read_b64_tr_b16 v[34:35], v21 offset:16640
    s_waitcnt lgkmcnt(6)
    v_mfma_f32_32x32x16_bf16 v[64:79], v[52:55], v[156:159], v[64:79]
    ds_read_b64_tr_b16 v[36:37], v22 offset:16384
    ds_read_b64_tr_b16 v[38:39], v22 offset:16640
    s_waitcnt lgkmcnt(6)
    v_mfma_f32_32x32x16_bf16 v[64:79], v[56:59], v[160:163], v[64:79]
    buffer_store_dwordx4 a[108:111], v254, s[12:15], m0 offen offset:3072 sc1
    ds_read_b64_tr_b16 v[40:41], v23 offset:16384
    ds_read_b64_tr_b16 v[42:43], v23 offset:16640
    s_waitcnt lgkmcnt(6)
    v_mfma_f32_32x32x16_bf16 v[64:79], v[60:63], v[164:167], v[64:79]
    ds_read_b64_tr_b16 v[44:45], v24 offset:16384
    ds_read_b64_tr_b16 v[46:47], v24 offset:16640
    s_waitcnt lgkmcnt(6)
    v_mfma_f32_32x32x16_bf16 v[64:79], v[32:35], v[168:171], v[64:79]
    s_add_u32 m0, s56, 12288
    s_nop 0
    buffer_store_dwordx4 a[112:115], v254, s[12:15], m0 offen offset:0 sc1
    ds_read_b64_tr_b16 v[48:49], v21 offset:20480
    ds_read_b64_tr_b16 v[50:51], v21 offset:20736
    v_add_f32 v96, v96, v97
    v_add_f32 v98, v98, v99
    v_add_f32 v30, v96, v98
    s_waitcnt lgkmcnt(6)
    v_mfma_f32_32x32x16_bf16 v[64:79], v[36:39], v[172:175], v[64:79]
    ds_read_b64_tr_b16 v[52:53], v22 offset:20480
    ds_read_b64_tr_b16 v[54:55], v22 offset:20736
    v_and_b32 v28, 0xffff0000, v30
    v_sub_f32 v29, v30, v28
    v_cvt_pk_bf16_f32 v232, v28, v29
    s_waitcnt lgkmcnt(6)
    v_mfma_f32_32x32x16_bf16 v[64:79], v[40:43], v[176:179], v[64:79]
    buffer_store_dwordx4 a[116:119], v254, s[12:15], m0 offen offset:1024 sc1
    ds_read_b64_tr_b16 v[56:57], v23 offset:20480
    ds_read_b64_tr_b16 v[58:59], v23 offset:20736
    v_lshrrev_b32 v233, 16, v30
    s_waitcnt lgkmcnt(6)
    v_mfma_f32_32x32x16_bf16 v[64:79], v[44:47], v[180:183], v[64:79]
    ds_read_b64_tr_b16 v[60:61], v24 offset:20480
    ds_read_b64_tr_b16 v[62:63], v24 offset:20736
    s_waitcnt lgkmcnt(6)
    v_mfma_f32_32x32x16_bf16 v[64:79], v[48:51], v[184:187], v[64:79]
    buffer_store_dwordx4 a[120:123], v254, s[12:15], m0 offen offset:2048 sc1
    ds_read_b64_tr_b16 v[32:33], v21 offset:24576
    ds_read_b64_tr_b16 v[34:35], v21 offset:24832
    v_accvgpr_read_b32 v169, a1
    v_accvgpr_read_b32 v172, a4
    v_accvgpr_read_b32 v160, a6
    s_waitcnt lgkmcnt(6)
    v_mfma_f32_32x32x16_bf16 v[64:79], v[52:55], v[188:191], v[64:79]
    ds_read_b64_tr_b16 v[36:37], v22 offset:24576
    ds_read_b64_tr_b16 v[38:39], v22 offset:24832
    v_accvgpr_read_b32 v161, a7
    v_accvgpr_read_b32 v177, a8
    v_accvgpr_read_b32 v165, a17
    s_waitcnt lgkmcnt(6)
    v_mfma_f32_32x32x16_bf16 v[64:79], v[56:59], v[192:195], v[64:79]
    buffer_store_dwordx4 a[124:127], v254, s[12:15], m0 offen offset:3072 sc1
    ds_read_b64_tr_b16 v[40:41], v23 offset:24576
    ds_read_b64_tr_b16 v[42:43], v23 offset:24832
    v_accvgpr_read_b32 v173, a18
    v_accvgpr_read_b32 v170, a20
    v_accvgpr_read_b32 v174, a22
    s_waitcnt lgkmcnt(6)
    v_mfma_f32_32x32x16_bf16 v[64:79], v[60:63], v[196:199], v[64:79]
    ds_read_b64_tr_b16 v[44:45], v24 offset:24576
    ds_read_b64_tr_b16 v[46:47], v24 offset:24832
    v_accvgpr_read_b32 v175, a23
    v_accvgpr_read_b32 v176, a24
    v_add_u32 v166, 13312, v165
    s_waitcnt lgkmcnt(6)
    v_mfma_f32_32x32x16_bf16 v[64:79], v[32:35], v[200:203], v[64:79]
    v_add_u32 v167, 26624, v165
    v_add_u32 v168, 39936, v165
    s_waitcnt lgkmcnt(4)
    v_mfma_f32_32x32x16_bf16 v[64:79], v[36:39], v[204:207], v[64:79]
    s_waitcnt lgkmcnt(2)
    v_mfma_f32_32x32x16_bf16 v[64:79], v[40:43], v[208:211], v[64:79]
    s_waitcnt lgkmcnt(0)
    v_mfma_f32_32x32x16_bf16 v[64:79], v[44:47], v[212:215], v[64:79]
    v_mfma_f32_32x32x16_bf16 v[64:79], v[232:235], v[216:219], v[64:79]
    s_load_dwordx2 s[32:33], s[0:1], 40
    s_load_dwordx2 s[36:37], s[0:1], 56
    s_load_dwordx2 s[40:41], s[0:1], 64
    v_mfma_f32_32x32x16_bf16 v[48:63], v[220:223], v[220:223], 0
    v_mfma_f32_32x32x16_bf16 v[80:95], v[220:223], v[220:223], 0
    v_mfma_f32_32x32x16_bf16 v[96:111], v[220:223], v[220:223], 0
    s_nop 5
    v_mul_f32 v64, v26, v64
    v_mul_f32 v65, v26, v65
    v_cvt_pk_bf16_f32 v40, v64, v65
    v_mul_f32 v66, v26, v66
    v_mul_f32 v67, v26, v67
    v_cvt_pk_bf16_f32 v41, v66, v67
    v_mul_f32 v68, v26, v68
    v_mul_f32 v69, v26, v69
    v_cvt_pk_bf16_f32 v42, v68, v69
    v_mul_f32 v70, v26, v70
    v_mul_f32 v71, v26, v71
    v_cvt_pk_bf16_f32 v43, v70, v71
    v_mul_f32 v72, v26, v72
    v_mul_f32 v73, v26, v73
    v_cvt_pk_bf16_f32 v44, v72, v73
    v_mul_f32 v74, v26, v74
    v_mul_f32 v75, v26, v75
    v_cvt_pk_bf16_f32 v45, v74, v75
    v_mul_f32 v76, v26, v76
    v_mul_f32 v77, v26, v77
    v_cvt_pk_bf16_f32 v46, v76, v77
    v_mul_f32 v78, v26, v78
    v_mul_f32 v79, v26, v79
    v_cvt_pk_bf16_f32 v47, v78, v79
    v_and_b32 v40, v13, v40
    v_and_b32 v41, v13, v41
    v_and_b32 v46, v5, v46
    v_and_b32 v47, v5, v47
    ds_write_b128 v15, v[40:43]
    ds_write_b128 v15, v[44:47] offset:1024
    v_mfma_f32_32x32x16_bf16 v[64:79], v[220:223], v[220:223], 0
    s_add_u32 s76, s51, 32768
    s_mov_b32 m0, s46
    s_branch L_s1
L_kk:
    s_waitcnt vmcnt(10)
    s_barrier
    ds_read_b128 v[104:107], v9 offset:0
    ds_read_b64_tr_b16 v[80:81], v13 offset:0
    ds_read_b64_tr_b16 v[82:83], v13 offset:512
    ds_read_b64_tr_b16 v[84:85], v14 offset:0
    ds_read_b64_tr_b16 v[86:87], v14 offset:512
    ds_read_b128 v[108:111], v10 offset:0
    ds_read_b64_tr_b16 v[88:89], v15 offset:0
    ds_read_b64_tr_b16 v[90:91], v15 offset:512
    ds_read_b64_tr_b16 v[92:93], v16 offset:0
    ds_read_b64_tr_b16 v[94:95], v16 offset:512
    s_add_u32 m0, s53, 16384
    s_mov_b32 s49, 344064
    buffer_load_dwordx4 v6, s[8:11], s49 offen offset:0 lds
    buffer_load_dwordx4 v7, s[8:11], s49 offen offset:1024 lds
    s_waitcnt lgkmcnt(5)
    v_mfma_f32_32x32x16_bf16 v[32:47], v[80:83], v[104:107], 0
    s_add_u32 m0, s52, 8192
    ds_read_b128 v[112:115], v11 offset:0
    ds_read_b64_tr_b16 v[96:97], v17 offset:0
    ds_read_b64_tr_b16 v[98:99], v17 offset:512
    s_mov_b32 s48, 256
    buffer_load_dwordx4 v2, s[4:7], s48 offen offset:0 lds
    s_add_u32 s76, s76, 114688
    v_mfma_f32_32x32x16_bf16 v[48:63], v[84:87], v[104:107], 0
    ds_read_b64_tr_b16 v[100:101], v18 offset:0
    ds_read_b64_tr_b16 v[102:103], v18 offset:512
    buffer_load_dwordx4 v3, s[4:7], s48 offen offset:1024 lds
    v_add_u32 v66, s76, v254
    v_accvgpr_write_b32 a16, v66
    s_waitcnt lgkmcnt(5)
    v_mfma_f32_32x32x16_bf16 v[32:47], v[88:91], v[108:111], v[32:47]
    ds_read_b128 v[116:119], v12 offset:0
    ds_read_b64_tr_b16 v[80:81], v19 offset:0
    ds_read_b64_tr_b16 v[82:83], v19 offset:512
    buffer_load_dwordx4 v4, s[4:7], s48 offen offset:2048 lds
    v_lshlrev_b32 v66, 2, v65
    v_and_b32 v67, 15, v1
    v_mfma_f32_32x32x16_bf16 v[48:63], v[92:95], v[108:111], v[48:63]
    ds_read_b64_tr_b16 v[84:85], v20 offset:0
    ds_read_b64_tr_b16 v[86:87], v20 offset:512
    buffer_load_dwordx4 v5, s[4:7], s48 offen offset:3072 lds
    v_xor_b32 v66, v66, v67
    v_mul_u32_u24 v67, 3584, v65
    s_waitcnt lgkmcnt(5)
    v_dot2c_f32_bf16 v28, v96, v25
    v_dot2c_f32_bf16 v29, v100, v25
    v_dot2c_f32_bf16 v28, v97, v25
    v_dot2c_f32_bf16 v29, v101, v25
    v_dot2c_f32_bf16 v28, v98, v25
    v_dot2c_f32_bf16 v29, v102, v25
    v_dot2c_f32_bf16 v28, v99, v25
    v_dot2c_f32_bf16 v29, v103, v25
    v_dot2c_f32_bf16 v26, v104, v25
    v_dot2c_f32_bf16 v27, v104, v104
    v_dot2c_f32_bf16 v26, v105, v25
    v_dot2c_f32_bf16 v27, v105, v105
    v_dot2c_f32_bf16 v26, v106, v25
    v_dot2c_f32_bf16 v27, v106, v106
    v_dot2c_f32_bf16 v26, v107, v25
    v_dot2c_f32_bf16 v27, v107, v107
    v_dot2c_f32_bf16 v26, v108, v25
    v_dot2c_f32_bf16 v27, v108, v108
    v_dot2c_f32_bf16 v26, v109, v25
    v_dot2c_f32_bf16 v27, v109, v109
    v_dot2c_f32_bf16 v26, v110, v25
    v_dot2c_f32_bf16 v27, v110, v110
    v_dot2c_f32_bf16 v26, v111, v25
    v_dot2c_f32_bf16 v27, v111, v111
    v_dot2c_f32_bf16 v26, v112, v25
    v_dot2c_f32_bf16 v27, v112, v112
    v_dot2c_f32_bf16 v26, v113, v25
    v_dot2c_f32_bf16 v27, v113, v113
    v_dot2c_f32_bf16 v26, v114, v25
    v_dot2c_f32_bf16 v27, v114, v114
    v_dot2c_f32_bf16 v26, v115, v25
    v_dot2c_f32_bf16 v27, v115, v115
    s_waitcnt vmcnt(6)
    s_barrier
    v_mfma_f32_32x32x16_bf16 v[32:47], v[96:99], v[112:115], v[32:47]
    ds_read_b128 v[120:123], v9 offset:4096
    ds_read_b64_tr_b16 v[88:89], v13 offset:8192
    ds_read_b64_tr_b16 v[90:91], v13 offset:8704
    v_lshl_add_u32 v66, v66, 4, v67
    v_accvgpr_write_b32 a17, v66
    v_lshl_add_u32 v66, v74, 8, v75
    v_xor_b32 v67, s16, v76
    v_mfma_f32_32x32x16_bf16 v[48:63], v[100:103], v[112:115], v[48:63]
    s_add_u32 m0, s53, 24576
    ds_read_b64_tr_b16 v[92:93], v14 offset:8192
    ds_read_b64_tr_b16 v[94:95], v14 offset:8704
    s_add_u32 s49, s49, 172032
    buffer_load_dwordx4 v6, s[8:11], s49 offen offset:0 lds
    v_lshl_add_u32 v66, v67, 6, v66
    s_waitcnt lgkmcnt(5)
    v_mfma_f32_32x32x16_bf16 v[32:47], v[80:83], v[116:119], v[32:47]
    ds_read_b128 v[124:127], v10 offset:4096
    ds_read_b64_tr_b16 v[96:97], v15 offset:8192
    ds_read_b64_tr_b16 v[98:99], v15 offset:8704
    buffer_load_dwordx4 v7, s[8:11], s49 offen offset:1024 lds
    v_accvgpr_write_b32 a18, v66
    v_add_u32 v66, s64, v79
    v_mfma_f32_32x32x16_bf16 v[48:63], v[84:87], v[116:119], v[48:63]
    ds_read_b64_tr_b16 v[100:101], v16 offset:8192
    ds_read_b64_tr_b16 v[102:103], v16 offset:8704
    s_and_b32 s76, s65, 0xffffff80
    s_sub_u32 s76, s76, 2048
    v_add_u32 v67, s76, v79
    v_cmp_gt_u32 vcc, 16, v1
    s_waitcnt lgkmcnt(5)
    v_mfma_f32_32x32x16_bf16 v[32:47], v[88:91], v[120:123], v[32:47]
    s_add_u32 m0, s52, 0
    ds_read_b128 v[128:131], v11 offset:4096
    ds_read_b64_tr_b16 v[80:81], v17 offset:8192
    ds_read_b64_tr_b16 v[82:83], v17 offset:8704
    s_add_u32 s48, s48, 128
    buffer_load_dwordx4 v2, s[4:7], s48 offen offset:0 lds
    v_cndmask_b32 v66, v67, v66, vcc
    v_mfma_f32_32x32x16_bf16 v[48:63], v[92:95], v[120:123], v[48:63]
    ds_read_b64_tr_b16 v[84:85], v18 offset:8192
    ds_read_b64_tr_b16 v[86:87], v18 offset:8704
    buffer_load_dwordx4 v3, s[4:7], s48 offen offset:1024 lds
    v_cmp_gt_u32 vcc, 20, v1
    s_nop 1
    v_cndmask_b32 v66, v78, v66, vcc
    s_waitcnt lgkmcnt(5)
    v_mfma_f32_32x32x16_bf16 v[32:47], v[96:99], v[124:127], v[32:47]
    ds_read_b128 v[132:135], v12 offset:4096
    ds_read_b64_tr_b16 v[88:89], v19 offset:8192
    ds_read_b64_tr_b16 v[90:91], v19 offset:8704
    buffer_load_dwordx4 v4, s[4:7], s48 offen offset:2048 lds
    s_lshl_b32 s51, s51, 11
    s_add_u32 s76, s51, 21047296
    v_mfma_f32_32x32x16_bf16 v[48:63], v[100:103], v[124:127], v[48:63]
    ds_read_b64_tr_b16 v[92:93], v20 offset:8192
    ds_read_b64_tr_b16 v[94:95], v20 offset:8704
    buffer_load_dwordx4 v5, s[4:7], s48 offen offset:3072 lds
    v_add_u32 v67, s76, v79
    v_cmp_gt_u32 vcc, 48, v1
    s_waitcnt lgkmcnt(5)
    v_dot2c_f32_bf16 v28, v80, v25
    v_dot2c_f32_bf16 v29, v84, v25
    v_dot2c_f32_bf16 v28, v81, v25
    v_dot2c_f32_bf16 v29, v85, v25
    v_dot2c_f32_bf16 v28, v82, v25
    v_dot2c_f32_bf16 v29, v86, v25
    v_dot2c_f32_bf16 v28, v83, v25
    v_dot2c_f32_bf16 v29, v87, v25
    v_dot2c_f32_bf16 v26, v116, v25
    v_dot2c_f32_bf16 v27, v116, v116
    v_dot2c_f32_bf16 v26, v117, v25
    v_dot2c_f32_bf16 v27, v117, v117
    v_dot2c_f32_bf16 v26, v118, v25
    v_dot2c_f32_bf16 v27, v118, v118
    v_dot2c_f32_bf16 v26, v119, v25
    v_dot2c_f32_bf16 v27, v119, v119
    v_dot2c_f32_bf16 v26, v120, v25
    v_dot2c_f32_bf16 v27, v120, v120
    v_dot2c_f32_bf16 v26, v121, v25
    v_dot2c_f32_bf16 v27, v121, v121
    v_dot2c_f32_bf16 v26, v122, v25
    v_dot2c_f32_bf16 v27, v122, v122
    v_dot2c_f32_bf16 v26, v123, v25
    v_dot2c_f32_bf16 v27, v123, v123
    v_dot2c_f32_bf16 v26, v124, v25
    v_dot2c_f32_bf16 v27, v124, v124
    v_dot2c_f32_bf16 v26, v125, v25
    v_dot2c_f32_bf16 v27, v125, v125
    v_dot2c_f32_bf16 v26, v126, v25
    v_dot2c_f32_bf16 v27, v126, v126
    v_dot2c_f32_bf16 v26, v127, v25
    v_dot2c_f32_bf16 v27, v127, v127
    v_dot2c_f32_bf16 v26, v128, v25
    v_dot2c_f32_bf16 v27, v128, v128
    v_dot2c_f32_bf16 v26, v129, v25
    v_dot2c_f32_bf16 v27, v129, v129
    v_dot2c_f32_bf16 v26, v130, v25
    v_dot2c_f32_bf16 v27, v130, v130
    v_dot2c_f32_bf16 v26, v131, v25
    v_dot2c_f32_bf16 v27, v131, v131
    s_waitcnt vmcnt(6)
    s_barrier
    v_mfma_f32_32x32x16_bf16 v[32:47], v[80:83], v[128:131], v[32:47]
    ds_read_b128 v[136:139], v9 offset:8192
    ds_read_b64_tr_b16 v[96:97], v13 offset:16384
    ds_read_b64_tr_b16 v[98:99], v13 offset:16896
    v_cndmask_b32 v66, v67, v66, vcc
    v_writelane_b32 v66, s78, 20
    s_add_u32 s51, s51, 21037056
    s_bfe_u32 s76, s2, 0x20003
    v_mfma_f32_32x32x16_bf16 v[48:63], v[84:87], v[128:131], v[48:63]
    s_add_u32 m0, s53, 32768
    ds_read_b64_tr_b16 v[100:101], v14 offset:16384
    ds_read_b64_tr_b16 v[102:103], v14 offset:16896
    s_add_u32 s49, s49, 172032
    buffer_load_dwordx4 v6, s[8:11], s49 offen offset:0 lds
    s_lshl2_add_u32 s76, s76, s16
    s_waitcnt lgkmcnt(5)
    v_mfma_f32_32x32x16_bf16 v[32:47], v[88:91], v[132:135], v[32:47]
    ds_read_b128 v[140:143], v10 offset:8192
    ds_read_b64_tr_b16 v[80:81], v15 offset:16384
    ds_read_b64_tr_b16 v[82:83], v15 offset:16896
    buffer_load_dwordx4 v7, s[8:11], s49 offen offset:1024 lds
    s_lshl_b32 s76, s76, 11
    v_and_b32 v67, 0x780, v79
    v_mfma_f32_32x32x16_bf16 v[48:63], v[92:95], v[132:135], v[48:63]
    ds_read_b64_tr_b16 v[84:85], v16 offset:16384
    ds_read_b64_tr_b16 v[86:87], v16 offset:16896
    v_add_u32 v71, s76, v67
    v_min_u32 v71, L_fallback-L_pc1, v71
    v_accvgpr_write_b32 a19, v66
    v_accvgpr_write_b32 a20, v71
    s_add_u32 m0, s54, 0
    s_nop 0
    buffer_load_dwordx4 v8, s[36:39], s50 offen lds
    s_waitcnt lgkmcnt(5)
    v_mfma_f32_32x32x16_bf16 v[32:47], v[96:99], v[136:139], v[32:47]
    s_add_u32 m0, s52, 4096
    ds_read_b128 v[144:147], v11 offset:8192
    ds_read_b64_tr_b16 v[88:89], v17 offset:16384
    ds_read_b64_tr_b16 v[90:91], v17 offset:16896
    s_add_u32 s48, s48, 128
    buffer_load_dwordx4 v2, s[4:7], s48 offen offset:0 lds
    v_mul_u32_u24 v66, 53248, v72
    v_mfma_f32_32x32x16_bf16 v[48:63], v[100:103], v[136:139], v[48:63]
    ds_read_b64_tr_b16 v[92:93], v18 offset:16384
    ds_read_b64_tr_b16 v[94:95], v18 offset:16896
    buffer_load_dwordx4 v3, s[4:7], s48 offen offset:1024 lds
    v_add_u32 v66, v66, v79
    v_accvgpr_write_b32 a21, v66
    s_waitcnt lgkmcnt(5)
    v_mfma_f32_32x32x16_bf16 v[32:47], v[80:83], v[140:143], v[32:47]
    ds_read_b128 v[148:151], v12 offset:8192
    ds_read_b64_tr_b16 v[96:97], v19 offset:16384
    ds_read_b64_tr_b16 v[98:99], v19 offset:16896
    buffer_load_dwordx4 v4, s[4:7], s48 offen offset:2048 lds
    s_lshl_b32 s76, s17, 12
    s_add_u32 s76, s76, 20971520
    v_mfma_f32_32x32x16_bf16 v[48:63], v[84:87], v[140:143], v[48:63]
    ds_read_b64_tr_b16 v[100:101], v20 offset:16384
    ds_read_b64_tr_b16 v[102:103], v20 offset:16896
    buffer_load_dwordx4 v5, s[4:7], s48 offen offset:3072 lds
    s_cmp_eq_u32 s16, 0
    s_cselect_b32 s76, s76, 23068672
    v_writelane_b32 v78, s76, 0
    s_waitcnt lgkmcnt(5)
    v_dot2c_f32_bf16 v28, v88, v25
    v_dot2c_f32_bf16 v29, v92, v25
    v_dot2c_f32_bf16 v28, v89, v25
    v_dot2c_f32_bf16 v29, v93, v25
    v_dot2c_f32_bf16 v28, v90, v25
    v_dot2c_f32_bf16 v29, v94, v25
    v_dot2c_f32_bf16 v28, v91, v25
    v_dot2c_f32_bf16 v29, v95, v25
    v_dot2c_f32_bf16 v26, v132, v25
    v_dot2c_f32_bf16 v27, v132, v132
    v_dot2c_f32_bf16 v26, v133, v25
    v_dot2c_f32_bf16 v27, v133, v133
    v_dot2c_f32_bf16 v26, v134, v25
    v_dot2c_f32_bf16 v27, v134, v134
    v_dot2c_f32_bf16 v26, v135, v25
    v_dot2c_f32_bf16 v27, v135, v135
    v_dot2c_f32_bf16 v26, v136, v25
    v_dot2c_f32_bf16 v27, v136, v136
    v_dot2c_f32_bf16 v26, v137, v25
    v_dot2c_f32_bf16 v27, v137, v137
    v_dot2c_f32_bf16 v26, v138, v25
    v_dot2c_f32_bf16 v27, v138, v138
    v_dot2c_f32_bf16 v26, v139, v25
    v_dot2c_f32_bf16 v27, v139, v139
    v_dot2c_f32_bf16 v26, v140, v25
    v_dot2c_f32_bf16 v27, v140, v140
    v_dot2c_f32_bf16 v26, v141, v25
    v_dot2c_f32_bf16 v27, v141, v141
    v_dot2c_f32_bf16 v26, v142, v25
    v_dot2c_f32_bf16 v27, v142, v142
    v_dot2c_f32_bf16 v26, v143, v25
    v_dot2c_f32_bf16 v27, v143, v143
    v_dot2c_f32_bf16 v26, v144, v25
    v_dot2c_f32_bf16 v27, v144, v144
    v_dot2c_f32_bf16 v26, v145, v25
    v_dot2c_f32_bf16 v27, v145, v145
    v_dot2c_f32_bf16 v26, v146, v25
    v_dot2c_f32_bf16 v27, v146, v146
    v_dot2c_f32_bf16 v26, v147, v25
    v_dot2c_f32_bf16 v27, v147, v147
    s_waitcnt vmcnt(7)
    s_barrier
    v_mfma_f32_32x32x16_bf16 v[32:47], v[88:91], v[144:147], v[32:47]
    ds_read_b128 v[152:155], v9 offset:0
    ds_read_b64_tr_b16 v[80:81], v13 offset:24576
    ds_read_b64_tr_b16 v[82:83], v13 offset:25088
    v_mul_u32_u24 v66, 12288, v77
    v_add_u32 v66, 114688, v66
    v_lshlrev_b32 v67, 2, v73
    v_sub_u32 v67, v67, v254
    v_mfma_f32_32x32x16_bf16 v[48:63], v[92:95], v[144:147], v[48:63]
    s_add_u32 m0, s53, 40960
    ds_read_b64_tr_b16 v[84:85], v14 offset:24576
    ds_read_b64_tr_b16 v[86:87], v14 offset:25088
    s_add_u32 s49, s49, 172032
    buffer_load_dwordx4 v6, s[8:11], s49 offen offset:0 lds
    v_accvgpr_write_b32 a22, v78
    s_waitcnt lgkmcnt(5)
    v_mfma_f32_32x32x16_bf16 v[32:47], v[96:99], v[148:151], v[32:47]
    ds_read_b128 v[156:159], v10 offset:0
    ds_read_b64_tr_b16 v[88:89], v15 offset:24576
    ds_read_b64_tr_b16 v[90:91], v15 offset:25088
    buffer_load_dwordx4 v7, s[8:11], s49 offen offset:1024 lds
    v_accvgpr_write_b32 a23, v66
    v_accvgpr_write_b32 a24, v67
    v_mfma_f32_32x32x16_bf16 v[48:63], v[100:103], v[148:151], v[48:63]
    ds_read_b64_tr_b16 v[92:93], v16 offset:24576
    ds_read_b64_tr_b16 v[94:95], v16 offset:25088
    s_and_b32 s76, s17, 1
    s_lshl1_add_u32 s76, s16, s76
    s_mul_i32 s46, s76, 460800
    s_xor_b32 s76, s76, 1
    s_waitcnt lgkmcnt(5)
    v_mfma_f32_32x32x16_bf16 v[32:47], v[80:83], v[152:155], v[32:47]
    s_add_u32 m0, s52, 8192
    ds_read_b128 v[160:163], v11 offset:0
    ds_read_b64_tr_b16 v[96:97], v17 offset:24576
    ds_read_b64_tr_b16 v[98:99], v17 offset:25088
    s_add_u32 s48, s48, 128
    buffer_load_dwordx4 v2, s[4:7], s48 offen offset:0 lds
    s_mul_i32 s47, s76, 460800
    v_mfma_f32_32x32x16_bf16 v[48:63], v[84:87], v[152:155], v[48:63]
    ds_read_b64_tr_b16 v[100:101], v18 offset:24576
    ds_read_b64_tr_b16 v[102:103], v18 offset:25088
    buffer_load_dwordx4 v3, s[4:7], s48 offen offset:1024 lds
    s_mul_i32 s44, s22, 294912
    s_add_u32 s44, s44, 18874368
    s_waitcnt lgkmcnt(5)
    v_mfma_f32_32x32x16_bf16 v[32:47], v[88:91], v[156:159], v[32:47]
    ds_read_b128 v[164:167], v12 offset:0
    ds_read_b64_tr_b16 v[80:81], v19 offset:24576
    ds_read_b64_tr_b16 v[82:83], v19 offset:25088
    buffer_load_dwordx4 v4, s[4:7], s48 offen offset:2048 lds
    s_cmp_lt_u32 s20, 14
    s_cselect_b32 s44, s44, 23068672
    s_mul_i32 s45, s16, 57344
    v_mfma_f32_32x32x16_bf16 v[48:63], v[92:95], v[156:159], v[48:63]
    ds_read_b64_tr_b16 v[84:85], v20 offset:24576
    ds_read_b64_tr_b16 v[86:87], v20 offset:25088
    buffer_load_dwordx4 v5, s[4:7], s48 offen offset:3072 lds
    s_add_u32 s45, s45, s44
    s_lshl2_add_u32 s44, s59, s44
    s_waitcnt lgkmcnt(5)
    v_dot2c_f32_bf16 v28, v96, v25
    v_dot2c_f32_bf16 v29, v100, v25
    v_dot2c_f32_bf16 v28, v97, v25
    v_dot2c_f32_bf16 v29, v101, v25
    v_dot2c_f32_bf16 v28, v98, v25
    v_dot2c_f32_bf16 v29, v102, v25
    v_dot2c_f32_bf16 v28, v99, v25
    v_dot2c_f32_bf16 v29, v103, v25
    v_dot2c_f32_bf16 v26, v148, v25
    v_dot2c_f32_bf16 v27, v148, v148
    v_dot2c_f32_bf16 v26, v149, v25
L_w0_1:
    s_cbranch_execz L_w0_r
    v_dot2c_f32_bf16 v27, v149, v149
    v_dot2c_f32_bf16 v26, v150, v25
    v_dot2c_f32_bf16 v27, v150, v150
    v_dot2c_f32_bf16 v26, v151, v25
    v_dot2c_f32_bf16 v27, v151, v151
    v_dot2c_f32_bf16 v26, v152, v25
    v_dot2c_f32_bf16 v27, v152, v152
    v_dot2c_f32_bf16 v26, v153, v25
    v_dot2c_f32_bf16 v27, v153, v153
    v_dot2c_f32_bf16 v26, v154, v25
    v_dot2c_f32_bf16 v27, v154, v154
    v_dot2c_f32_bf16 v26, v155, v25
    v_dot2c_f32_bf16 v27, v155, v155
    v_dot2c_f32_bf16 v26, v156, v25
    v_dot2c_f32_bf16 v27, v156, v156
    v_dot2c_f32_bf16 v26, v157, v25
    v_dot2c_f32_bf16 v27, v157, v157
    v_dot2c_f32_bf16 v26, v158, v25
    v_dot2c_f32_bf16 v27, v158, v158
    v_dot2c_f32_bf16 v26, v159, v25
    v_dot2c_f32_bf16 v27, v159, v159
    v_dot2c_f32_bf16 v26, v160, v25
    v_dot2c_f32_bf16 v27, v160, v160
    v_dot2c_f32_bf16 v26, v161, v25
    v_dot2c_f32_bf16 v27, v161, v161
    v_dot2c_f32_bf16 v26, v162, v25
    v_dot2c_f32_bf16 v27, v162, v162
    v_dot2c_f32_bf16 v26, v163, v25
    v_dot2c_f32_bf16 v27, v163, v163
    s_waitcnt vmcnt(6)
    s_barrier
    v_mfma_f32_32x32x16_bf16 v[32:47], v[96:99], v[160:163], v[32:47]
    ds_read_b128 v[168:171], v9 offset:4096
    ds_read_b64_tr_b16 v[88:89], v13 offset:32768
    ds_read_b64_tr_b16 v[90:91], v13 offset:33280
    s_add_u32 s44, s44, 229376
    s_and_b32 s76, s16, 1
    s_lshl1_add_u32 s63, s23, s76
    s_lshl_b32 s62, s63, 14
    v_mfma_f32_32x32x16_bf16 v[48:63], v[100:103], v[160:163], v[48:63]
    s_add_u32 m0, s53, 49152
    ds_read_b64_tr_b16 v[92:93], v14 offset:32768
    ds_read_b64_tr_b16 v[94:95], v14 offset:33280
    s_add_u32 s49, s49, 172032
    buffer_load_dwordx4 v6, s[8:11], s49 offen offset:0 lds
    s_add_u32 s62, s59, s62
    s_waitcnt lgkmcnt(5)
    v_mfma_f32_32x32x16_bf16 v[32:47], v[80:83], v[164:167], v[32:47]
    ds_read_b128 v[172:175], v10 offset:4096
    ds_read_b64_tr_b16 v[96:97], v15 offset:32768
    ds_read_b64_tr_b16 v[98:99], v15 offset:33280
    buffer_load_dwordx4 v7, s[8:11], s49 offen offset:1024 lds
    s_add_u32 s62, s62, 6291456
    s_mul_i32 s77, s76, 1792
    v_mfma_f32_32x32x16_bf16 v[48:63], v[84:87], v[164:167], v[48:63]
    ds_read_b64_tr_b16 v[100:101], v16 offset:32768
    ds_read_b64_tr_b16 v[102:103], v16 offset:33280
    s_sub_u32 s64, s64, s77
    s_lshl_b32 s77, s76, 8
    s_add_u32 s65, s65, s77
    s_and_b32 s77, s22, 1
    s_add_u32 m0, s54, 4096
    s_sub_u32 s50, 172032, s50
    buffer_load_dwordx4 v8, s[36:39], s50 offen lds
    s_waitcnt lgkmcnt(5)
    v_mfma_f32_32x32x16_bf16 v[32:47], v[88:91], v[168:171], v[32:47]
    s_add_u32 m0, s52, 0
    ds_read_b128 v[176:179], v11 offset:4096
    ds_read_b64_tr_b16 v[80:81], v17 offset:32768
    ds_read_b64_tr_b16 v[82:83], v17 offset:33280
    s_add_u32 s48, s48, 128
    buffer_load_dwordx4 v2, s[4:7], s48 offen offset:0 lds
    s_lshl3_add_u32 s65, s77, s65
    v_mfma_f32_32x32x16_bf16 v[48:63], v[92:95], v[168:171], v[48:63]
    ds_read_b64_tr_b16 v[84:85], v18 offset:32768
    ds_read_b64_tr_b16 v[86:87], v18 offset:33280
    buffer_load_dwordx4 v3, s[4:7], s48 offen offset:1024 lds
    s_lshl_b32 s66, s16, 7
    s_add_u32 s66, s66, s25
    s_waitcnt lgkmcnt(5)
    v_mfma_f32_32x32x16_bf16 v[32:47], v[96:99], v[172:175], v[32:47]
    ds_read_b128 v[180:183], v12 offset:4096
    ds_read_b64_tr_b16 v[88:89], v19 offset:32768
    ds_read_b64_tr_b16 v[90:91], v19 offset:33280
    buffer_load_dwordx4 v4, s[4:7], s48 offen offset:2048 lds
    s_lshl2_add_u32 s76, s19, s16
    s_mul_i32 s67, s76, 28672
    v_mfma_f32_32x32x16_bf16 v[48:63], v[100:103], v[172:175], v[48:63]
    ds_read_b64_tr_b16 v[92:93], v20 offset:32768
    ds_read_b64_tr_b16 v[94:95], v20 offset:33280
    buffer_load_dwordx4 v5, s[4:7], s48 offen offset:3072 lds
    s_add_u32 s67, s67, 8388608
    s_lshl_b32 s68, s76, 12
    global_load_dword v245, v219, s[100:101] sc1
    s_waitcnt lgkmcnt(5)
    v_dot2c_f32_bf16 v28, v80, v25
    v_dot2c_f32_bf16 v29, v84, v25
    v_dot2c_f32_bf16 v28, v81, v25
    v_dot2c_f32_bf16 v29, v85, v25
    v_dot2c_f32_bf16 v28, v82, v25
    v_dot2c_f32_bf16 v29, v86, v25
    v_dot2c_f32_bf16 v28, v83, v25
    v_dot2c_f32_bf16 v29, v87, v25
    v_dot2c_f32_bf16 v26, v164, v25
    v_dot2c_f32_bf16 v27, v164, v164
    v_dot2c_f32_bf16 v26, v165, v25
    v_dot2c_f32_bf16 v27, v165, v165
    v_dot2c_f32_bf16 v26, v166, v25
    v_dot2c_f32_bf16 v27, v166, v166
    v_dot2c_f32_bf16 v26, v167, v25
    v_dot2c_f32_bf16 v27, v167, v167
    v_dot2c_f32_bf16 v26, v168, v25
    v_dot2c_f32_bf16 v27, v168, v168
    v_dot2c_f32_bf16 v26, v169, v25
    v_dot2c_f32_bf16 v27, v169, v169
    v_dot2c_f32_bf16 v26, v170, v25
    v_dot2c_f32_bf16 v27, v170, v170
    v_dot2c_f32_bf16 v26, v171, v25
    v_dot2c_f32_bf16 v27, v171, v171
    v_dot2c_f32_bf16 v26, v172, v25
    v_dot2c_f32_bf16 v27, v172, v172
    v_dot2c_f32_bf16 v26, v173, v25
    v_dot2c_f32_bf16 v27, v173, v173
    v_dot2c_f32_bf16 v26, v174, v25
    v_dot2c_f32_bf16 v27, v174, v174
    v_dot2c_f32_bf16 v26, v175, v25
    v_dot2c_f32_bf16 v27, v175, v175
    v_dot2c_f32_bf16 v26, v176, v25
    v_dot2c_f32_bf16 v27, v176, v176
    v_dot2c_f32_bf16 v26, v177, v25
    v_dot2c_f32_bf16 v27, v177, v177
    v_dot2c_f32_bf16 v26, v178, v25
    v_dot2c_f32_bf16 v27, v178, v178
    v_dot2c_f32_bf16 v26, v179, v25
    v_dot2c_f32_bf16 v27, v179, v179
    s_waitcnt vmcnt(8)
    s_barrier
    v_mfma_f32_32x32x16_bf16 v[32:47], v[80:83], v[176:179], v[32:47]
    ds_read_b128 v[184:187], v9 offset:8192
    ds_read_b64_tr_b16 v[96:97], v13 offset:40960
    ds_read_b64_tr_b16 v[98:99], v13 offset:41472
    s_add_u32 s68, s68, 10354688
    s_mul_i32 s28, s76, 114688
    s_lshl_b32 s77, s20, 12
    s_add_u32 s28, s28, s77
    v_mfma_f32_32x32x16_bf16 v[48:63], v[84:87], v[176:179], v[48:63]
    s_add_u32 m0, s54, 8192
    ds_read_b64_tr_b16 v[100:101], v14 offset:40960
    ds_read_b64_tr_b16 v[102:103], v14 offset:41472
    s_mov_b32 s50, 344064
    buffer_load_dwordx4 v8, s[36:39], s50 offen lds
    s_add_u32 s28, s28, 10747904
    s_waitcnt lgkmcnt(5)
    v_mfma_f32_32x32x16_bf16 v[32:47], v[88:91], v[180:183], v[32:47]
    ds_read_b128 v[188:191], v10 offset:8192
    ds_read_b64_tr_b16 v[80:81], v15 offset:40960
    ds_read_b64_tr_b16 v[82:83], v15 offset:41472
    s_and_b32 s74, s53, 2048
    s_lshl2_add_u32 s72, s74, s45
    s_lshl_b32 s77, s74, 2
    s_sub_u32 s73, s45, s77
    v_mfma_f32_32x32x16_bf16 v[48:63], v[92:95], v[180:183], v[48:63]
    s_add_u32 m0, s54, 12288
    ds_read_b64_tr_b16 v[84:85], v16 offset:40960
    ds_read_b64_tr_b16 v[86:87], v16 offset:41472
    s_add_u32 s50, s50, 172032
    buffer_load_dwordx4 v8, s[36:39], s50 offen lds
    s_lshl_b32 s69, s21, 8
    s_waitcnt lgkmcnt(5)
    v_mfma_f32_32x32x16_bf16 v[32:47], v[96:99], v[184:187], v[32:47]
    ds_read_b128 v[192:195], v11 offset:8192
    ds_read_b64_tr_b16 v[88:89], v17 offset:40960
    ds_read_b64_tr_b16 v[90:91], v17 offset:41472
    s_add_u32 s69, s69, s25
    s_mul_i32 s75, s16, 14336
    s_add_u32 s75, s75, 10747904
    v_mfma_f32_32x32x16_bf16 v[48:63], v[100:103], v[184:187], v[48:63]
    s_add_u32 m0, s54, 16384
    ds_read_b64_tr_b16 v[92:93], v18 offset:40960
    ds_read_b64_tr_b16 v[94:95], v18 offset:41472
    s_add_u32 s50, s50, 172032
    buffer_load_dwordx4 v8, s[36:39], s50 offen lds
    s_waitcnt lgkmcnt(5)
    v_mfma_f32_32x32x16_bf16 v[32:47], v[80:83], v[188:191], v[32:47]
    ds_read_b128 v[196:199], v12 offset:8192
    ds_read_b64_tr_b16 v[96:97], v19 offset:40960
    ds_read_b64_tr_b16 v[98:99], v19 offset:41472
    v_mfma_f32_32x32x16_bf16 v[48:63], v[84:87], v[188:191], v[48:63]
    s_add_u32 m0, s54, 20480
    ds_read_b64_tr_b16 v[100:101], v20 offset:40960
    ds_read_b64_tr_b16 v[102:103], v20 offset:41472
    s_add_u32 s50, s50, 172032
    buffer_load_dwordx4 v8, s[36:39], s50 offen lds
    s_waitcnt lgkmcnt(5)
    v_dot2c_f32_bf16 v28, v88, v25
    v_dot2c_f32_bf16 v29, v92, v25
    v_dot2c_f32_bf16 v28, v89, v25
    v_dot2c_f32_bf16 v29, v93, v25
    v_dot2c_f32_bf16 v28, v90, v25
    v_dot2c_f32_bf16 v29, v94, v25
    v_dot2c_f32_bf16 v28, v91, v25
    v_dot2c_f32_bf16 v29, v95, v25
    v_dot2c_f32_bf16 v26, v180, v25
    v_dot2c_f32_bf16 v27, v180, v180
    v_dot2c_f32_bf16 v26, v181, v25
    v_dot2c_f32_bf16 v27, v181, v181
    v_dot2c_f32_bf16 v26, v182, v25
    v_dot2c_f32_bf16 v27, v182, v182
    v_dot2c_f32_bf16 v26, v183, v25
    v_dot2c_f32_bf16 v27, v183, v183
    v_dot2c_f32_bf16 v26, v184, v25
    v_dot2c_f32_bf16 v27, v184, v184
    v_dot2c_f32_bf16 v26, v185, v25
    v_dot2c_f32_bf16 v27, v185, v185
    v_dot2c_f32_bf16 v26, v186, v25
    v_dot2c_f32_bf16 v27, v186, v186
    v_dot2c_f32_bf16 v26, v187, v25
    v_dot2c_f32_bf16 v27, v187, v187
    v_dot2c_f32_bf16 v26, v188, v25
    v_dot2c_f32_bf16 v27, v188, v188
    v_dot2c_f32_bf16 v26, v189, v25
    v_dot2c_f32_bf16 v27, v189, v189
    v_dot2c_f32_bf16 v26, v190, v25
    v_dot2c_f32_bf16 v27, v190, v190
    v_dot2c_f32_bf16 v26, v191, v25
    v_dot2c_f32_bf16 v27, v191, v191
    v_dot2c_f32_bf16 v26, v192, v25
    v_dot2c_f32_bf16 v27, v192, v192
    v_dot2c_f32_bf16 v26, v193, v25
    v_dot2c_f32_bf16 v27, v193, v193
    v_dot2c_f32_bf16 v26, v194, v25
    v_dot2c_f32_bf16 v27, v194, v194
    v_dot2c_f32_bf16 v26, v195, v25
    v_dot2c_f32_bf16 v27, v195, v195
    s_waitcnt vmcnt(5)
    s_barrier
    v_mfma_f32_32x32x16_bf16 v[32:47], v[88:91], v[192:195], v[32:47]
    ds_read_b128 v[200:203], v9 offset:0
    ds_read_b64_tr_b16 v[80:81], v13 offset:49152
    ds_read_b64_tr_b16 v[82:83], v13 offset:49664
    v_mfma_f32_32x32x16_bf16 v[48:63], v[92:95], v[192:195], v[48:63]
    s_add_u32 m0, s54, 24576
    ds_read_b64_tr_b16 v[84:85], v14 offset:49152
    ds_read_b64_tr_b16 v[86:87], v14 offset:49664
    s_add_u32 s50, s50, 172032
    buffer_load_dwordx4 v8, s[36:39], s50 offen lds
    s_waitcnt lgkmcnt(5)
    v_mfma_f32_32x32x16_bf16 v[32:47], v[96:99], v[196:199], v[32:47]
    ds_read_b128 v[204:207], v10 offset:0
    ds_read_b64_tr_b16 v[88:89], v15 offset:49152
    ds_read_b64_tr_b16 v[90:91], v15 offset:49664
    v_mfma_f32_32x32x16_bf16 v[48:63], v[100:103], v[196:199], v[48:63]
    ds_read_b64_tr_b16 v[92:93], v16 offset:49152
    ds_read_b64_tr_b16 v[94:95], v16 offset:49664
    s_waitcnt lgkmcnt(5)
    v_mfma_f32_32x32x16_bf16 v[32:47], v[80:83], v[200:203], v[32:47]
    ds_read_b128 v[208:211], v11 offset:0
    ds_read_b64_tr_b16 v[96:97], v17 offset:49152
    ds_read_b64_tr_b16 v[98:99], v17 offset:49664
    v_mfma_f32_32x32x16_bf16 v[48:63], v[84:87], v[200:203], v[48:63]
    ds_read_b64_tr_b16 v[100:101], v18 offset:49152
    ds_read_b64_tr_b16 v[102:103], v18 offset:49664
    s_waitcnt lgkmcnt(5)
    v_mfma_f32_32x32x16_bf16 v[32:47], v[88:91], v[204:207], v[32:47]
    ds_read_b128 v[212:215], v12 offset:0
    ds_read_b64_tr_b16 v[80:81], v19 offset:49152
    ds_read_b64_tr_b16 v[82:83], v19 offset:49664
    v_mfma_f32_32x32x16_bf16 v[48:63], v[92:95], v[204:207], v[48:63]
    ds_read_b64_tr_b16 v[84:85], v20 offset:49152
    ds_read_b64_tr_b16 v[86:87], v20 offset:49664
    s_waitcnt lgkmcnt(0)
    v_dot2c_f32_bf16 v28, v96, v25
    v_dot2c_f32_bf16 v29, v100, v25
    v_dot2c_f32_bf16 v28, v97, v25
    v_dot2c_f32_bf16 v29, v101, v25
    v_dot2c_f32_bf16 v28, v98, v25
    v_dot2c_f32_bf16 v29, v102, v25
    v_dot2c_f32_bf16 v28, v99, v25
    v_dot2c_f32_bf16 v29, v103, v25
    v_dot2c_f32_bf16 v26, v196, v25
    v_dot2c_f32_bf16 v27, v196, v196
    v_dot2c_f32_bf16 v26, v197, v25
    v_dot2c_f32_bf16 v27, v197, v197
    v_dot2c_f32_bf16 v26, v198, v25
    v_dot2c_f32_bf16 v27, v198, v198
    v_dot2c_f32_bf16 v26, v199, v25
    v_dot2c_f32_bf16 v27, v199, v199
    v_dot2c_f32_bf16 v26, v200, v25
    v_dot2c_f32_bf16 v27, v200, v200
    v_dot2c_f32_bf16 v26, v201, v25
    v_dot2c_f32_bf16 v27, v201, v201
    v_dot2c_f32_bf16 v26, v202, v25
    v_dot2c_f32_bf16 v27, v202, v202
    v_dot2c_f32_bf16 v26, v203, v25
    v_dot2c_f32_bf16 v27, v203, v203
    v_dot2c_f32_bf16 v26, v204, v25
    v_dot2c_f32_bf16 v27, v204, v204
    v_dot2c_f32_bf16 v26, v205, v25
    v_dot2c_f32_bf16 v27, v205, v205
    v_dot2c_f32_bf16 v26, v206, v25
    v_dot2c_f32_bf16 v27, v206, v206
    v_dot2c_f32_bf16 v26, v207, v25
    v_dot2c_f32_bf16 v27, v207, v207
    v_dot2c_f32_bf16 v26, v208, v25
    v_dot2c_f32_bf16 v27, v208, v208
    v_dot2c_f32_bf16 v26, v209, v25
    v_dot2c_f32_bf16 v27, v209, v209
    v_dot2c_f32_bf16 v26, v210, v25
    v_dot2c_f32_bf16 v27, v210, v210
    v_dot2c_f32_bf16 v26, v211, v25
    v_dot2c_f32_bf16 v27, v211, v211
    v_dot2c_f32_bf16 v26, v212, v25
    v_dot2c_f32_bf16 v27, v212, v212
    v_dot2c_f32_bf16 v26, v213, v25
    v_dot2c_f32_bf16 v27, v213, v213
    v_dot2c_f32_bf16 v26, v214, v25
    v_dot2c_f32_bf16 v27, v214, v214
    v_dot2c_f32_bf16 v26, v215, v25
    v_dot2c_f32_bf16 v27, v215, v215
    v_mov_b32 v246, v28
    v_mov_b32 v247, v29
    s_nop 0
    v_permlane32_swap_b32 v28, v246
    v_permlane32_swap_b32 v29, v247
    v_add_f32 v28, v28, v246
    v_add_f32 v29, v29, v247
    ds_write_b64 v243, v[28:29]
    v_mfma_f32_32x32x16_bf16 v[32:47], v[96:99], v[208:211], v[32:47]
    v_mov_b32 v246, v26
    v_mov_b32 v247, v27
    s_nop 0
    v_permlane32_swap_b32 v26, v246
    v_permlane32_swap_b32 v27, v247
    v_add_f32 v26, v26, v246
    v_add_f32 v27, v27, v247
    v_mul_f32 v247, 0x3b124925, v26
    v_mul_f32 v246, v247, v247
    v_mov_b32 v248, 0x3b124925
    v_fma_f32 v246, v27, v248, -v246
    v_max_f32 v246, 0, v246
    v_add_f32 v246, 0x3727c5ac, v246
    v_rsq_f32 v248, v246
    v_mfma_f32_32x32x16_bf16 v[48:63], v[100:103], v[208:211], v[48:63]
    s_waitcnt lgkmcnt(0)
    s_barrier
    ds_read_b64 v[64:65], v242 offset:0
    ds_read_b64 v[66:67], v242 offset:256
    ds_read_b64 v[68:69], v242 offset:512
    ds_read_b64 v[70:71], v242 offset:768
    v_mfma_f32_32x32x16_bf16 v[32:47], v[80:83], v[212:215], v[32:47]
    v_cmp_gt_u32 vcc, 32, v1
    v_sub_f32 v247, 0, v247
    s_nop 0
    v_cndmask_b32 v247, 0, v247, vcc
    v_and_b32 v26, 0xffff0000, v247
    v_sub_f32 v27, v247, v26
    v_cvt_pk_bf16_f32 v216, v26, v26
    v_cvt_pk_bf16_f32 v217, v27, 0
    v_mfma_f32_32x32x16_bf16 v[48:63], v[84:87], v[212:215], v[48:63]
    s_waitcnt lgkmcnt(0)
    v_add_f32 v64, v64, v66
    v_add_f32 v68, v68, v70
    v_add_f32 v64, v64, v68
    v_and_b32 v26, 0xffff0000, v64
    v_sub_f32 v27, v64, v26
    v_cvt_pk_bf16_f32 v224, v26, v27
    v_lshrrev_b32 v225, 16, v64
    s_nop 1
    v_mfma_f32_32x32x16_bf16 v[32:47], v[224:227], v[216:219], v[32:47]
    v_add_f32 v65, v65, v67
    v_add_f32 v69, v69, v71
    v_add_f32 v65, v65, v69
    v_and_b32 v26, 0xffff0000, v65
    v_sub_f32 v27, v65, v26
    v_cvt_pk_bf16_f32 v228, v26, v27
    v_lshrrev_b32 v229, 16, v65
    s_nop 1
    v_mfma_f32_32x32x16_bf16 v[48:63], v[228:231], v[216:219], v[48:63]
    buffer_store_dwordx4 v[236:239], v244, s[12:15], s58 offen sc1
    s_nop 0
    v_pk_mul_f32 v[32:33], v[32:33], v[248:249] op_sel_hi:[1,0]
    v_cvt_pk_bf16_f32 v32, v32, v33
    v_pk_mul_f32 v[34:35], v[34:35], v[248:249] op_sel_hi:[1,0]
    v_cvt_pk_bf16_f32 v33, v34, v35
    v_pk_mul_f32 v[36:37], v[36:37], v[248:249] op_sel_hi:[1,0]
    v_cvt_pk_bf16_f32 v34, v36, v37
    v_pk_mul_f32 v[38:39], v[38:39], v[248:249] op_sel_hi:[1,0]
    v_cvt_pk_bf16_f32 v35, v38, v39
    buffer_store_dwordx4 v[32:35], v254, s[12:15], s57 offen offset:0 sc1
    v_pk_mul_f32 v[40:41], v[40:41], v[248:249] op_sel_hi:[1,0]
    v_cvt_pk_bf16_f32 v36, v40, v41
    v_pk_mul_f32 v[42:43], v[42:43], v[248:249] op_sel_hi:[1,0]
    v_cvt_pk_bf16_f32 v37, v42, v43
    v_pk_mul_f32 v[44:45], v[44:45], v[248:249] op_sel_hi:[1,0]
    v_cvt_pk_bf16_f32 v38, v44, v45
    v_pk_mul_f32 v[46:47], v[46:47], v[248:249] op_sel_hi:[1,0]
    v_cvt_pk_bf16_f32 v39, v46, v47
    buffer_store_dwordx4 v[36:39], v254, s[12:15], s57 offen offset:1024 sc1
    v_pk_mul_f32 v[48:49], v[48:49], v[248:249] op_sel_hi:[1,0]
    v_cvt_pk_bf16_f32 v48, v48, v49
    v_pk_mul_f32 v[50:51], v[50:51], v[248:249] op_sel_hi:[1,0]
    v_cvt_pk_bf16_f32 v49, v50, v51
    v_pk_mul_f32 v[52:53], v[52:53], v[248:249] op_sel_hi:[1,0]
    v_cvt_pk_bf16_f32 v50, v52, v53
    v_pk_mul_f32 v[54:55], v[54:55], v[248:249] op_sel_hi:[1,0]
    v_cvt_pk_bf16_f32 v51, v54, v55
    buffer_store_dwordx4 v[48:51], v254, s[12:15], s57 offen offset:2048 sc1
    v_pk_mul_f32 v[56:57], v[56:57], v[248:249] op_sel_hi:[1,0]
    v_cvt_pk_bf16_f32 v52, v56, v57
    v_pk_mul_f32 v[58:59], v[58:59], v[248:249] op_sel_hi:[1,0]
    v_cvt_pk_bf16_f32 v53, v58, v59
    v_pk_mul_f32 v[60:61], v[60:61], v[248:249] op_sel_hi:[1,0]
    v_cvt_pk_bf16_f32 v54, v60, v61
    v_pk_mul_f32 v[62:63], v[62:63], v[248:249] op_sel_hi:[1,0]
    v_cvt_pk_bf16_f32 v55, v62, v63
    buffer_store_dwordx4 v[52:55], v254, s[12:15], s57 offen offset:3072 sc1
L_q:
L_w0_2:
    s_cbranch_execz L_w0_r
    s_waitcnt vmcnt(10)
    v_cmp_gt_u32 vcc, 32, v245
    s_cbranch_vccnz L_rdp
L_rdd:
    s_waitcnt vmcnt(5)
    s_barrier
    ds_read_b64_tr_b16 v[76:77], v21 offset:0
    ds_read_b64_tr_b16 v[78:79], v21 offset:256
    ds_read_b64_tr_b16 v[80:81], v21 offset:4096
    ds_read_b64_tr_b16 v[82:83], v21 offset:4352
    ds_read_b64_tr_b16 v[84:85], v21 offset:8192
    ds_read_b64_tr_b16 v[86:87], v21 offset:8448
    ds_read_b64_tr_b16 v[88:89], v21 offset:12288
    ds_read_b64_tr_b16 v[90:91], v21 offset:12544
    ds_read_b64_tr_b16 v[92:93], v21 offset:16384
    ds_read_b64_tr_b16 v[94:95], v21 offset:16640
    ds_read_b64_tr_b16 v[96:97], v21 offset:20480
    ds_read_b64_tr_b16 v[98:99], v21 offset:20736
    ds_read_b64_tr_b16 v[100:101], v21 offset:24576
    ds_read_b64_tr_b16 v[102:103], v21 offset:24832
    s_waitcnt lgkmcnt(6)
    ds_read_b64_tr_b16 v[32:33], v21 offset:0
    ds_read_b64_tr_b16 v[34:35], v21 offset:256
    ds_read_b64_tr_b16 v[36:37], v22 offset:0
    ds_read_b64_tr_b16 v[38:39], v22 offset:256
    ds_read_b64_tr_b16 v[40:41], v23 offset:0
    ds_read_b64_tr_b16 v[42:43], v23 offset:256
    ds_read_b64_tr_b16 v[44:45], v24 offset:0
    ds_read_b64_tr_b16 v[46:47], v24 offset:256
    v_dot2c_f32_bf16 v30, v76, v25
    v_dot2c_f32_bf16 v30, v77, v25
    v_dot2c_f32_bf16 v30, v78, v25
    v_dot2c_f32_bf16 v30, v79, v25
    v_dot2c_f32_bf16 v30, v80, v25
    v_dot2c_f32_bf16 v30, v81, v25
    v_dot2c_f32_bf16 v30, v82, v25
    v_dot2c_f32_bf16 v30, v83, v25
    v_dot2c_f32_bf16 v30, v84, v25
    v_dot2c_f32_bf16 v30, v85, v25
    v_dot2c_f32_bf16 v30, v86, v25
    v_dot2c_f32_bf16 v30, v87, v25
    v_dot2c_f32_bf16 v30, v88, v25
    v_dot2c_f32_bf16 v30, v89, v25
    v_dot2c_f32_bf16 v30, v90, v25
    v_dot2c_f32_bf16 v30, v91, v25
    s_waitcnt lgkmcnt(8)
    v_dot2c_f32_bf16 v30, v92, v25
    v_dot2c_f32_bf16 v30, v93, v25
    v_dot2c_f32_bf16 v30, v94, v25
    v_dot2c_f32_bf16 v30, v95, v25
    v_dot2c_f32_bf16 v30, v96, v25
    v_dot2c_f32_bf16 v30, v97, v25
    v_dot2c_f32_bf16 v30, v98, v25
    v_dot2c_f32_bf16 v30, v99, v25
    v_dot2c_f32_bf16 v30, v100, v25
    v_dot2c_f32_bf16 v30, v101, v25
    v_dot2c_f32_bf16 v30, v102, v25
    v_dot2c_f32_bf16 v30, v103, v25
    s_nop 2
    v_mov_b32 v246, v30
    s_nop 1
    v_permlane32_swap_b32 v30, v246
    v_add_f32 v30, v30, v246
    ds_write_b32 v243, v30
    s_waitcnt lgkmcnt(6)
    v_mfma_f32_32x32x16_bf16 v[64:79], v[32:35], v[104:107], 0
    ds_read_b64_tr_b16 v[48:49], v21 offset:4096
    ds_read_b64_tr_b16 v[50:51], v21 offset:4352
    v_mul_f32 v26, 0x3e8b97f6, v248
    v_mov_b32 v2, v254
    v_accvgpr_read_b32 v3, a0
    s_waitcnt lgkmcnt(6)
    v_mfma_f32_32x32x16_bf16 v[64:79], v[36:39], v[108:111], v[64:79]
    ds_read_b64_tr_b16 v[52:53], v22 offset:4096
    ds_read_b64_tr_b16 v[54:55], v22 offset:4352
    v_accvgpr_read_b32 v4, a2
    v_accvgpr_read_b32 v248, a3
    v_accvgpr_read_b32 v0, a5
    s_waitcnt lgkmcnt(6)
    v_mfma_f32_32x32x16_bf16 v[64:79], v[40:43], v[112:115], v[64:79]
    ds_read_b64_tr_b16 v[56:57], v23 offset:4096
    ds_read_b64_tr_b16 v[58:59], v23 offset:4352
    v_accvgpr_read_b32 v6, a9
    v_accvgpr_read_b32 v13, a10
    v_accvgpr_read_b32 v5, a11
    s_waitcnt lgkmcnt(6)
    v_mfma_f32_32x32x16_bf16 v[64:79], v[44:47], v[116:119], v[64:79]
    ds_read_b64_tr_b16 v[60:61], v24 offset:4096
    ds_read_b64_tr_b16 v[62:63], v24 offset:4352
    v_accvgpr_read_b32 v15, a12
    v_accvgpr_read_b32 v9, a13
    v_accvgpr_read_b32 v10, a14
    s_waitcnt lgkmcnt(6)
    v_mfma_f32_32x32x16_bf16 v[64:79], v[48:51], v[120:123], v[64:79]
    ds_read_b64_tr_b16 v[32:33], v21 offset:8192
    ds_read_b64_tr_b16 v[34:35], v21 offset:8448
    v_accvgpr_read_b32 v11, a15
    v_accvgpr_read_b32 v12, a16
    v_accvgpr_read_b32 v241, a19
    s_waitcnt lgkmcnt(6)
    v_mfma_f32_32x32x16_bf16 v[64:79], v[52:55], v[124:127], v[64:79]
    ds_read_b64_tr_b16 v[36:37], v22 offset:8192
    ds_read_b64_tr_b16 v[38:39], v22 offset:8448
    v_accvgpr_read_b32 v240, a21
    v_xor_b32 v249, 6144, v15
    v_xor_b32 v250, 4096, v15
    s_waitcnt lgkmcnt(6)
    v_mfma_f32_32x32x16_bf16 v[64:79], v[56:59], v[128:131], v[64:79]
    ds_read_b64_tr_b16 v[40:41], v23 offset:8192
    ds_read_b64_tr_b16 v[42:43], v23 offset:8448
    v_xor_b32 v251, 2048, v15
    v_mov_b32 v220, 0
    v_mov_b32 v7, 0xdddd
    s_waitcnt lgkmcnt(6)
    v_mfma_f32_32x32x16_bf16 v[64:79], v[60:63], v[132:135], v[64:79]
    ds_read_b64_tr_b16 v[44:45], v24 offset:8192
    ds_read_b64_tr_b16 v[46:47], v24 offset:8448
    s_mov_b32 s30, 0
    s_mov_b32 s34, 3584
    s_mov_b32 s35, 0x00020000
    s_barrier
    ds_read_b32 v96, v242 offset:0
    ds_read_b32 v97, v242 offset:256
    ds_read_b32 v98, v242 offset:512
    ds_read_b32 v99, v242 offset:768
    s_waitcnt lgkmcnt(6)
    v_mfma_f32_32x32x16_bf16 v[64:79], v[32:35], v[136:139], v[64:79]
    ds_read_b64_tr_b16 v[48:49], v21 offset:12288
    ds_read_b64_tr_b16 v[50:51], v21 offset:12544
    s_mov_b32 s38, 896
    s_mov_b32 s42, 1835008
    s_mov_b32 s43, 0x00020000
    s_waitcnt lgkmcnt(6)
    v_mfma_f32_32x32x16_bf16 v[64:79], v[36:39], v[140:143], v[64:79]
    ds_read_b64_tr_b16 v[52:53], v22 offset:12288
    ds_read_b64_tr_b16 v[54:55], v22 offset:12544
    s_mov_b32 s8, s60
    s_mov_b32 s9, s61
    s_cmp_lt_u32 s20, 14
    s_cselect_b32 s10, 57344, 0
    s_waitcnt lgkmcnt(6)
    v_mfma_f32_32x32x16_bf16 v[64:79], v[40:43], v[144:147], v[64:79]
    ds_read_b64_tr_b16 v[56:57], v23 offset:12288
    ds_read_b64_tr_b16 v[58:59], v23 offset:12544
    s_waitcnt lgkmcnt(6)
    v_mfma_f32_32x32x16_bf16 v[64:79], v[44:47], v[148:151], v[64:79]
    ds_read_b64_tr_b16 v[60:61], v24 offset:12288
    ds_read_b64_tr_b16 v[62:63], v24 offset:12544
    s_waitcnt vmcnt(0)
    s_barrier
    buffer_atomic_add v253, v255, s[12:15], 0 offen sc1
    s_waitcnt lgkmcnt(6)
    v_mfma_f32_32x32x16_bf16 v[64:79], v[48:51], v[152:155], v[64:79]
    ds_read_b64_tr_b16 v[32:33], v21 offset:16384
    ds_read_b64_tr_b16 v[34:35], v21 offset:16640
    s_waitcnt lgkmcnt(6)
    v_mfma_f32_32x32x16_bf16 v[64:79], v[52:55], v[156:159], v[64:79]
    ds_read_b64_tr_b16 v[36:37], v22 offset:16384
    ds_read_b64_tr_b16 v[38:39], v22 offset:16640
    s_waitcnt lgkmcnt(6)
    v_mfma_f32_32x32x16_bf16 v[64:79], v[56:59], v[160:163], v[64:79]
    ds_read_b64_tr_b16 v[40:41], v23 offset:16384
    ds_read_b64_tr_b16 v[42:43], v23 offset:16640
    s_waitcnt lgkmcnt(6)
    v_mfma_f32_32x32x16_bf16 v[64:79], v[60:63], v[164:167], v[64:79]
    ds_read_b64_tr_b16 v[44:45], v24 offset:16384
    ds_read_b64_tr_b16 v[46:47], v24 offset:16640
    s_waitcnt lgkmcnt(6)
    v_mfma_f32_32x32x16_bf16 v[64:79], v[32:35], v[168:171], v[64:79]
    ds_read_b64_tr_b16 v[48:49], v21 offset:20480
    ds_read_b64_tr_b16 v[50:51], v21 offset:20736
    v_add_f32 v96, v96, v97
    v_add_f32 v98, v98, v99
    v_add_f32 v30, v96, v98
    s_waitcnt lgkmcnt(6)
    v_mfma_f32_32x32x16_bf16 v[64:79], v[36:39], v[172:175], v[64:79]
    ds_read_b64_tr_b16 v[52:53], v22 offset:20480
    ds_read_b64_tr_b16 v[54:55], v22 offset:20736
    v_and_b32 v28, 0xffff0000, v30
    v_sub_f32 v29, v30, v28
    v_cvt_pk_bf16_f32 v232, v28, v29
    s_waitcnt lgkmcnt(6)
    v_mfma_f32_32x32x16_bf16 v[64:79], v[40:43], v[176:179], v[64:79]
    ds_read_b64_tr_b16 v[56:57], v23 offset:20480
    ds_read_b64_tr_b16 v[58:59], v23 offset:20736
    v_lshrrev_b32 v233, 16, v30
    s_waitcnt lgkmcnt(6)
    v_mfma_f32_32x32x16_bf16 v[64:79], v[44:47], v[180:183], v[64:79]
    ds_read_b64_tr_b16 v[60:61], v24 offset:20480
    ds_read_b64_tr_b16 v[62:63], v24 offset:20736
    s_waitcnt lgkmcnt(6)
    v_mfma_f32_32x32x16_bf16 v[64:79], v[48:51], v[184:187], v[64:79]
    ds_read_b64_tr_b16 v[32:33], v21 offset:24576
    ds_read_b64_tr_b16 v[34:35], v21 offset:24832
    v_accvgpr_read_b32 v169, a1
    v_accvgpr_read_b32 v172, a4
    v_accvgpr_read_b32 v160, a6
    s_waitcnt lgkmcnt(6)
    v_mfma_f32_32x32x16_bf16 v[64:79], v[52:55], v[188:191], v[64:79]
    ds_read_b64_tr_b16 v[36:37], v22 offset:24576
    ds_read_b64_tr_b16 v[38:39], v22 offset:24832
    v_accvgpr_read_b32 v161, a7
    v_accvgpr_read_b32 v177, a8
    v_accvgpr_read_b32 v165, a17
    s_waitcnt lgkmcnt(6)
    v_mfma_f32_32x32x16_bf16 v[64:79], v[56:59], v[192:195], v[64:79]
    ds_read_b64_tr_b16 v[40:41], v23 offset:24576
    ds_read_b64_tr_b16 v[42:43], v23 offset:24832
    v_accvgpr_read_b32 v173, a18
    v_accvgpr_read_b32 v170, a20
    v_accvgpr_read_b32 v174, a22
    s_waitcnt lgkmcnt(6)
    v_mfma_f32_32x32x16_bf16 v[64:79], v[60:63], v[196:199], v[64:79]
    ds_read_b64_tr_b16 v[44:45], v24 offset:24576
    ds_read_b64_tr_b16 v[46:47], v24 offset:24832
    v_accvgpr_read_b32 v175, a23
    v_accvgpr_read_b32 v176, a24
    v_add_u32 v166, 13312, v165
    s_waitcnt lgkmcnt(6)
    v_mfma_f32_32x32x16_bf16 v[64:79], v[32:35], v[200:203], v[64:79]
    v_add_u32 v167, 26624, v165
    v_add_u32 v168, 39936, v165
    s_waitcnt lgkmcnt(4)
    v_mfma_f32_32x32x16_bf16 v[64:79], v[36:39], v[204:207], v[64:79]
    s_waitcnt lgkmcnt(2)
    v_mfma_f32_32x32x16_bf16 v[64:79], v[40:43], v[208:211], v[64:79]
    s_waitcnt lgkmcnt(0)
    v_mfma_f32_32x32x16_bf16 v[64:79], v[44:47], v[212:215], v[64:79]
    v_mfma_f32_32x32x16_bf16 v[64:79], v[232:235], v[216:219], v[64:79]
    s_load_dwordx2 s[32:33], s[0:1], 40
    s_load_dwordx2 s[36:37], s[0:1], 56
    s_load_dwordx2 s[40:41], s[0:1], 64
    s_getpc_b64 s[80:81]
L_pc1:
    global_load_dword v242, v170, s[80:81]
    v_mfma_f32_32x32x16_bf16 v[48:63], v[220:223], v[220:223], 0
    v_mfma_f32_32x32x16_bf16 v[80:95], v[220:223], v[220:223], 0
    v_mfma_f32_32x32x16_bf16 v[96:111], v[220:223], v[220:223], 0
    s_nop 3
    v_mul_f32 v64, v26, v64
    v_mul_f32 v65, v26, v65
    v_cvt_pk_bf16_f32 v40, v64, v65
    v_mul_f32 v66, v26, v66
    v_mul_f32 v67, v26, v67
    v_cvt_pk_bf16_f32 v41, v66, v67
    v_mul_f32 v68, v26, v68
    v_mul_f32 v69, v26, v69
    v_cvt_pk_bf16_f32 v42, v68, v69
    v_mul_f32 v70, v26, v70
    v_mul_f32 v71, v26, v71
    v_cvt_pk_bf16_f32 v43, v70, v71
    v_mul_f32 v72, v26, v72
    v_mul_f32 v73, v26, v73
    v_cvt_pk_bf16_f32 v44, v72, v73
    v_mul_f32 v74, v26, v74
    v_mul_f32 v75, v26, v75
    v_cvt_pk_bf16_f32 v45, v74, v75
    v_mul_f32 v76, v26, v76
    v_mul_f32 v77, v26, v77
    v_cvt_pk_bf16_f32 v46, v76, v77
    v_mul_f32 v78, v26, v78
    v_mul_f32 v79, v26, v79
    v_cvt_pk_bf16_f32 v47, v78, v79
    v_and_b32 v40, v13, v40
    v_and_b32 v41, v13, v41
L_w0_3:
    s_cbranch_execz L_w0_r
    v_and_b32 v46, v5, v46
    v_and_b32 v47, v5, v47
    ds_write_b128 v15, v[40:43]
    ds_write_b128 v15, v[44:47] offset:1024
    v_mfma_f32_32x32x16_bf16 v[64:79], v[220:223], v[220:223], 0
    s_add_u32 s76, s51, 32768
    s_mov_b32 m0, s46
    v_mov_b32 v255, 23068672
L_s1:
    s_cmp_lg_u32 s16, 1
    s_cbranch_scc1 L_s1wait
    s_mov_b32 s26, 262144
L_s1poll:
    buffer_load_dword v15, v169, s[12:15], s51 offen sc1
    s_sub_u32 s26, s26, 1
    s_cbranch_scc1 L_s1done
    s_waitcnt vmcnt(0)
    v_cmp_gt_u32 vcc, 16, v15
    s_cbranch_vccnz L_s1poll
L_s1done:
    buffer_load_dwordx4 a[0:3], v3, s[12:15], m0 offen offset:0 sc1
    buffer_load_dwordx4 a[4:7], v3, s[12:15], m0 offen offset:1024 sc1
    s_waitcnt lgkmcnt(0)
    s_barrier
    s_branch L_s1go
L_s1wait:
    s_mov_b64 exec, 0
    s_cmp_eq_u32 s16, 0
    s_cbranch_scc1 L_w1_0
    s_cmp_eq_u32 s16, 2
    s_cbranch_scc1 L_w1_1
    s_cmp_eq_u32 s16, 3
    s_cbranch_scc1 L_w1_r
L_w1_r:
    s_mov_b64 exec, -1
    s_waitcnt vmcnt(0) lgkmcnt(0)
    s_barrier
    buffer_load_dwordx4 a[0:3], v3, s[12:15], m0 offen offset:0 sc1
    buffer_load_dwordx4 a[4:7], v3, s[12:15], m0 offen offset:1024 sc1
L_s1go:
    buffer_load_dwordx4 a[8:11], v4, s[12:15], m0 offen sc1
    buffer_load_dwordx4 a[12:15], v248, s[12:15], m0 offen sc1
    buffer_atomic_add v253, v255, s[12:15], 0 offen sc1
    s_add_u32 m0, s46, 57600
    ds_read_b128 v[16:19], v249 offset:0
    ds_read_b128 v[20:23], v249 offset:1024
    ds_read_b128 v[24:27], v250 offset:0
    ds_read_b128 v[28:31], v250 offset:1024
    ds_read_b128 v[32:35], v251 offset:0
    ds_read_b128 v[36:39], v251 offset:1024
    buffer_load_dwordx4 a[16:19], v3, s[12:15], m0 offen offset:0 sc1
    buffer_load_dwordx4 a[20:23], v3, s[12:15], m0 offen offset:1024 sc1
    buffer_load_dwordx4 a[24:27], v4, s[12:15], m0 offen sc1
    buffer_load_dwordx4 a[28:31], v248, s[12:15], m0 offen sc1
    s_add_u32 m0, s46, 115200
    s_nop 0
    buffer_load_dwordx4 a[32:35], v3, s[12:15], m0 offen offset:0 sc1
    buffer_load_dwordx4 a[36:39], v3, s[12:15], m0 offen offset:1024 sc1
    buffer_load_dwordx4 a[40:43], v4, s[12:15], m0 offen sc1
    buffer_load_dwordx4 a[44:47], v248, s[12:15], m0 offen sc1
    s_add_u32 m0, s46, 172800
    s_lshl_b32 s76, s24, 6
    s_waitcnt lgkmcnt(0)
    s_barrier
    v_mov_b32 v249, v173
    v_add_u32 v254, 0x10000, v173
    v_mov_b32 v250, v174
    v_mov_b32 v251, v175
    v_mov_b32 v5, v176
    v_mov_b32 v255, v172
    v_mov_b32 v8, 1
    v_mov_b32 v14, 0x3f803f80
    s_getpc_b64 s[80:81]
L_pc2:
    s_bfe_u32 s77, s2, 0x30003
    s_lshl2_add_u32 s77, s77, s16
    v_lshrrev_b32 v13, 4, v1
    v_lshl_add_u32 v13, s77, 2, v13
    v_min_u32 v13, (L_fallback-L_combine)/128, v13
    v_lshlrev_b32 v13, 7, v13
    v_add_u32 v13, L_combine-L_pc2, v13
    s_waitcnt vmcnt(11)
    v_mfma_f32_32x32x16_bf16 v[112:127], a[0:3], v[16:19], 0
    v_mfma_f32_32x32x16_bf16 v[112:127], a[4:7], v[20:23], v[112:127]
    v_mfma_f32_32x32x16_bf16 v[128:143], a[0:3], v[24:27], 0
    buffer_load_dwordx4 a[48:51], v3, s[12:15], m0 offen offset:0 sc1
    s_nop 9
    v_exp_f32 v112, v112
    v_exp_f32 v113, v113
    v_exp_f32 v114, v114
    v_exp_f32 v115, v115
    v_mfma_f32_32x32x16_bf16 v[128:143], a[4:7], v[28:31], v[128:143]
    v_exp_f32 v116, v116
    v_exp_f32 v117, v117
    v_exp_f32 v118, v118
    v_exp_f32 v119, v119
    s_waitcnt vmcnt(10)
    buffer_load_dwordx4 a[52:55], v3, s[12:15], m0 offen offset:1024 sc1
    v_exp_f32 v120, v120
    v_exp_f32 v121, v121
    v_exp_f32 v122, v122
    v_exp_f32 v123, v123
    v_smfmac_f32_32x32x32_bf16 v[48:63], a[8:11], v[112:119], v7
    v_exp_f32 v124, v124
    v_exp_f32 v125, v125
    v_exp_f32 v126, v126
    v_exp_f32 v127, v127
    v_mfma_f32_32x32x16_bf16 v[144:159], a[0:3], v[32:35], 0
    buffer_load_dwordx4 a[56:59], v4, s[12:15], m0 offen sc1
    v_exp_f32 v128, v128
    v_exp_f32 v129, v129
    v_exp_f32 v130, v130
    v_exp_f32 v131, v131
    v_mfma_f32_32x32x16_bf16 v[144:159], a[4:7], v[36:39], v[144:159]
    v_exp_f32 v132, v132
    v_exp_f32 v133, v133
    v_exp_f32 v134, v134
    v_exp_f32 v135, v135
    v_smfmac_f32_32x32x32_bf16 v[48:63], a[12:15], v[120:127], v7
    s_waitcnt vmcnt(7)
    buffer_load_dwordx4 a[60:63], v248, s[12:15], m0 offen sc1
    v_exp_f32 v136, v136
    v_exp_f32 v137, v137
    v_exp_f32 v138, v138
    v_exp_f32 v139, v139
    v_smfmac_f32_32x32x32_bf16 v[64:79], a[8:11], v[128:135], v7
    s_add_u32 m0, s46, 230400
    v_exp_f32 v140, v140
    v_exp_f32 v141, v141
    v_exp_f32 v142, v142
    v_exp_f32 v143, v143
    v_mfma_f32_32x32x16_bf16 v[112:127], a[16:19], v[16:19], 0
    buffer_load_dwordx4 a[64:67], v3, s[12:15], m0 offen offset:0 sc1
    v_exp_f32 v144, v144
    v_exp_f32 v145, v145
    v_exp_f32 v146, v146
    v_exp_f32 v147, v147
    v_mfma_f32_32x32x16_bf16 v[112:127], a[20:23], v[20:23], v[112:127]
    v_exp_f32 v148, v148
    v_exp_f32 v149, v149
    v_exp_f32 v150, v150
    v_exp_f32 v151, v151
    v_smfmac_f32_32x32x32_bf16 v[64:79], a[12:15], v[136:143], v7
    buffer_load_dwordx4 a[68:71], v3, s[12:15], m0 offen offset:1024 sc1
    v_exp_f32 v152, v152
    v_exp_f32 v153, v153
    v_exp_f32 v154, v154
    v_exp_f32 v155, v155
    v_smfmac_f32_32x32x32_bf16 v[80:95], a[8:11], v[144:151], v7
    v_exp_f32 v156, v156
    v_exp_f32 v157, v157
    v_exp_f32 v158, v158
    v_exp_f32 v159, v159
    v_mfma_f32_32x32x16_bf16 v[128:143], a[16:19], v[24:27], 0
    buffer_load_dwordx4 a[72:75], v4, s[12:15], m0 offen sc1
    v_exp_f32 v112, v112
    v_exp_f32 v113, v113
    v_exp_f32 v114, v114
    v_exp_f32 v115, v115
    v_mfma_f32_32x32x16_bf16 v[128:143], a[20:23], v[28:31], v[128:143]
    v_exp_f32 v116, v116
    v_exp_f32 v117, v117
    v_exp_f32 v118, v118
    v_exp_f32 v119, v119
    v_smfmac_f32_32x32x32_bf16 v[80:95], a[12:15], v[152:159], v7
    buffer_load_dwordx4 a[76:79], v248, s[12:15], m0 offen sc1
    v_exp_f32 v120, v120
    v_exp_f32 v121, v121
    v_exp_f32 v122, v122
    v_exp_f32 v123, v123
    v_smfmac_f32_32x32x32_bf16 v[48:63], a[24:27], v[112:119], v7
    s_add_u32 m0, s46, 288000
    v_exp_f32 v124, v124
    v_exp_f32 v125, v125
    v_exp_f32 v126, v126
    v_exp_f32 v127, v127
    v_mfma_f32_32x32x16_bf16 v[144:159], a[16:19], v[32:35], 0
    buffer_load_dwordx4 a[80:83], v3, s[12:15], m0 offen offset:0 sc1
    v_exp_f32 v128, v128
    v_exp_f32 v129, v129
    v_exp_f32 v130, v130
    v_exp_f32 v131, v131
    v_mfma_f32_32x32x16_bf16 v[144:159], a[20:23], v[36:39], v[144:159]
    v_exp_f32 v132, v132
    v_exp_f32 v133, v133
    v_exp_f32 v134, v134
    v_exp_f32 v135, v135
    v_smfmac_f32_32x32x32_bf16 v[48:63], a[28:31], v[120:127], v7
    s_waitcnt vmcnt(9)
    buffer_load_dwordx4 a[84:87], v3, s[12:15], m0 offen offset:1024 sc1
    v_exp_f32 v136, v136
    v_exp_f32 v137, v137
    v_exp_f32 v138, v138
    v_exp_f32 v139, v139
    v_smfmac_f32_32x32x32_bf16 v[64:79], a[24:27], v[128:135], v7
    v_exp_f32 v140, v140
    v_exp_f32 v141, v141
    v_exp_f32 v142, v142
    v_exp_f32 v143, v143
    v_mfma_f32_32x32x16_bf16 v[112:127], a[32:35], v[16:19], 0
    buffer_load_dwordx4 a[88:91], v4, s[12:15], m0 offen sc1
    v_exp_f32 v144, v144
    v_exp_f32 v145, v145
    v_exp_f32 v146, v146
    v_exp_f32 v147, v147
    v_mfma_f32_32x32x16_bf16 v[112:127], a[36:39], v[20:23], v[112:127]
    v_exp_f32 v148, v148
    v_exp_f32 v149, v149
    v_exp_f32 v150, v150
    v_exp_f32 v151, v151
    v_smfmac_f32_32x32x32_bf16 v[64:79], a[28:31], v[136:143], v7
    buffer_load_dwordx4 a[92:95], v248, s[12:15], m0 offen sc1
    v_exp_f32 v152, v152
    v_exp_f32 v153, v153
    v_exp_f32 v154, v154
    v_exp_f32 v155, v155
    v_smfmac_f32_32x32x32_bf16 v[80:95], a[24:27], v[144:151], v7
    s_add_u32 m0, s46, 345600
    v_exp_f32 v156, v156
    v_exp_f32 v157, v157
    v_exp_f32 v158, v158
    v_exp_f32 v159, v159
    v_mfma_f32_32x32x16_bf16 v[128:143], a[32:35], v[24:27], 0
    buffer_load_dwordx4 a[96:99], v3, s[12:15], m0 offen offset:0 sc1
    v_exp_f32 v112, v112
    v_exp_f32 v113, v113
    v_exp_f32 v114, v114
    v_exp_f32 v115, v115
    v_mfma_f32_32x32x16_bf16 v[128:143], a[36:39], v[28:31], v[128:143]
    v_exp_f32 v116, v116
    v_exp_f32 v117, v117
    v_exp_f32 v118, v118
    v_exp_f32 v119, v119
    v_smfmac_f32_32x32x32_bf16 v[80:95], a[28:31], v[152:159], v7
    buffer_load_dwordx4 a[100:103], v3, s[12:15], m0 offen offset:1024 sc1
    v_exp_f32 v120, v120
    v_exp_f32 v121, v121
    v_exp_f32 v122, v122
    v_exp_f32 v123, v123
    v_smfmac_f32_32x32x32_bf16 v[48:63], a[40:43], v[112:119], v7
    v_exp_f32 v124, v124
    v_exp_f32 v125, v125
    v_exp_f32 v126, v126
    v_exp_f32 v127, v127
    v_mfma_f32_32x32x16_bf16 v[144:159], a[32:35], v[32:35], 0
    buffer_load_dwordx4 a[104:107], v4, s[12:15], m0 offen sc1
    v_exp_f32 v128, v128
    v_exp_f32 v129, v129
    v_exp_f32 v130, v130
    v_exp_f32 v131, v131
    v_mfma_f32_32x32x16_bf16 v[144:159], a[36:39], v[36:39], v[144:159]
    v_exp_f32 v132, v132
    v_exp_f32 v133, v133
    v_exp_f32 v134, v134
    v_exp_f32 v135, v135
    v_smfmac_f32_32x32x32_bf16 v[48:63], a[44:47], v[120:127], v7
    s_waitcnt vmcnt(11)
    buffer_load_dwordx4 a[108:111], v248, s[12:15], m0 offen sc1
    v_exp_f32 v136, v136
    v_exp_f32 v137, v137
    v_exp_f32 v138, v138
    v_exp_f32 v139, v139
    v_smfmac_f32_32x32x32_bf16 v[64:79], a[40:43], v[128:135], v7
    s_add_u32 m0, s46, 403200
    v_exp_f32 v140, v140
    v_exp_f32 v141, v141
    v_exp_f32 v142, v142
    v_exp_f32 v143, v143
    v_mfma_f32_32x32x16_bf16 v[112:127], a[48:51], v[16:19], 0
    buffer_load_dwordx4 a[112:115], v3, s[12:15], m0 offen offset:0 sc1
    v_exp_f32 v144, v144
    v_exp_f32 v145, v145
    v_exp_f32 v146, v146
    v_exp_f32 v147, v147
    v_mfma_f32_32x32x16_bf16 v[112:127], a[52:55], v[20:23], v[112:127]
    v_exp_f32 v148, v148
    v_exp_f32 v149, v149
    v_exp_f32 v150, v150
    v_exp_f32 v151, v151
    v_smfmac_f32_32x32x32_bf16 v[64:79], a[44:47], v[136:143], v7
    buffer_load_dwordx4 a[116:119], v3, s[12:15], m0 offen offset:1024 sc1
    v_exp_f32 v152, v152
    v_exp_f32 v153, v153
    v_exp_f32 v154, v154
    v_exp_f32 v155, v155
    v_smfmac_f32_32x32x32_bf16 v[80:95], a[40:43], v[144:151], v7
    v_exp_f32 v156, v156
    v_exp_f32 v157, v157
    v_exp_f32 v158, v158
    v_exp_f32 v159, v159
    v_mfma_f32_32x32x16_bf16 v[128:143], a[48:51], v[24:27], 0
    buffer_load_dwordx4 a[120:123], v4, s[12:15], m0 offen sc1
    v_exp_f32 v112, v112
    v_exp_f32 v113, v113
    v_exp_f32 v114, v114
    v_exp_f32 v115, v115
    v_mfma_f32_32x32x16_bf16 v[128:143], a[52:55], v[28:31], v[128:143]
    buffer_load_dwordx4 v[232:235], v160, s[36:39], 0 offen offset:0
    v_exp_f32 v116, v116
    v_exp_f32 v117, v117
    v_exp_f32 v118, v118
    v_exp_f32 v119, v119
    v_smfmac_f32_32x32x32_bf16 v[80:95], a[44:47], v[152:159], v7
    buffer_load_dwordx4 a[124:127], v248, s[12:15], m0 offen sc1
    v_exp_f32 v120, v120
    v_exp_f32 v121, v121
    v_exp_f32 v122, v122
    v_exp_f32 v123, v123
    v_smfmac_f32_32x32x32_bf16 v[48:63], a[56:59], v[112:119], v7
    buffer_load_dwordx4 v[236:239], v160, s[36:39], 0 offen offset:64
    v_exp_f32 v124, v124
    v_exp_f32 v125, v125
    v_exp_f32 v126, v126
    v_exp_f32 v127, v127
    v_mfma_f32_32x32x16_bf16 v[144:159], a[48:51], v[32:35], 0
    global_load_dword v242, v177, s[82:83]
    v_exp_f32 v128, v128
    v_exp_f32 v129, v129
    v_exp_f32 v130, v130
    v_exp_f32 v131, v131
    v_mfma_f32_32x32x16_bf16 v[144:159], a[52:55], v[36:39], v[144:159]
    buffer_load_ushort v244, v161, s[32:35], 0 offen offset:0
    v_exp_f32 v132, v132
    v_exp_f32 v133, v133
    v_exp_f32 v134, v134
    v_exp_f32 v135, v135
    v_smfmac_f32_32x32x32_bf16 v[48:63], a[60:63], v[120:127], v7
    s_waitcnt vmcnt(16)
    v_exp_f32 v136, v136
    v_exp_f32 v137, v137
    v_exp_f32 v138, v138
    v_exp_f32 v139, v139
    v_smfmac_f32_32x32x32_bf16 v[64:79], a[56:59], v[128:135], v7
    buffer_load_ushort v245, v161, s[32:35], 0 offen offset:64
    v_exp_f32 v140, v140
    v_exp_f32 v141, v141
    v_exp_f32 v142, v142
    v_exp_f32 v143, v143
    v_mfma_f32_32x32x16_bf16 v[112:127], a[64:67], v[16:19], 0
    v_exp_f32 v144, v144
    v_exp_f32 v145, v145
    v_exp_f32 v146, v146
    v_exp_f32 v147, v147
    v_mfma_f32_32x32x16_bf16 v[112:127], a[68:71], v[20:23], v[112:127]
    s_add_u32 m0, s47, 0
    buffer_load_ushort v246, v161, s[32:35], 0 offen offset:128
    v_exp_f32 v148, v148
    v_exp_f32 v149, v149
    v_exp_f32 v150, v150
    v_exp_f32 v151, v151
    v_smfmac_f32_32x32x32_bf16 v[64:79], a[60:63], v[136:143], v7
    buffer_load_dwordx4 a[128:131], v3, s[12:15], m0 offen offset:0 sc1
    v_exp_f32 v152, v152
    v_exp_f32 v153, v153
    v_exp_f32 v154, v154
    v_exp_f32 v155, v155
    v_smfmac_f32_32x32x32_bf16 v[80:95], a[56:59], v[144:151], v7
    buffer_load_ushort v247, v161, s[32:35], 0 offen offset:192
    v_exp_f32 v156, v156
    v_exp_f32 v157, v157
    v_exp_f32 v158, v158
    v_exp_f32 v159, v159
    v_mfma_f32_32x32x16_bf16 v[128:143], a[64:67], v[24:27], 0
    buffer_load_dwordx4 a[132:135], v3, s[12:15], m0 offen offset:1024 sc1
    v_exp_f32 v112, v112
    v_exp_f32 v113, v113
    v_exp_f32 v114, v114
    v_exp_f32 v115, v115
    v_mfma_f32_32x32x16_bf16 v[128:143], a[68:71], v[28:31], v[128:143]
    v_exp_f32 v116, v116
    v_exp_f32 v117, v117
    v_exp_f32 v118, v118
    v_exp_f32 v119, v119
    v_smfmac_f32_32x32x32_bf16 v[80:95], a[60:63], v[152:159], v7
    buffer_load_dwordx4 a[136:139], v4, s[12:15], m0 offen sc1
    v_exp_f32 v120, v120
    v_exp_f32 v121, v121
    v_exp_f32 v122, v122
    v_exp_f32 v123, v123
    v_smfmac_f32_32x32x32_bf16 v[48:63], a[72:75], v[112:119], v7
    v_exp_f32 v124, v124
    v_exp_f32 v125, v125
    v_exp_f32 v126, v126
    v_exp_f32 v127, v127
    v_mfma_f32_32x32x16_bf16 v[144:159], a[64:67], v[32:35], 0
    buffer_load_dwordx4 a[140:143], v248, s[12:15], m0 offen sc1
    v_exp_f32 v128, v128
    v_exp_f32 v129, v129
    v_exp_f32 v130, v130
    v_exp_f32 v131, v131
    v_mfma_f32_32x32x16_bf16 v[144:159], a[68:71], v[36:39], v[144:159]
    s_add_u32 m0, s47, 57600
    v_exp_f32 v132, v132
    v_exp_f32 v133, v133
    v_exp_f32 v134, v134
    v_exp_f32 v135, v135
    v_smfmac_f32_32x32x32_bf16 v[48:63], a[76:79], v[120:127], v7
    s_waitcnt vmcnt(19)
    buffer_load_dwordx4 a[144:147], v3, s[12:15], m0 offen offset:0 sc1
    v_exp_f32 v136, v136
    v_exp_f32 v137, v137
    v_exp_f32 v138, v138
    v_exp_f32 v139, v139
    v_smfmac_f32_32x32x32_bf16 v[64:79], a[72:75], v[128:135], v7
    v_exp_f32 v140, v140
    v_exp_f32 v141, v141
    v_exp_f32 v142, v142
    v_exp_f32 v143, v143
    v_mfma_f32_32x32x16_bf16 v[112:127], a[80:83], v[16:19], 0
    buffer_load_dwordx4 a[148:151], v3, s[12:15], m0 offen offset:1024 sc1
    v_exp_f32 v144, v144
    v_exp_f32 v145, v145
    v_exp_f32 v146, v146
    v_exp_f32 v147, v147
    v_mfma_f32_32x32x16_bf16 v[112:127], a[84:87], v[20:23], v[112:127]
    v_exp_f32 v148, v148
    v_exp_f32 v149, v149
    v_exp_f32 v150, v150
    v_exp_f32 v151, v151
    v_smfmac_f32_32x32x32_bf16 v[64:79], a[76:79], v[136:143], v7
    buffer_load_dwordx4 a[152:155], v4, s[12:15], m0 offen sc1
    v_exp_f32 v152, v152
    v_exp_f32 v153, v153
    v_exp_f32 v154, v154
    v_exp_f32 v155, v155
    v_smfmac_f32_32x32x32_bf16 v[80:95], a[72:75], v[144:151], v7
    v_exp_f32 v156, v156
    v_exp_f32 v157, v157
    v_exp_f32 v158, v158
    v_exp_f32 v159, v159
    v_mfma_f32_32x32x16_bf16 v[128:143], a[80:83], v[24:27], 0
    buffer_load_dwordx4 a[156:159], v248, s[12:15], m0 offen sc1
    v_exp_f32 v112, v112
    v_exp_f32 v113, v113
    v_exp_f32 v114, v114
    v_exp_f32 v115, v115
    v_mfma_f32_32x32x16_bf16 v[128:143], a[84:87], v[28:31], v[128:143]
    s_add_u32 m0, s47, 115200
    v_exp_f32 v116, v116
    v_exp_f32 v117, v117
    v_exp_f32 v118, v118
    v_exp_f32 v119, v119
    v_smfmac_f32_32x32x32_bf16 v[80:95], a[76:79], v[152:159], v7
    buffer_load_dwordx4 a[160:163], v3, s[12:15], m0 offen offset:0 sc1
    v_exp_f32 v120, v120
    v_exp_f32 v121, v121
    v_exp_f32 v122, v122
    v_exp_f32 v123, v123
    v_smfmac_f32_32x32x32_bf16 v[48:63], a[88:91], v[112:119], v7
    v_exp_f32 v124, v124
    v_exp_f32 v125, v125
    v_exp_f32 v126, v126
    v_exp_f32 v127, v127
    v_mfma_f32_32x32x16_bf16 v[144:159], a[80:83], v[32:35], 0
    buffer_load_dwordx4 a[164:167], v3, s[12:15], m0 offen offset:1024 sc1
    v_exp_f32 v128, v128
    v_exp_f32 v129, v129
    v_exp_f32 v130, v130
    v_exp_f32 v131, v131
    v_mfma_f32_32x32x16_bf16 v[144:159], a[84:87], v[36:39], v[144:159]
    v_exp_f32 v132, v132
    v_exp_f32 v133, v133
    v_exp_f32 v134, v134
    v_exp_f32 v135, v135
    v_smfmac_f32_32x32x32_bf16 v[48:63], a[92:95], v[120:127], v7
    s_waitcnt vmcnt(16)
    buffer_load_dwordx4 a[168:171], v4, s[12:15], m0 offen sc1
    v_exp_f32 v136, v136
    v_exp_f32 v137, v137
    v_exp_f32 v138, v138
    v_exp_f32 v139, v139
    v_smfmac_f32_32x32x32_bf16 v[64:79], a[88:91], v[128:135], v7
    v_exp_f32 v140, v140
    v_exp_f32 v141, v141
    v_exp_f32 v142, v142
    v_exp_f32 v143, v143
    v_mfma_f32_32x32x16_bf16 v[112:127], a[96:99], v[16:19], 0
    buffer_load_dwordx4 a[172:175], v248, s[12:15], m0 offen sc1
    v_exp_f32 v144, v144
    v_exp_f32 v145, v145
    v_exp_f32 v146, v146
    v_exp_f32 v147, v147
    v_mfma_f32_32x32x16_bf16 v[112:127], a[100:103], v[20:23], v[112:127]
    s_add_u32 m0, s47, 172800
    v_exp_f32 v148, v148
    v_exp_f32 v149, v149
    v_exp_f32 v150, v150
    v_exp_f32 v151, v151
    v_smfmac_f32_32x32x32_bf16 v[64:79], a[92:95], v[136:143], v7
    buffer_load_dwordx4 a[176:179], v3, s[12:15], m0 offen offset:0 sc1
    v_exp_f32 v152, v152
    v_exp_f32 v153, v153
    v_exp_f32 v154, v154
    v_exp_f32 v155, v155
    v_smfmac_f32_32x32x32_bf16 v[80:95], a[88:91], v[144:151], v7
    v_exp_f32 v156, v156
    v_exp_f32 v157, v157
    v_exp_f32 v158, v158
    v_exp_f32 v159, v159
    v_mfma_f32_32x32x16_bf16 v[128:143], a[96:99], v[24:27], 0
    buffer_load_dwordx4 a[180:183], v3, s[12:15], m0 offen offset:1024 sc1
    v_exp_f32 v112, v112
    v_exp_f32 v113, v113
    v_exp_f32 v114, v114
    v_exp_f32 v115, v115
    v_mfma_f32_32x32x16_bf16 v[128:143], a[100:103], v[28:31], v[128:143]
    v_exp_f32 v116, v116
    v_exp_f32 v117, v117
    v_exp_f32 v118, v118
    v_exp_f32 v119, v119
    v_smfmac_f32_32x32x32_bf16 v[80:95], a[92:95], v[152:159], v7
    buffer_load_dwordx4 a[184:187], v4, s[12:15], m0 offen sc1
    v_exp_f32 v120, v120
    v_exp_f32 v121, v121
    v_exp_f32 v122, v122
    v_exp_f32 v123, v123
    v_smfmac_f32_32x32x32_bf16 v[48:63], a[104:107], v[112:119], v7
    v_exp_f32 v124, v124
    v_exp_f32 v125, v125
    v_exp_f32 v126, v126
    v_exp_f32 v127, v127
    v_mfma_f32_32x32x16_bf16 v[144:159], a[96:99], v[32:35], 0
    buffer_load_dwordx4 a[188:191], v248, s[12:15], m0 offen sc1
    v_exp_f32 v128, v128
    v_exp_f32 v129, v129
    v_exp_f32 v130, v130
    v_exp_f32 v131, v131
    v_mfma_f32_32x32x16_bf16 v[144:159], a[100:103], v[36:39], v[144:159]
    s_add_u32 m0, s47, 230400
    v_exp_f32 v132, v132
    v_exp_f32 v133, v133
    v_exp_f32 v134, v134
    v_exp_f32 v135, v135
    v_smfmac_f32_32x32x32_bf16 v[48:63], a[108:111], v[120:127], v7
    buffer_load_dwordx4 a[192:195], v3, s[12:15], m0 offen offset:0 sc1
    v_exp_f32 v136, v136
    v_exp_f32 v137, v137
    v_exp_f32 v138, v138
    v_exp_f32 v139, v139
    v_smfmac_f32_32x32x32_bf16 v[64:79], a[104:107], v[128:135], v7
    v_exp_f32 v140, v140
    v_exp_f32 v141, v141
    v_exp_f32 v142, v142
    v_exp_f32 v143, v143
    v_mfma_f32_32x32x16_bf16 v[112:127], a[112:115], v[16:19], 0
    buffer_load_dwordx4 a[196:199], v3, s[12:15], m0 offen offset:1024 sc1
    v_exp_f32 v144, v144
    v_exp_f32 v145, v145
    v_exp_f32 v146, v146
    v_exp_f32 v147, v147
    v_mfma_f32_32x32x16_bf16 v[112:127], a[116:119], v[20:23], v[112:127]
    v_exp_f32 v148, v148
    v_exp_f32 v149, v149
    v_exp_f32 v150, v150
    v_exp_f32 v151, v151
    v_smfmac_f32_32x32x32_bf16 v[64:79], a[108:111], v[136:143], v7
    buffer_load_dwordx4 a[200:203], v4, s[12:15], m0 offen sc1
    v_exp_f32 v152, v152
    v_exp_f32 v153, v153
    v_exp_f32 v154, v154
    v_exp_f32 v155, v155
    v_smfmac_f32_32x32x32_bf16 v[80:95], a[104:107], v[144:151], v7
    v_exp_f32 v156, v156
    v_exp_f32 v157, v157
    v_exp_f32 v158, v158
    v_exp_f32 v159, v159
    v_mfma_f32_32x32x16_bf16 v[128:143], a[112:115], v[24:27], 0
    buffer_load_dwordx4 a[204:207], v248, s[12:15], m0 offen sc1
    v_exp_f32 v112, v112
    v_exp_f32 v113, v113
    v_exp_f32 v114, v114
    v_exp_f32 v115, v115
    v_mfma_f32_32x32x16_bf16 v[128:143], a[116:119], v[28:31], v[128:143]
    s_add_u32 m0, s47, 288000
    v_exp_f32 v116, v116
    v_exp_f32 v117, v117
    v_exp_f32 v118, v118
    v_exp_f32 v119, v119
    v_smfmac_f32_32x32x32_bf16 v[80:95], a[108:111], v[152:159], v7
    buffer_load_dwordx4 a[208:211], v3, s[12:15], m0 offen offset:0 sc1
    v_exp_f32 v120, v120
    v_exp_f32 v121, v121
    v_exp_f32 v122, v122
    v_exp_f32 v123, v123
    v_smfmac_f32_32x32x32_bf16 v[48:63], a[120:123], v[112:119], v7
    v_exp_f32 v124, v124
    v_exp_f32 v125, v125
    v_exp_f32 v126, v126
    v_exp_f32 v127, v127
    v_mfma_f32_32x32x16_bf16 v[144:159], a[112:115], v[32:35], 0
    buffer_load_dwordx4 a[212:215], v3, s[12:15], m0 offen offset:1024 sc1
    v_exp_f32 v128, v128
    v_exp_f32 v129, v129
    v_exp_f32 v130, v130
    v_exp_f32 v131, v131
    v_mfma_f32_32x32x16_bf16 v[144:159], a[116:119], v[36:39], v[144:159]
    v_exp_f32 v132, v132
    v_exp_f32 v133, v133
    v_exp_f32 v134, v134
    v_exp_f32 v135, v135
    v_smfmac_f32_32x32x32_bf16 v[48:63], a[124:127], v[120:127], v7
    s_waitcnt vmcnt(14)
    buffer_load_dwordx4 a[216:219], v4, s[12:15], m0 offen sc1
    v_exp_f32 v136, v136
    v_exp_f32 v137, v137
    v_exp_f32 v138, v138
    v_exp_f32 v139, v139
    v_smfmac_f32_32x32x32_bf16 v[64:79], a[120:123], v[128:135], v7
    v_exp_f32 v140, v140
    v_exp_f32 v141, v141
    v_exp_f32 v142, v142
    v_exp_f32 v143, v143
    v_mfma_f32_32x32x16_bf16 v[112:127], a[128:131], v[16:19], 0
    buffer_load_dwordx4 a[220:223], v248, s[12:15], m0 offen sc1
    v_exp_f32 v144, v144
    v_exp_f32 v145, v145
    v_exp_f32 v146, v146
    v_exp_f32 v147, v147
    v_mfma_f32_32x32x16_bf16 v[112:127], a[132:135], v[20:23], v[112:127]
    s_add_u32 m0, s47, 345600
    v_exp_f32 v148, v148
    v_exp_f32 v149, v149
    v_exp_f32 v150, v150
    v_exp_f32 v151, v151
    v_smfmac_f32_32x32x32_bf16 v[64:79], a[124:127], v[136:143], v7
    buffer_load_dwordx4 a[224:227], v3, s[12:15], m0 offen offset:0 sc1
    v_exp_f32 v152, v152
    v_exp_f32 v153, v153
    v_exp_f32 v154, v154
    v_exp_f32 v155, v155
    v_smfmac_f32_32x32x32_bf16 v[80:95], a[120:123], v[144:151], v7
    v_exp_f32 v156, v156
    v_exp_f32 v157, v157
    v_exp_f32 v158, v158
    v_exp_f32 v159, v159
    v_mfma_f32_32x32x16_bf16 v[128:143], a[128:131], v[24:27], 0
    buffer_load_dwordx4 a[228:231], v3, s[12:15], m0 offen offset:1024 sc1
    v_exp_f32 v112, v112
    v_exp_f32 v113, v113
    v_exp_f32 v114, v114
    v_exp_f32 v115, v115
    v_mfma_f32_32x32x16_bf16 v[128:143], a[132:135], v[28:31], v[128:143]
    v_exp_f32 v116, v116
    v_exp_f32 v117, v117
    v_exp_f32 v118, v118
    v_exp_f32 v119, v119
    v_smfmac_f32_32x32x32_bf16 v[80:95], a[124:127], v[152:159], v7
    buffer_load_dwordx4 a[232:235], v4, s[12:15], m0 offen sc1
    v_exp_f32 v120, v120
    v_exp_f32 v121, v121
    v_exp_f32 v122, v122
    v_exp_f32 v123, v123
    v_smfmac_f32_32x32x32_bf16 v[48:63], a[136:139], v[112:119], v7
    v_exp_f32 v124, v124
    v_exp_f32 v125, v125
    v_exp_f32 v126, v126
    v_exp_f32 v127, v127
    v_mfma_f32_32x32x16_bf16 v[144:159], a[128:131], v[32:35], 0
    buffer_load_dwordx4 a[236:239], v248, s[12:15], m0 offen sc1
    v_exp_f32 v128, v128
    v_exp_f32 v129, v129
    v_exp_f32 v130, v130
    v_exp_f32 v131, v131
    v_mfma_f32_32x32x16_bf16 v[144:159], a[132:135], v[36:39], v[144:159]
    s_add_u32 m0, s47, 403200
    v_exp_f32 v132, v132
    v_exp_f32 v133, v133
    v_exp_f32 v134, v134
    v_exp_f32 v135, v135
    v_smfmac_f32_32x32x32_bf16 v[48:63], a[140:143], v[120:127], v7
    buffer_load_dwordx4 a[240:243], v3, s[12:15], m0 offen offset:0 sc1
    v_exp_f32 v136, v136
    v_exp_f32 v137, v137
    v_exp_f32 v138, v138
    v_exp_f32 v139, v139
    v_smfmac_f32_32x32x32_bf16 v[64:79], a[136:139], v[128:135], v7
    v_exp_f32 v140, v140
    v_exp_f32 v141, v141
    v_exp_f32 v142, v142
    v_exp_f32 v143, v143
    v_mfma_f32_32x32x16_bf16 v[112:127], a[144:147], v[16:19], 0
    buffer_load_dwordx4 a[244:247], v3, s[12:15], m0 offen offset:1024 sc1
    v_exp_f32 v144, v144
    v_exp_f32 v145, v145
    v_exp_f32 v146, v146
    v_exp_f32 v147, v147
    v_mfma_f32_32x32x16_bf16 v[112:127], a[148:151], v[20:23], v[112:127]
    v_exp_f32 v148, v148
    v_exp_f32 v149, v149
    v_exp_f32 v150, v150
    v_exp_f32 v151, v151
    v_smfmac_f32_32x32x32_bf16 v[64:79], a[140:143], v[136:143], v7
    buffer_load_dwordx4 a[248:251], v4, s[12:15], m0 offen sc1
    v_exp_f32 v152, v152
    v_exp_f32 v153, v153
    v_exp_f32 v154, v154
    v_exp_f32 v155, v155
    v_smfmac_f32_32x32x32_bf16 v[80:95], a[136:139], v[144:151], v7
    v_exp_f32 v156, v156
    v_exp_f32 v157, v157
    v_exp_f32 v158, v158
    v_exp_f32 v159, v159
    v_mfma_f32_32x32x16_bf16 v[128:143], a[144:147], v[24:27], 0
    buffer_load_dwordx4 a[252:255], v248, s[12:15], m0 offen sc1
    v_exp_f32 v112, v112
    v_exp_f32 v113, v113
    v_exp_f32 v114, v114
    v_exp_f32 v115, v115
    v_mfma_f32_32x32x16_bf16 v[128:143], a[148:151], v[28:31], v[128:143]
    s_mov_b32 m0, s27
    v_exp_f32 v116, v116
    v_exp_f32 v117, v117
    v_exp_f32 v118, v118
    v_exp_f32 v119, v119
    v_smfmac_f32_32x32x32_bf16 v[80:95], a[140:143], v[152:159], v7
    buffer_load_dwordx4 v[224:227], v0, s[4:7], m0 offen offset:0
    v_exp_f32 v120, v120
    v_exp_f32 v121, v121
    v_exp_f32 v122, v122
    v_exp_f32 v123, v123
    v_smfmac_f32_32x32x32_bf16 v[48:63], a[152:155], v[112:119], v7
    v_exp_f32 v124, v124
    v_exp_f32 v125, v125
    v_exp_f32 v126, v126
    v_exp_f32 v127, v127
    v_mfma_f32_32x32x16_bf16 v[144:159], a[144:147], v[32:35], 0
    buffer_load_dwordx4 v[228:231], v0, s[4:7], m0 offen offset:64
    v_exp_f32 v128, v128
    v_exp_f32 v129, v129
    v_exp_f32 v130, v130
    v_exp_f32 v131, v131
    v_mfma_f32_32x32x16_bf16 v[144:159], a[148:151], v[36:39], v[144:159]
    s_add_u32 m0, s59, 0
    v_exp_f32 v132, v132
    v_exp_f32 v133, v133
    v_exp_f32 v134, v134
    v_exp_f32 v135, v135
    v_smfmac_f32_32x32x32_bf16 v[48:63], a[156:159], v[120:127], v7
    s_waitcnt vmcnt(18)
    buffer_load_dwordx4 v165, s[8:11], 0 offen offset:0 lds
    v_exp_f32 v136, v136
    v_exp_f32 v137, v137
    v_exp_f32 v138, v138
    v_exp_f32 v139, v139
    v_smfmac_f32_32x32x32_bf16 v[64:79], a[152:155], v[128:135], v7
    v_exp_f32 v140, v140
    v_exp_f32 v141, v141
    v_exp_f32 v142, v142
    v_exp_f32 v143, v143
    v_mfma_f32_32x32x16_bf16 v[112:127], a[160:163], v[16:19], 0
    buffer_load_dwordx4 v166, s[8:11], 0 offen offset:1024 lds
    v_exp_f32 v144, v144
    v_exp_f32 v145, v145
    v_exp_f32 v146, v146
    v_exp_f32 v147, v147
    v_mfma_f32_32x32x16_bf16 v[112:127], a[164:167], v[20:23], v[112:127]
    v_exp_f32 v148, v148
    v_exp_f32 v149, v149
    v_exp_f32 v150, v150
    v_exp_f32 v151, v151
    v_smfmac_f32_32x32x32_bf16 v[64:79], a[156:159], v[136:143], v7
    buffer_load_dwordx4 v167, s[8:11], 0 offen offset:2048 lds
    v_exp_f32 v152, v152
    v_exp_f32 v153, v153
    v_exp_f32 v154, v154
    v_exp_f32 v155, v155
    v_smfmac_f32_32x32x32_bf16 v[80:95], a[152:155], v[144:151], v7
    v_exp_f32 v156, v156
    v_exp_f32 v157, v157
    v_exp_f32 v158, v158
    v_exp_f32 v159, v159
    v_mfma_f32_32x32x16_bf16 v[128:143], a[160:163], v[24:27], 0
    buffer_load_dwordx4 v168, s[8:11], 0 offen offset:3072 lds
    v_exp_f32 v112, v112
    v_exp_f32 v113, v113
    v_exp_f32 v114, v114
    v_exp_f32 v115, v115
    v_mfma_f32_32x32x16_bf16 v[128:143], a[164:167], v[28:31], v[128:143]
    s_add_u32 m0, s59, 16384
    v_exp_f32 v116, v116
    v_exp_f32 v117, v117
    v_exp_f32 v118, v118
    v_exp_f32 v119, v119
    v_smfmac_f32_32x32x32_bf16 v[80:95], a[156:159], v[152:159], v7
    s_add_u32 s8, s8, 229376
    s_addc_u32 s9, s9, 0
    buffer_load_dwordx4 v165, s[8:11], 0 offen offset:0 lds
    v_exp_f32 v120, v120
    v_exp_f32 v121, v121
    v_exp_f32 v122, v122
    v_exp_f32 v123, v123
    v_smfmac_f32_32x32x32_bf16 v[48:63], a[168:171], v[112:119], v7
L_w1_0:
    s_cbranch_execz L_w1_r
    v_exp_f32 v124, v124
    v_exp_f32 v125, v125
    v_exp_f32 v126, v126
    v_exp_f32 v127, v127
    v_mfma_f32_32x32x16_bf16 v[144:159], a[160:163], v[32:35], 0
    buffer_load_dwordx4 v166, s[8:11], 0 offen offset:1024 lds
    v_exp_f32 v128, v128
    v_exp_f32 v129, v129
    v_exp_f32 v130, v130
    v_exp_f32 v131, v131
    v_mfma_f32_32x32x16_bf16 v[144:159], a[164:167], v[36:39], v[144:159]
    v_exp_f32 v132, v132
    v_exp_f32 v133, v133
    v_exp_f32 v134, v134
    v_exp_f32 v135, v135
    v_smfmac_f32_32x32x32_bf16 v[48:63], a[172:175], v[120:127], v7
    buffer_load_dwordx4 v167, s[8:11], 0 offen offset:2048 lds
    v_exp_f32 v136, v136
    v_exp_f32 v137, v137
    v_exp_f32 v138, v138
    v_exp_f32 v139, v139
    v_smfmac_f32_32x32x32_bf16 v[64:79], a[168:171], v[128:135], v7
    v_exp_f32 v140, v140
    v_exp_f32 v141, v141
    v_exp_f32 v142, v142
    v_exp_f32 v143, v143
    v_mfma_f32_32x32x16_bf16 v[112:127], a[176:179], v[16:19], 0
    buffer_load_dwordx4 v168, s[8:11], 0 offen offset:3072 lds
    v_exp_f32 v144, v144
    v_exp_f32 v145, v145
    v_exp_f32 v146, v146
    v_exp_f32 v147, v147
    v_mfma_f32_32x32x16_bf16 v[112:127], a[180:183], v[20:23], v[112:127]
    s_add_u32 m0, s59, 32768
    v_exp_f32 v148, v148
    v_exp_f32 v149, v149
    v_exp_f32 v150, v150
    v_exp_f32 v151, v151
    v_smfmac_f32_32x32x32_bf16 v[64:79], a[172:175], v[136:143], v7
    s_add_u32 s8, s8, 229376
    s_addc_u32 s9, s9, 0
    buffer_load_dwordx4 v165, s[8:11], 0 offen offset:0 lds
    v_exp_f32 v152, v152
    v_exp_f32 v153, v153
    v_exp_f32 v154, v154
    v_exp_f32 v155, v155
    v_smfmac_f32_32x32x32_bf16 v[80:95], a[168:171], v[144:151], v7
    v_exp_f32 v156, v156
    v_exp_f32 v157, v157
    v_exp_f32 v158, v158
    v_exp_f32 v159, v159
    v_mfma_f32_32x32x16_bf16 v[128:143], a[176:179], v[24:27], 0
    buffer_load_dwordx4 v166, s[8:11], 0 offen offset:1024 lds
    v_exp_f32 v112, v112
    v_exp_f32 v113, v113
    v_exp_f32 v114, v114
    v_exp_f32 v115, v115
    v_mfma_f32_32x32x16_bf16 v[128:143], a[180:183], v[28:31], v[128:143]
    v_exp_f32 v116, v116
    v_exp_f32 v117, v117
    v_exp_f32 v118, v118
    v_exp_f32 v119, v119
    v_smfmac_f32_32x32x32_bf16 v[80:95], a[172:175], v[152:159], v7
    buffer_load_dwordx4 v167, s[8:11], 0 offen offset:2048 lds
    v_exp_f32 v120, v120
    v_exp_f32 v121, v121
    v_exp_f32 v122, v122
    v_exp_f32 v123, v123
    v_smfmac_f32_32x32x32_bf16 v[48:63], a[184:187], v[112:119], v7
    v_exp_f32 v124, v124
    v_exp_f32 v125, v125
    v_exp_f32 v126, v126
    v_exp_f32 v127, v127
    v_mfma_f32_32x32x16_bf16 v[144:159], a[176:179], v[32:35], 0
    buffer_load_dwordx4 v168, s[8:11], 0 offen offset:3072 lds
    v_exp_f32 v128, v128
    v_exp_f32 v129, v129
    v_exp_f32 v130, v130
    v_exp_f32 v131, v131
    v_mfma_f32_32x32x16_bf16 v[144:159], a[180:183], v[36:39], v[144:159]
    s_add_u32 m0, s59, 49152
    v_exp_f32 v132, v132
    v_exp_f32 v133, v133
    v_exp_f32 v134, v134
    v_exp_f32 v135, v135
    v_smfmac_f32_32x32x32_bf16 v[48:63], a[188:191], v[120:127], v7
    s_add_u32 s8, s8, 229376
    s_addc_u32 s9, s9, 0
    s_waitcnt vmcnt(22)
    buffer_load_dwordx4 v165, s[8:11], 0 offen offset:0 lds
    v_exp_f32 v136, v136
    v_exp_f32 v137, v137
    v_exp_f32 v138, v138
    v_exp_f32 v139, v139
    v_smfmac_f32_32x32x32_bf16 v[64:79], a[184:187], v[128:135], v7
    v_exp_f32 v140, v140
    v_exp_f32 v141, v141
    v_exp_f32 v142, v142
    v_exp_f32 v143, v143
    v_mfma_f32_32x32x16_bf16 v[112:127], a[192:195], v[16:19], 0
    buffer_load_dwordx4 v166, s[8:11], 0 offen offset:1024 lds
    v_exp_f32 v144, v144
    v_exp_f32 v145, v145
    v_exp_f32 v146, v146
    v_exp_f32 v147, v147
    v_mfma_f32_32x32x16_bf16 v[112:127], a[196:199], v[20:23], v[112:127]
    v_exp_f32 v148, v148
    v_exp_f32 v149, v149
    v_exp_f32 v150, v150
    v_exp_f32 v151, v151
    v_smfmac_f32_32x32x32_bf16 v[64:79], a[188:191], v[136:143], v7
    buffer_load_dwordx4 v167, s[8:11], 0 offen offset:2048 lds
    v_exp_f32 v152, v152
    v_exp_f32 v153, v153
    v_exp_f32 v154, v154
    v_exp_f32 v155, v155
    v_smfmac_f32_32x32x32_bf16 v[80:95], a[184:187], v[144:151], v7
    v_exp_f32 v156, v156
    v_exp_f32 v157, v157
    v_exp_f32 v158, v158
    v_exp_f32 v159, v159
    v_mfma_f32_32x32x16_bf16 v[128:143], a[192:195], v[24:27], 0
    buffer_load_dwordx4 v168, s[8:11], 0 offen offset:3072 lds
    v_exp_f32 v112, v112
    v_exp_f32 v113, v113
    v_exp_f32 v114, v114
    v_exp_f32 v115, v115
    v_mfma_f32_32x32x16_bf16 v[128:143], a[196:199], v[28:31], v[128:143]
    v_exp_f32 v116, v116
    v_exp_f32 v117, v117
    v_exp_f32 v118, v118
    v_exp_f32 v119, v119
    v_smfmac_f32_32x32x32_bf16 v[80:95], a[188:191], v[152:159], v7
    s_mov_b32 exec_lo, 0xfff00000
    buffer_load_dword v243, v241, s[12:15], 0 offen sc1
    s_mov_b32 exec_lo, -1
    v_exp_f32 v120, v120
    v_exp_f32 v121, v121
    v_exp_f32 v122, v122
    v_exp_f32 v123, v123
    v_smfmac_f32_32x32x32_bf16 v[48:63], a[200:203], v[112:119], v7
    s_add_u32 m0, s59, 65536
    v_exp_f32 v124, v124
    v_exp_f32 v125, v125
    v_exp_f32 v126, v126
    v_exp_f32 v127, v127
    v_mfma_f32_32x32x16_bf16 v[144:159], a[192:195], v[32:35], 0
    s_add_u32 s8, s8, 229376
    s_addc_u32 s9, s9, 0
    buffer_load_dwordx4 v165, s[8:11], 0 offen offset:0 lds
    v_exp_f32 v128, v128
    v_exp_f32 v129, v129
    v_exp_f32 v130, v130
    v_exp_f32 v131, v131
    v_mfma_f32_32x32x16_bf16 v[144:159], a[196:199], v[36:39], v[144:159]
    v_exp_f32 v132, v132
    v_exp_f32 v133, v133
    v_exp_f32 v134, v134
    v_exp_f32 v135, v135
    v_smfmac_f32_32x32x32_bf16 v[48:63], a[204:207], v[120:127], v7
    buffer_load_dwordx4 v166, s[8:11], 0 offen offset:1024 lds
    v_exp_f32 v136, v136
    v_exp_f32 v137, v137
    v_exp_f32 v138, v138
    v_exp_f32 v139, v139
    v_smfmac_f32_32x32x32_bf16 v[64:79], a[200:203], v[128:135], v7
    v_exp_f32 v140, v140
    v_exp_f32 v141, v141
    v_exp_f32 v142, v142
    v_exp_f32 v143, v143
    v_mfma_f32_32x32x16_bf16 v[112:127], a[208:211], v[16:19], 0
    buffer_load_dwordx4 v167, s[8:11], 0 offen offset:2048 lds
    v_exp_f32 v144, v144
    v_exp_f32 v145, v145
    v_exp_f32 v146, v146
    v_exp_f32 v147, v147
    v_mfma_f32_32x32x16_bf16 v[112:127], a[212:215], v[20:23], v[112:127]
    v_exp_f32 v148, v148
    v_exp_f32 v149, v149
    v_exp_f32 v150, v150
    v_exp_f32 v151, v151
    v_smfmac_f32_32x32x32_bf16 v[64:79], a[204:207], v[136:143], v7
    buffer_load_dwordx4 v168, s[8:11], 0 offen offset:3072 lds
    v_exp_f32 v152, v152
    v_exp_f32 v153, v153
    v_exp_f32 v154, v154
    v_exp_f32 v155, v155
    v_smfmac_f32_32x32x32_bf16 v[80:95], a[200:203], v[144:151], v7
    s_add_u32 m0, s59, 81920
    v_exp_f32 v156, v156
    v_exp_f32 v157, v157
    v_exp_f32 v158, v158
    v_exp_f32 v159, v159
    v_mfma_f32_32x32x16_bf16 v[128:143], a[208:211], v[24:27], 0
    s_add_u32 s8, s8, 229376
    s_addc_u32 s9, s9, 0
    buffer_load_dwordx4 v165, s[8:11], 0 offen offset:0 lds
    v_exp_f32 v112, v112
    v_exp_f32 v113, v113
    v_exp_f32 v114, v114
    v_exp_f32 v115, v115
    v_mfma_f32_32x32x16_bf16 v[128:143], a[212:215], v[28:31], v[128:143]
    v_exp_f32 v116, v116
    v_exp_f32 v117, v117
    v_exp_f32 v118, v118
    v_exp_f32 v119, v119
    v_smfmac_f32_32x32x32_bf16 v[80:95], a[204:207], v[152:159], v7
    buffer_load_dwordx4 v166, s[8:11], 0 offen offset:1024 lds
    v_exp_f32 v120, v120
    v_exp_f32 v121, v121
    v_exp_f32 v122, v122
    v_exp_f32 v123, v123
    v_smfmac_f32_32x32x32_bf16 v[48:63], a[216:219], v[112:119], v7
    v_exp_f32 v124, v124
    v_exp_f32 v125, v125
    v_exp_f32 v126, v126
    v_exp_f32 v127, v127
    v_mfma_f32_32x32x16_bf16 v[144:159], a[208:211], v[32:35], 0
    buffer_load_dwordx4 v167, s[8:11], 0 offen offset:2048 lds
    v_exp_f32 v128, v128
    v_exp_f32 v129, v129
    v_exp_f32 v130, v130
    v_exp_f32 v131, v131
    v_mfma_f32_32x32x16_bf16 v[144:159], a[212:215], v[36:39], v[144:159]
    v_exp_f32 v132, v132
    v_exp_f32 v133, v133
    v_exp_f32 v134, v134
    v_exp_f32 v135, v135
    v_smfmac_f32_32x32x32_bf16 v[48:63], a[220:223], v[120:127], v7
    s_waitcnt vmcnt(26)
    buffer_load_dwordx4 v168, s[8:11], 0 offen offset:3072 lds
    v_exp_f32 v136, v136
    v_exp_f32 v137, v137
    v_exp_f32 v138, v138
    v_exp_f32 v139, v139
    v_smfmac_f32_32x32x32_bf16 v[64:79], a[216:219], v[128:135], v7
    s_add_u32 m0, s59, 98304
    v_exp_f32 v140, v140
    v_exp_f32 v141, v141
    v_exp_f32 v142, v142
    v_exp_f32 v143, v143
    v_mfma_f32_32x32x16_bf16 v[112:127], a[224:227], v[16:19], 0
    s_add_u32 s8, s8, 229376
    s_addc_u32 s9, s9, 0
    buffer_load_dwordx4 v165, s[8:11], 0 offen offset:0 lds
    v_exp_f32 v144, v144
    v_exp_f32 v145, v145
    v_exp_f32 v146, v146
    v_exp_f32 v147, v147
    v_mfma_f32_32x32x16_bf16 v[112:127], a[228:231], v[20:23], v[112:127]
    v_exp_f32 v148, v148
    v_exp_f32 v149, v149
    v_exp_f32 v150, v150
    v_exp_f32 v151, v151
    v_smfmac_f32_32x32x32_bf16 v[64:79], a[220:223], v[136:143], v7
    buffer_load_dwordx4 v166, s[8:11], 0 offen offset:1024 lds
    v_exp_f32 v152, v152
    v_exp_f32 v153, v153
    v_exp_f32 v154, v154
    v_exp_f32 v155, v155
    v_smfmac_f32_32x32x32_bf16 v[80:95], a[216:219], v[144:151], v7
    v_exp_f32 v156, v156
    v_exp_f32 v157, v157
    v_exp_f32 v158, v158
    v_exp_f32 v159, v159
    v_mfma_f32_32x32x16_bf16 v[128:143], a[224:227], v[24:27], 0
    buffer_load_dwordx4 v167, s[8:11], 0 offen offset:2048 lds
    v_exp_f32 v112, v112
    v_exp_f32 v113, v113
    v_exp_f32 v114, v114
    v_exp_f32 v115, v115
    v_mfma_f32_32x32x16_bf16 v[128:143], a[228:231], v[28:31], v[128:143]
    s_waitcnt vmcnt(11)
    v_cmp_gt_u32 vcc, 2, v243
    s_nop 0
    s_lshr_b32 s26, vcc_hi, 16
    s_cbranch_scc1 L_wf
L_wfd:
    v_exp_f32 v116, v116
    v_exp_f32 v117, v117
    v_exp_f32 v118, v118
    v_exp_f32 v119, v119
    v_smfmac_f32_32x32x32_bf16 v[80:95], a[220:223], v[152:159], v7
    buffer_load_dwordx4 v168, s[8:11], 0 offen offset:3072 lds
    v_exp_f32 v120, v120
    v_exp_f32 v121, v121
    v_exp_f32 v122, v122
    v_exp_f32 v123, v123
    v_smfmac_f32_32x32x32_bf16 v[48:63], a[232:235], v[112:119], v7
    s_add_u32 m0, s44, 0
    v_exp_f32 v124, v124
    v_exp_f32 v125, v125
    v_exp_f32 v126, v126
    v_exp_f32 v127, v127
    v_mfma_f32_32x32x16_bf16 v[144:159], a[224:227], v[32:35], 0
    buffer_load_dwordx4 v[160:163], v2, s[12:15], m0 offen offset:0 sc1
    v_exp_f32 v128, v128
    v_exp_f32 v129, v129
    v_exp_f32 v130, v130
    v_exp_f32 v131, v131
    v_mfma_f32_32x32x16_bf16 v[144:159], a[228:231], v[36:39], v[144:159]
    v_exp_f32 v132, v132
    v_exp_f32 v133, v133
    v_exp_f32 v134, v134
    v_exp_f32 v135, v135
    v_smfmac_f32_32x32x32_bf16 v[48:63], a[236:239], v[120:127], v7
    buffer_load_dwordx4 v[164:167], v2, s[12:15], m0 offen offset:1024 sc1
    v_exp_f32 v136, v136
    v_exp_f32 v137, v137
    v_exp_f32 v138, v138
    v_exp_f32 v139, v139
    v_smfmac_f32_32x32x32_bf16 v[64:79], a[232:235], v[128:135], v7
    v_exp_f32 v140, v140
    v_exp_f32 v141, v141
    v_exp_f32 v142, v142
    v_exp_f32 v143, v143
    v_mfma_f32_32x32x16_bf16 v[112:127], a[240:243], v[16:19], 0
    buffer_load_dwordx4 v[168:171], v2, s[12:15], m0 offen offset:2048 sc1
    v_exp_f32 v144, v144
    v_exp_f32 v145, v145
    v_exp_f32 v146, v146
    v_exp_f32 v147, v147
    v_mfma_f32_32x32x16_bf16 v[112:127], a[244:247], v[20:23], v[112:127]
    v_exp_f32 v148, v148
    v_exp_f32 v149, v149
    v_exp_f32 v150, v150
    v_exp_f32 v151, v151
    v_smfmac_f32_32x32x32_bf16 v[64:79], a[236:239], v[136:143], v7
    buffer_load_dwordx4 v[172:175], v2, s[12:15], m0 offen offset:3072 sc1
    v_exp_f32 v152, v152
    v_exp_f32 v153, v153
    v_exp_f32 v154, v154
    v_exp_f32 v155, v155
    v_smfmac_f32_32x32x32_bf16 v[80:95], a[232:235], v[144:151], v7
    s_add_u32 m0, s44, 4096
    v_exp_f32 v156, v156
    v_exp_f32 v157, v157
    v_exp_f32 v158, v158
    v_exp_f32 v159, v159
    v_mfma_f32_32x32x16_bf16 v[128:143], a[240:243], v[24:27], 0
    buffer_load_dwordx4 v[176:179], v2, s[12:15], m0 offen offset:0 sc1
    v_exp_f32 v112, v112
    v_exp_f32 v113, v113
    v_exp_f32 v114, v114
    v_exp_f32 v115, v115
    v_mfma_f32_32x32x16_bf16 v[128:143], a[244:247], v[28:31], v[128:143]
    v_exp_f32 v116, v116
    v_exp_f32 v117, v117
    v_exp_f32 v118, v118
    v_exp_f32 v119, v119
    v_smfmac_f32_32x32x32_bf16 v[80:95], a[236:239], v[152:159], v7
    buffer_load_dwordx4 v[180:183], v2, s[12:15], m0 offen offset:1024 sc1
    v_exp_f32 v120, v120
    v_exp_f32 v121, v121
    v_exp_f32 v122, v122
    v_exp_f32 v123, v123
    v_smfmac_f32_32x32x32_bf16 v[48:63], a[248:251], v[112:119], v7
    v_exp_f32 v124, v124
    v_exp_f32 v125, v125
    v_exp_f32 v126, v126
    v_exp_f32 v127, v127
    v_mfma_f32_32x32x16_bf16 v[144:159], a[240:243], v[32:35], 0
    buffer_load_dwordx4 v[184:187], v2, s[12:15], m0 offen offset:2048 sc1
    v_exp_f32 v128, v128
    v_exp_f32 v129, v129
    v_exp_f32 v130, v130
    v_exp_f32 v131, v131
    v_mfma_f32_32x32x16_bf16 v[144:159], a[244:247], v[36:39], v[144:159]
    v_exp_f32 v132, v132
    v_exp_f32 v133, v133
    v_exp_f32 v134, v134
    v_exp_f32 v135, v135
    v_smfmac_f32_32x32x32_bf16 v[48:63], a[252:255], v[120:127], v7
    buffer_load_dwordx4 v[188:191], v2, s[12:15], m0 offen offset:3072 sc1
    v_exp_f32 v136, v136
    v_exp_f32 v137, v137
    v_exp_f32 v138, v138
    v_exp_f32 v139, v139
    v_smfmac_f32_32x32x32_bf16 v[64:79], a[248:251], v[128:135], v7
    s_add_u32 m0, s44, 8192
    v_exp_f32 v140, v140
    v_exp_f32 v141, v141
    v_exp_f32 v142, v142
    v_exp_f32 v143, v143
    v_mfma_f32_32x32x16_bf16 v[112:127], a[0:3], v[40:43], 0
    buffer_load_dwordx4 v[192:195], v2, s[12:15], m0 offen offset:0 sc1
    v_exp_f32 v144, v144
    v_exp_f32 v145, v145
    v_exp_f32 v146, v146
    v_exp_f32 v147, v147
    v_mfma_f32_32x32x16_bf16 v[112:127], a[4:7], v[44:47], v[112:127]
    v_exp_f32 v148, v148
    v_exp_f32 v149, v149
    v_exp_f32 v150, v150
    v_exp_f32 v151, v151
    v_smfmac_f32_32x32x32_bf16 v[64:79], a[252:255], v[136:143], v7
    buffer_load_dwordx4 v[196:199], v2, s[12:15], m0 offen offset:1024 sc1
    v_exp_f32 v152, v152
    v_exp_f32 v153, v153
    v_exp_f32 v154, v154
    v_exp_f32 v155, v155
    v_smfmac_f32_32x32x32_bf16 v[80:95], a[248:251], v[144:151], v7
    v_exp_f32 v156, v156
    v_exp_f32 v157, v157
    v_exp_f32 v158, v158
    v_exp_f32 v159, v159
    v_mfma_f32_32x32x16_bf16 v[128:143], a[16:19], v[40:43], 0
    buffer_load_dwordx4 v[200:203], v2, s[12:15], m0 offen offset:2048 sc1
    v_exp_f32 v112, v112
    v_exp_f32 v113, v113
    v_exp_f32 v114, v114
    v_exp_f32 v115, v115
    v_mfma_f32_32x32x16_bf16 v[128:143], a[20:23], v[44:47], v[128:143]
    v_exp_f32 v116, v116
    v_exp_f32 v117, v117
    v_exp_f32 v118, v118
    v_exp_f32 v119, v119
    v_smfmac_f32_32x32x32_bf16 v[80:95], a[252:255], v[152:159], v7
    buffer_load_dwordx4 v[204:207], v2, s[12:15], m0 offen offset:3072 sc1
    v_exp_f32 v120, v120
    v_exp_f32 v121, v121
    v_exp_f32 v122, v122
    v_exp_f32 v123, v123
    v_smfmac_f32_32x32x32_bf16 v[96:111], a[8:11], v[112:119], v7
    s_add_u32 m0, s44, 12288
    v_exp_f32 v124, v124
    v_exp_f32 v125, v125
    v_exp_f32 v126, v126
    v_exp_f32 v127, v127
    v_mfma_f32_32x32x16_bf16 v[144:159], a[32:35], v[40:43], 0
    buffer_load_dwordx4 v[208:211], v2, s[12:15], m0 offen offset:0 sc1
    v_exp_f32 v128, v128
    v_exp_f32 v129, v129
    v_exp_f32 v130, v130
    v_exp_f32 v131, v131
    v_mfma_f32_32x32x16_bf16 v[144:159], a[36:39], v[44:47], v[144:159]
    v_exp_f32 v132, v132
    v_exp_f32 v133, v133
    v_exp_f32 v134, v134
    v_exp_f32 v135, v135
    v_smfmac_f32_32x32x32_bf16 v[96:111], a[12:15], v[120:127], v7
    buffer_load_dwordx4 v[212:215], v2, s[12:15], m0 offen offset:1024 sc1
    v_exp_f32 v136, v136
    v_exp_f32 v137, v137
    v_exp_f32 v138, v138
    v_exp_f32 v139, v139
    v_smfmac_f32_32x32x32_bf16 v[96:111], a[24:27], v[128:135], v7
    global_load_dword v242, v13, s[80:81]
    v_exp_f32 v140, v140
    v_exp_f32 v141, v141
    v_exp_f32 v142, v142
    v_exp_f32 v143, v143
    v_mfma_f32_32x32x16_bf16 v[112:127], a[48:51], v[40:43], 0
    buffer_load_dwordx4 v[216:219], v2, s[12:15], m0 offen offset:2048 sc1
    v_exp_f32 v144, v144
    v_exp_f32 v145, v145
    v_exp_f32 v146, v146
    v_exp_f32 v147, v147
    v_mfma_f32_32x32x16_bf16 v[112:127], a[52:55], v[44:47], v[112:127]
    ds_write_b128 v9, v[48:51] offset:0
    v_exp_f32 v148, v148
    v_exp_f32 v149, v149
    v_exp_f32 v150, v150
    v_exp_f32 v151, v151
    v_smfmac_f32_32x32x32_bf16 v[96:111], a[28:31], v[136:143], v7
    buffer_load_dwordx4 v[220:223], v2, s[12:15], m0 offen offset:3072 sc1
    v_exp_f32 v152, v152
    v_exp_f32 v153, v153
    v_exp_f32 v154, v154
    v_exp_f32 v155, v155
    v_smfmac_f32_32x32x32_bf16 v[96:111], a[40:43], v[144:151], v7
    s_add_u32 m0, s72, 0
    ds_write_b128 v9, v[52:55] offset:1024
    v_exp_f32 v156, v156
    v_exp_f32 v157, v157
    v_exp_f32 v158, v158
    v_exp_f32 v159, v159
    v_mfma_f32_32x32x16_bf16 v[128:143], a[64:67], v[40:43], 0
    buffer_load_dwordx4 a[0:3], v2, s[12:15], m0 offen offset:0 sc1
    v_exp_f32 v112, v112
    v_exp_f32 v113, v113
    v_exp_f32 v114, v114
    v_exp_f32 v115, v115
    v_mfma_f32_32x32x16_bf16 v[128:143], a[68:71], v[44:47], v[128:143]
    ds_write_b128 v9, v[56:59] offset:2048
    v_exp_f32 v116, v116
    v_exp_f32 v117, v117
    v_exp_f32 v118, v118
    v_exp_f32 v119, v119
    v_smfmac_f32_32x32x32_bf16 v[96:111], a[44:47], v[152:159], v7
    buffer_load_dwordx4 a[4:7], v2, s[12:15], m0 offen offset:1024 sc1
    v_exp_f32 v120, v120
    v_exp_f32 v121, v121
    v_exp_f32 v122, v122
    v_exp_f32 v123, v123
    v_smfmac_f32_32x32x32_bf16 v[96:111], a[56:59], v[112:119], v7
    ds_write_b128 v9, v[60:63] offset:3072
    v_exp_f32 v124, v124
    v_exp_f32 v125, v125
    v_exp_f32 v126, v126
    v_exp_f32 v127, v127
    v_mfma_f32_32x32x16_bf16 v[144:159], a[80:83], v[40:43], 0
    buffer_load_dwordx4 a[8:11], v2, s[12:15], m0 offen offset:2048 sc1
    v_exp_f32 v128, v128
    v_exp_f32 v129, v129
    v_exp_f32 v130, v130
    v_exp_f32 v131, v131
    v_mfma_f32_32x32x16_bf16 v[144:159], a[84:87], v[44:47], v[144:159]
    ds_write_b128 v10, v[64:67] offset:4096
    v_exp_f32 v132, v132
    v_exp_f32 v133, v133
    v_exp_f32 v134, v134
    v_exp_f32 v135, v135
    v_smfmac_f32_32x32x32_bf16 v[96:111], a[60:63], v[120:127], v7
    buffer_load_dwordx4 a[12:15], v2, s[12:15], m0 offen offset:3072 sc1
    v_exp_f32 v136, v136
    v_exp_f32 v137, v137
    v_exp_f32 v138, v138
    v_exp_f32 v139, v139
    v_smfmac_f32_32x32x32_bf16 v[96:111], a[72:75], v[128:135], v7
    ds_write_b128 v10, v[68:71] offset:5120
    v_exp_f32 v140, v140
    v_exp_f32 v141, v141
    v_exp_f32 v142, v142
    v_exp_f32 v143, v143
    v_mfma_f32_32x32x16_bf16 v[112:127], a[96:99], v[40:43], 0
    buffer_load_dword v242, v241, s[12:15], 0 offen sc1
    v_exp_f32 v144, v144
    v_exp_f32 v145, v145
    v_exp_f32 v146, v146
    v_exp_f32 v147, v147
    v_mfma_f32_32x32x16_bf16 v[112:127], a[100:103], v[44:47], v[112:127]
    s_mov_b32 m0, s28
    ds_write_b128 v10, v[72:75] offset:6144
    v_exp_f32 v148, v148
    v_exp_f32 v149, v149
    v_exp_f32 v150, v150
    v_exp_f32 v151, v151
    v_smfmac_f32_32x32x32_bf16 v[96:111], a[76:79], v[136:143], v7
    buffer_load_dword v242, v240, s[12:15], m0 offen sc1
    v_exp_f32 v152, v152
    v_exp_f32 v153, v153
    v_exp_f32 v154, v154
    v_exp_f32 v155, v155
    v_smfmac_f32_32x32x32_bf16 v[96:111], a[88:91], v[144:151], v7
    ds_write_b128 v10, v[76:79] offset:7168
    v_exp_f32 v156, v156
    v_exp_f32 v157, v157
    v_exp_f32 v158, v158
    v_exp_f32 v159, v159
    v_mfma_f32_32x32x16_bf16 v[128:143], a[112:115], v[40:43], 0
    v_exp_f32 v112, v112
    v_exp_f32 v113, v113
    v_exp_f32 v114, v114
    v_exp_f32 v115, v115
    v_mfma_f32_32x32x16_bf16 v[128:143], a[116:119], v[44:47], v[128:143]
    ds_write_b128 v11, v[80:83] offset:8192
    v_exp_f32 v116, v116
    v_exp_f32 v117, v117
    v_exp_f32 v118, v118
    v_exp_f32 v119, v119
    v_smfmac_f32_32x32x32_bf16 v[96:111], a[92:95], v[152:159], v7
    v_exp_f32 v120, v120
    v_exp_f32 v121, v121
    v_exp_f32 v122, v122
    v_exp_f32 v123, v123
    v_smfmac_f32_32x32x32_bf16 v[96:111], a[104:107], v[112:119], v7
    ds_write_b128 v11, v[84:87] offset:9216
    v_exp_f32 v124, v124
    v_exp_f32 v125, v125
    v_exp_f32 v126, v126
    v_exp_f32 v127, v127
    v_mfma_f32_32x32x16_bf16 v[144:159], a[128:131], v[40:43], 0
    v_exp_f32 v128, v128
    v_exp_f32 v129, v129
    v_exp_f32 v130, v130
    v_exp_f32 v131, v131
    v_mfma_f32_32x32x16_bf16 v[144:159], a[132:135], v[44:47], v[144:159]
    ds_write_b128 v11, v[88:91] offset:10240
    v_exp_f32 v132, v132
    v_exp_f32 v133, v133
    v_exp_f32 v134, v134
    v_exp_f32 v135, v135
    v_smfmac_f32_32x32x32_bf16 v[96:111], a[108:111], v[120:127], v7
    v_exp_f32 v136, v136
    v_exp_f32 v137, v137
    v_exp_f32 v138, v138
    v_exp_f32 v139, v139
    v_smfmac_f32_32x32x32_bf16 v[96:111], a[120:123], v[128:135], v7
    ds_write_b128 v11, v[92:95] offset:11264
    v_exp_f32 v140, v140
    v_exp_f32 v141, v141
    v_exp_f32 v142, v142
    v_exp_f32 v143, v143
    v_mfma_f32_32x32x16_bf16 v[112:127], a[144:147], v[40:43], 0
    v_exp_f32 v144, v144
    v_exp_f32 v145, v145
    v_exp_f32 v146, v146
    v_exp_f32 v147, v147
    v_mfma_f32_32x32x16_bf16 v[112:127], a[148:151], v[44:47], v[112:127]
    v_exp_f32 v148, v148
    v_exp_f32 v149, v149
    v_exp_f32 v150, v150
    v_exp_f32 v151, v151
    v_smfmac_f32_32x32x32_bf16 v[96:111], a[124:127], v[136:143], v7
    v_exp_f32 v152, v152
    v_exp_f32 v153, v153
    v_exp_f32 v154, v154
    v_exp_f32 v155, v155
    v_smfmac_f32_32x32x32_bf16 v[96:111], a[136:139], v[144:151], v7
    v_exp_f32 v156, v156
    v_exp_f32 v157, v157
    v_exp_f32 v158, v158
    v_exp_f32 v159, v159
    v_mfma_f32_32x32x16_bf16 v[128:143], a[160:163], v[40:43], 0
    v_exp_f32 v112, v112
    v_exp_f32 v113, v113
    v_exp_f32 v114, v114
    v_exp_f32 v115, v115
    v_mfma_f32_32x32x16_bf16 v[128:143], a[164:167], v[44:47], v[128:143]
    v_exp_f32 v116, v116
    v_exp_f32 v117, v117
    v_exp_f32 v118, v118
    v_exp_f32 v119, v119
    v_smfmac_f32_32x32x32_bf16 v[96:111], a[140:143], v[152:159], v7
    v_exp_f32 v120, v120
    v_exp_f32 v121, v121
    v_exp_f32 v122, v122
    v_exp_f32 v123, v123
    v_smfmac_f32_32x32x32_bf16 v[96:111], a[152:155], v[112:119], v7
    v_exp_f32 v124, v124
    v_exp_f32 v125, v125
    v_exp_f32 v126, v126
    v_exp_f32 v127, v127
    v_mfma_f32_32x32x16_bf16 v[144:159], a[176:179], v[40:43], 0
    v_exp_f32 v128, v128
    v_exp_f32 v129, v129
    v_exp_f32 v130, v130
    v_exp_f32 v131, v131
    v_mfma_f32_32x32x16_bf16 v[144:159], a[180:183], v[44:47], v[144:159]
    v_exp_f32 v132, v132
    v_exp_f32 v133, v133
    v_exp_f32 v134, v134
    v_exp_f32 v135, v135
    v_smfmac_f32_32x32x32_bf16 v[96:111], a[156:159], v[120:127], v7
    v_exp_f32 v136, v136
    v_exp_f32 v137, v137
    v_exp_f32 v138, v138
    v_exp_f32 v139, v139
    v_smfmac_f32_32x32x32_bf16 v[96:111], a[168:171], v[128:135], v7
    v_exp_f32 v140, v140
    v_exp_f32 v141, v141
    v_exp_f32 v142, v142
    v_exp_f32 v143, v143
    v_mfma_f32_32x32x16_bf16 v[112:127], a[192:195], v[40:43], 0
    s_waitcnt vmcnt(23) lgkmcnt(0)
    v_exp_f32 v144, v144
    v_exp_f32 v145, v145
    v_exp_f32 v146, v146
    v_exp_f32 v147, v147
    v_mfma_f32_32x32x16_bf16 v[112:127], a[196:199], v[44:47], v[112:127]
    v_exp_f32 v148, v148
    v_exp_f32 v149, v149
    v_exp_f32 v150, v150
    v_exp_f32 v151, v151
    v_smfmac_f32_32x32x32_bf16 v[96:111], a[172:175], v[136:143], v7
    s_barrier
    v_exp_f32 v152, v152
    v_exp_f32 v153, v153
    v_exp_f32 v154, v154
    v_exp_f32 v155, v155
    v_smfmac_f32_32x32x32_bf16 v[96:111], a[184:187], v[144:151], v7
    v_exp_f32 v156, v156
    v_exp_f32 v157, v157
    v_exp_f32 v158, v158
    v_exp_f32 v159, v159
    v_mfma_f32_32x32x16_bf16 v[128:143], a[208:211], v[40:43], 0
    ds_read_b128 v[48:51], v12 offset:0
    v_exp_f32 v112, v112
    v_exp_f32 v113, v113
    v_exp_f32 v114, v114
    v_exp_f32 v115, v115
    v_mfma_f32_32x32x16_bf16 v[128:143], a[212:215], v[44:47], v[128:143]
    ds_read_b128 v[52:55], v12 offset:1024
    v_exp_f32 v116, v116
    v_exp_f32 v117, v117
    v_exp_f32 v118, v118
    v_exp_f32 v119, v119
    v_smfmac_f32_32x32x32_bf16 v[96:111], a[188:191], v[152:159], v7
    ds_read_b128 v[56:59], v12 offset:2048
    v_exp_f32 v120, v120
    v_exp_f32 v121, v121
    v_exp_f32 v122, v122
    v_exp_f32 v123, v123
    v_smfmac_f32_32x32x32_bf16 v[96:111], a[200:203], v[112:119], v7
    ds_read_b128 v[60:63], v12 offset:3072
    v_exp_f32 v124, v124
    v_exp_f32 v125, v125
    v_exp_f32 v126, v126
    v_exp_f32 v127, v127
    v_mfma_f32_32x32x16_bf16 v[144:159], a[224:227], v[40:43], 0
    ds_read_b128 v[64:67], v12 offset:4096
    v_exp_f32 v128, v128
    v_exp_f32 v129, v129
    v_exp_f32 v130, v130
    v_exp_f32 v131, v131
    v_mfma_f32_32x32x16_bf16 v[144:159], a[228:231], v[44:47], v[144:159]
    ds_read_b128 v[68:71], v12 offset:5120
    v_exp_f32 v132, v132
    v_exp_f32 v133, v133
    v_exp_f32 v134, v134
    v_exp_f32 v135, v135
    v_smfmac_f32_32x32x32_bf16 v[96:111], a[204:207], v[120:127], v7
    ds_read_b128 v[72:75], v12 offset:6144
    v_exp_f32 v136, v136
    v_exp_f32 v137, v137
    v_exp_f32 v138, v138
    v_exp_f32 v139, v139
    v_smfmac_f32_32x32x32_bf16 v[96:111], a[216:219], v[128:135], v7
    ds_read_b128 v[76:79], v12 offset:7168
    v_exp_f32 v140, v140
    v_exp_f32 v141, v141
    v_exp_f32 v142, v142
    v_exp_f32 v143, v143
    v_mfma_f32_32x32x16_bf16 v[112:127], a[240:243], v[40:43], 0
    ds_read_b128 v[80:83], v12 offset:8192
    v_exp_f32 v144, v144
    v_exp_f32 v145, v145
    v_exp_f32 v146, v146
    v_exp_f32 v147, v147
    v_mfma_f32_32x32x16_bf16 v[112:127], a[244:247], v[44:47], v[112:127]
    ds_read_b128 v[84:87], v12 offset:9216
    v_exp_f32 v148, v148
    v_exp_f32 v149, v149
    v_exp_f32 v150, v150
    v_exp_f32 v151, v151
    v_smfmac_f32_32x32x32_bf16 v[96:111], a[220:223], v[136:143], v7
    ds_read_b128 v[88:91], v12 offset:10240
    v_exp_f32 v152, v152
    v_exp_f32 v153, v153
    v_exp_f32 v154, v154
    v_exp_f32 v155, v155
    v_smfmac_f32_32x32x32_bf16 v[96:111], a[232:235], v[144:151], v7
    ds_read_b128 v[92:95], v12 offset:11264
    v_exp_f32 v156, v156
    v_exp_f32 v157, v157
    v_exp_f32 v158, v158
    v_exp_f32 v159, v159
    v_exp_f32 v112, v112
    v_exp_f32 v113, v113
    v_exp_f32 v114, v114
    v_exp_f32 v115, v115
    v_exp_f32 v116, v116
    v_exp_f32 v117, v117
    v_exp_f32 v118, v118
    v_exp_f32 v119, v119
    v_smfmac_f32_32x32x32_bf16 v[96:111], a[236:239], v[152:159], v7
    v_exp_f32 v120, v120
    v_exp_f32 v121, v121
    v_exp_f32 v122, v122
    v_exp_f32 v123, v123
    v_smfmac_f32_32x32x32_bf16 v[96:111], a[248:251], v[112:119], v7
    v_exp_f32 v124, v124
    v_exp_f32 v125, v125
    v_exp_f32 v126, v126
    v_exp_f32 v127, v127
    s_nop 1
    v_smfmac_f32_32x32x32_bf16 v[96:111], a[252:255], v[120:127], v7
L_combine:
    s_waitcnt lgkmcnt(0)
    v_add_f32 v48, v48, v64
    v_add_f32 v49, v49, v65
    v_add_f32 v50, v50, v66
    v_add_f32 v51, v51, v67
    v_add_f32 v52, v52, v68
    v_add_f32 v53, v53, v69
    v_add_f32 v54, v54, v70
    v_add_f32 v55, v55, v71
    v_add_f32 v56, v56, v72
    v_add_f32 v57, v57, v73
    v_add_f32 v58, v58, v74
    v_add_f32 v59, v59, v75
    v_add_f32 v60, v60, v76
    v_add_f32 v61, v61, v77
    v_add_f32 v62, v62, v78
    v_add_f32 v63, v63, v79
    v_pk_add_f32 v[48:49], v[48:49], v[80:81]
    v_pk_add_f32 v[50:51], v[50:51], v[82:83]
    v_pk_add_f32 v[52:53], v[52:53], v[84:85]
    v_pk_add_f32 v[54:55], v[54:55], v[86:87]
    v_pk_add_f32 v[56:57], v[56:57], v[88:89]
    v_pk_add_f32 v[58:59], v[58:59], v[90:91]
    v_pk_add_f32 v[60:61], v[60:61], v[92:93]
    v_pk_add_f32 v[62:63], v[62:63], v[94:95]
    v_pk_add_f32 v[60:61], v[60:61], v[108:109]
    v_mov_b32 v13, v60
    v_mov_b32 v15, v60
L_w1_1:
    s_cbranch_execz L_w1_r
    v_pk_add_f32 v[48:49], v[48:49], v[96:97]
    v_pk_add_f32 v[50:51], v[50:51], v[98:99]
    v_permlane32_swap_b32 v13, v15
    v_pk_add_f32 v[52:53], v[52:53], v[100:101]
    v_rcp_f32 v158, v15
    v_pk_add_f32 v[54:55], v[54:55], v[102:103]
    v_pk_add_f32 v[56:57], v[56:57], v[104:105]
    v_pk_add_f32 v[58:59], v[58:59], v[106:107]
    v_pk_add_f32 v[62:63], v[62:63], v[110:111]
    v_pk_mul_f32 v[48:49], v[48:49], v[158:159] op_sel_hi:[1,0]
    v_cvt_pk_bf16_f32 v48, v48, v49
    v_pk_mul_f32 v[50:51], v[50:51], v[158:159] op_sel_hi:[1,0]
    v_cvt_pk_bf16_f32 v49, v50, v51
    v_pk_mul_f32 v[52:53], v[52:53], v[158:159] op_sel_hi:[1,0]
    v_cvt_pk_bf16_f32 v50, v52, v53
    v_pk_mul_f32 v[54:55], v[54:55], v[158:159] op_sel_hi:[1,0]
    v_cvt_pk_bf16_f32 v51, v54, v55
    buffer_store_dwordx4 v[48:51], v255, s[12:15], s3 offen sc1
    v_pk_mul_f32 v[56:57], v[56:57], v[158:159] op_sel_hi:[1,0]
    v_cvt_pk_bf16_f32 v52, v56, v57
    v_pk_mul_f32 v[58:59], v[58:59], v[158:159] op_sel_hi:[1,0]
    v_cvt_pk_bf16_f32 v53, v58, v59
    v_pk_mul_f32 v[60:61], v[60:61], v[158:159] op_sel_hi:[1,0]
    v_cvt_pk_bf16_f32 v54, v60, v61
    v_and_b32 v54, v6, v54
    v_pk_mul_f32 v[62:63], v[62:63], v[158:159] op_sel_hi:[1,0]
    v_cvt_pk_bf16_f32 v55, v62, v63
    v_and_b32 v55, v6, v55
    buffer_store_dwordx4 v[52:55], v255, s[12:15], s3 offen offset:512 sc1
    ds_read_b64_tr_b16 v[112:113], v249 offset:0
    ds_read_b64_tr_b16 v[114:115], v249 offset:1024
    ds_read_b64_tr_b16 v[116:117], v249 offset:4096
    ds_read_b64_tr_b16 v[118:119], v249 offset:5120
    ds_read_b64_tr_b16 v[120:121], v249 offset:8192
    ds_read_b64_tr_b16 v[122:123], v249 offset:9216
    ds_read_b64_tr_b16 v[124:125], v249 offset:12288
    ds_read_b64_tr_b16 v[126:127], v249 offset:13312
    v_cmp_nle_f32 vcc, 0x2b800000, v15
    v_mov_b32 v156, 0
    v_mov_b32 v157, 0
    s_mov_b64 s[82:83], vcc
    v_cmp_nge_f32 vcc, 0x53800000, v15
    v_add_u32 v15, v12, v5
    s_or_b64 vcc, vcc, s[82:83]
    s_cselect_b32 s26, 1, 0
    s_andn2_b32 s26, s26, s30
    v_mov_b32 v13, s26
    ds_write_b32 v12, v13
    ds_read_b64_tr_b16 v[128:129], v249 offset:16384
    ds_read_b64_tr_b16 v[130:131], v249 offset:17408
    ds_read_b64_tr_b16 v[132:133], v249 offset:20480
    ds_read_b64_tr_b16 v[134:135], v249 offset:21504
    ds_read_b64_tr_b16 v[136:137], v249 offset:24576
    ds_read_b64_tr_b16 v[138:139], v249 offset:25600
    ds_read_b64_tr_b16 v[140:141], v249 offset:28672
    ds_read_b64_tr_b16 v[142:143], v249 offset:29696
    s_add_u32 m0, s72, 4096
    s_nop 0
    buffer_load_dwordx4 a[16:19], v2, s[12:15], m0 offen offset:0 sc1
    s_waitcnt lgkmcnt(8)
    v_dot2c_f32_bf16 v156, v112, v14
    v_dot2c_f32_bf16 v157, v113, v14
    v_dot2c_f32_bf16 v156, v114, v14
    v_dot2c_f32_bf16 v157, v115, v14
    v_dot2c_f32_bf16 v156, v116, v14
    v_dot2c_f32_bf16 v157, v117, v14
    v_dot2c_f32_bf16 v156, v118, v14
    v_dot2c_f32_bf16 v157, v119, v14
    v_dot2c_f32_bf16 v156, v120, v14
    v_dot2c_f32_bf16 v157, v121, v14
    v_dot2c_f32_bf16 v156, v122, v14
    v_dot2c_f32_bf16 v157, v123, v14
    v_dot2c_f32_bf16 v156, v124, v14
    v_dot2c_f32_bf16 v157, v125, v14
    v_dot2c_f32_bf16 v156, v126, v14
    v_dot2c_f32_bf16 v157, v127, v14
    ds_read_b64_tr_b16 v[112:113], v249 offset:32768
    ds_read_b64_tr_b16 v[114:115], v249 offset:33792
    ds_read_b64_tr_b16 v[116:117], v249 offset:36864
    ds_read_b64_tr_b16 v[118:119], v249 offset:37888
    ds_read_b64_tr_b16 v[120:121], v249 offset:40960
    ds_read_b64_tr_b16 v[122:123], v249 offset:41984
    ds_read_b64_tr_b16 v[124:125], v249 offset:45056
    ds_read_b64_tr_b16 v[126:127], v249 offset:46080
    buffer_load_dwordx4 a[20:23], v2, s[12:15], m0 offen offset:1024 sc1
    buffer_load_dwordx4 a[24:27], v2, s[12:15], m0 offen offset:2048 sc1
    s_waitcnt lgkmcnt(8)
    v_dot2c_f32_bf16 v156, v128, v14
    v_dot2c_f32_bf16 v157, v129, v14
    v_dot2c_f32_bf16 v156, v130, v14
    v_dot2c_f32_bf16 v157, v131, v14
    v_dot2c_f32_bf16 v156, v132, v14
    v_dot2c_f32_bf16 v157, v133, v14
    v_dot2c_f32_bf16 v156, v134, v14
    v_dot2c_f32_bf16 v157, v135, v14
    v_dot2c_f32_bf16 v156, v136, v14
    v_dot2c_f32_bf16 v157, v137, v14
    v_dot2c_f32_bf16 v156, v138, v14
    v_dot2c_f32_bf16 v157, v139, v14
    v_dot2c_f32_bf16 v156, v140, v14
    v_dot2c_f32_bf16 v157, v141, v14
    v_dot2c_f32_bf16 v156, v142, v14
    v_dot2c_f32_bf16 v157, v143, v14
    s_barrier
    ds_read_b32 v13, v251
    ds_read_b64_tr_b16 v[128:129], v249 offset:49152
    ds_read_b64_tr_b16 v[130:131], v249 offset:50176
    ds_read_b64_tr_b16 v[132:133], v249 offset:53248
    ds_read_b64_tr_b16 v[134:135], v249 offset:54272
    ds_read_b64_tr_b16 v[136:137], v249 offset:57344
    ds_read_b64_tr_b16 v[138:139], v249 offset:58368
    ds_read_b64_tr_b16 v[140:141], v249 offset:61440
    ds_read_b64_tr_b16 v[142:143], v249 offset:62464
    buffer_load_dwordx4 a[28:31], v2, s[12:15], m0 offen offset:3072 sc1
    s_waitcnt lgkmcnt(8)
    v_dot2c_f32_bf16 v156, v112, v14
    v_dot2c_f32_bf16 v157, v113, v14
    v_dot2c_f32_bf16 v156, v114, v14
    v_dot2c_f32_bf16 v157, v115, v14
    v_dot2c_f32_bf16 v156, v116, v14
    v_dot2c_f32_bf16 v157, v117, v14
    v_dot2c_f32_bf16 v156, v118, v14
    v_dot2c_f32_bf16 v157, v119, v14
    v_dot2c_f32_bf16 v156, v120, v14
    v_dot2c_f32_bf16 v157, v121, v14
    v_dot2c_f32_bf16 v156, v122, v14
    v_dot2c_f32_bf16 v157, v123, v14
    v_dot2c_f32_bf16 v156, v124, v14
    v_dot2c_f32_bf16 v157, v125, v14
    v_dot2c_f32_bf16 v156, v126, v14
    v_dot2c_f32_bf16 v157, v127, v14
    ds_read_b64_tr_b16 v[112:113], v254 offset:0
    ds_read_b64_tr_b16 v[114:115], v254 offset:1024
    ds_read_b64_tr_b16 v[116:117], v254 offset:4096
    ds_read_b64_tr_b16 v[118:119], v254 offset:5120
    ds_read_b64_tr_b16 v[120:121], v254 offset:8192
    ds_read_b64_tr_b16 v[122:123], v254 offset:9216
    ds_read_b64_tr_b16 v[124:125], v254 offset:12288
    ds_read_b64_tr_b16 v[126:127], v254 offset:13312
    s_add_u32 m0, s73, 8192
    s_nop 0
    buffer_load_dwordx4 a[32:35], v2, s[12:15], m0 offen offset:0 sc1
    buffer_load_dwordx4 a[36:39], v2, s[12:15], m0 offen offset:1024 sc1
    s_waitcnt lgkmcnt(8)
    v_dot2c_f32_bf16 v156, v128, v14
    v_dot2c_f32_bf16 v157, v129, v14
    v_dot2c_f32_bf16 v156, v130, v14
    v_dot2c_f32_bf16 v157, v131, v14
    v_dot2c_f32_bf16 v156, v132, v14
    v_dot2c_f32_bf16 v157, v133, v14
    v_dot2c_f32_bf16 v156, v134, v14
    v_dot2c_f32_bf16 v157, v135, v14
    v_dot2c_f32_bf16 v156, v136, v14
    v_dot2c_f32_bf16 v157, v137, v14
    v_dot2c_f32_bf16 v156, v138, v14
    v_dot2c_f32_bf16 v157, v139, v14
    v_dot2c_f32_bf16 v156, v140, v14
    v_dot2c_f32_bf16 v157, v141, v14
    v_dot2c_f32_bf16 v156, v142, v14
    v_dot2c_f32_bf16 v157, v143, v14
    ds_read_b64_tr_b16 v[128:129], v254 offset:16384
    ds_read_b64_tr_b16 v[130:131], v254 offset:17408
    ds_read_b64_tr_b16 v[132:133], v254 offset:20480
    ds_read_b64_tr_b16 v[134:135], v254 offset:21504
    ds_read_b64_tr_b16 v[136:137], v254 offset:24576
    ds_read_b64_tr_b16 v[138:139], v254 offset:25600
    ds_read_b64_tr_b16 v[140:141], v254 offset:28672
    ds_read_b64_tr_b16 v[142:143], v254 offset:29696
    buffer_load_dwordx4 a[40:43], v2, s[12:15], m0 offen offset:2048 sc1
    buffer_load_dwordx4 a[44:47], v2, s[12:15], m0 offen offset:3072 sc1
    s_waitcnt lgkmcnt(8)
    v_dot2c_f32_bf16 v156, v112, v14
    v_dot2c_f32_bf16 v157, v113, v14
    v_dot2c_f32_bf16 v156, v114, v14
    v_dot2c_f32_bf16 v157, v115, v14
    v_dot2c_f32_bf16 v156, v116, v14
    v_dot2c_f32_bf16 v157, v117, v14
    v_dot2c_f32_bf16 v156, v118, v14
    v_dot2c_f32_bf16 v157, v119, v14
    v_dot2c_f32_bf16 v156, v120, v14
    v_dot2c_f32_bf16 v157, v121, v14
    v_dot2c_f32_bf16 v156, v122, v14
    v_dot2c_f32_bf16 v157, v123, v14
    v_dot2c_f32_bf16 v156, v124, v14
    v_dot2c_f32_bf16 v157, v125, v14
    v_dot2c_f32_bf16 v156, v126, v14
    v_dot2c_f32_bf16 v157, v127, v14
    v_cmp_ne_u32 vcc, 0, v13
    s_cbranch_vccnz L_fallback
    s_waitcnt vmcnt(8)
    s_barrier
    buffer_atomic_add v8, v250, s[12:15], 0 offen sc1
    s_cmp_ge_u32 s20, 14
    s_cbranch_scc1 L_end
    s_add_u32 m0, s73, 12288
    s_nop 0
    buffer_load_dwordx4 a[48:51], v2, s[12:15], m0 offen offset:0 sc1
    buffer_load_dwordx4 a[52:55], v2, s[12:15], m0 offen offset:1024 sc1
    buffer_load_dwordx4 a[56:59], v2, s[12:15], m0 offen offset:2048 sc1
    buffer_load_dwordx4 a[60:63], v2, s[12:15], m0 offen offset:3072 sc1
    s_add_u32 m0, s72, 16384
    s_nop 0
    buffer_load_dwordx4 a[64:67], v2, s[12:15], m0 offen offset:0 sc1
    buffer_load_dwordx4 a[68:71], v2, s[12:15], m0 offen offset:1024 sc1
    buffer_load_dwordx4 a[72:75], v2, s[12:15], m0 offen offset:2048 sc1
    buffer_load_dwordx4 a[76:79], v2, s[12:15], m0 offen offset:3072 sc1
    s_add_u32 m0, s72, 20480
    s_nop 0
    buffer_load_dwordx4 a[80:83], v2, s[12:15], m0 offen offset:0 sc1
    buffer_load_dwordx4 a[84:87], v2, s[12:15], m0 offen offset:1024 sc1
    buffer_load_dwordx4 a[88:91], v2, s[12:15], m0 offen offset:2048 sc1
    v_readlane_b32 s31, v243, 20
    v_mov_b32 v13, 0
    v_mov_b32 v3, v15
    s_xor_b32 m0, s62, 0xc000
    s_cmp_eq_u32 s31, s29
    s_cselect_b32 s31, 1, 0
    s_cmp_lg_u32 s16, 1
    s_cbranch_scc1 L_s2wait
    s_mov_b32 s26, 262144
L_s2poll:
    buffer_load_dword v15, v13, s[12:15], s25 offen sc1
    s_sub_u32 s26, s26, 1
    s_cbranch_scc1 L_s2done
    s_waitcnt vmcnt(0)
    v_cmp_gt_u32 vcc, 16, v15
    s_cbranch_vccnz L_s2poll
L_s2done:
    buffer_load_dwordx4 v[64:67], v2, s[12:15], m0 offen offset:0 sc1
    buffer_load_dwordx4 v[68:71], v2, s[12:15], m0 offen offset:1024 sc1
    s_waitcnt lgkmcnt(0)
    s_barrier
    s_branch L_s2go
L_s2wait:
    s_mov_b64 exec, 0
    s_cmp_eq_u32 s16, 0
    s_cbranch_scc1 L_w2_0
    s_cmp_eq_u32 s16, 2
    s_cbranch_scc1 L_w2_1
    s_cmp_eq_u32 s16, 3
    s_cbranch_scc1 L_w2_2
L_w2_r:
    s_mov_b64 exec, -1
    s_waitcnt  lgkmcnt(0)
    s_barrier
    buffer_load_dwordx4 v[64:67], v2, s[12:15], m0 offen offset:0 sc1
    buffer_load_dwordx4 v[68:71], v2, s[12:15], m0 offen offset:1024 sc1
L_s2go:
    buffer_load_dwordx4 v[72:75], v2, s[12:15], m0 offen offset:2048 sc1
    buffer_load_dwordx4 v[76:79], v2, s[12:15], m0 offen offset:3072 sc1
    s_xor_b32 m0, s62, 32768
    s_nop 0
    buffer_load_dwordx4 v[48:51], v2, s[12:15], m0 offen offset:0 sc1
    buffer_load_dwordx4 v[52:55], v2, s[12:15], m0 offen offset:1024 sc1
    buffer_load_dwordx4 v[56:59], v2, s[12:15], m0 offen offset:2048 sc1
    buffer_load_dwordx4 v[60:63], v2, s[12:15], m0 offen offset:3072 sc1
    s_xor_b32 m0, s62, 16384
    s_nop 0
    buffer_load_dwordx4 v[32:35], v2, s[12:15], m0 offen offset:0 sc1
    buffer_load_dwordx4 v[36:39], v2, s[12:15], m0 offen offset:1024 sc1
    buffer_load_dwordx4 v[40:43], v2, s[12:15], m0 offen offset:2048 sc1
    buffer_load_dwordx4 v[44:47], v2, s[12:15], m0 offen offset:3072 sc1
    ds_read_b64_tr_b16 v[112:113], v254 offset:32768
    ds_read_b64_tr_b16 v[114:115], v254 offset:33792
    ds_read_b64_tr_b16 v[116:117], v254 offset:36864
    ds_read_b64_tr_b16 v[118:119], v254 offset:37888
    ds_read_b64_tr_b16 v[120:121], v254 offset:40960
    ds_read_b64_tr_b16 v[122:123], v254 offset:41984
    ds_read_b64_tr_b16 v[124:125], v254 offset:45056
    ds_read_b64_tr_b16 v[126:127], v254 offset:46080
    s_waitcnt lgkmcnt(8)
    v_dot2c_f32_bf16 v156, v128, v14
    v_dot2c_f32_bf16 v157, v129, v14
    v_dot2c_f32_bf16 v156, v130, v14
    v_dot2c_f32_bf16 v157, v131, v14
    v_dot2c_f32_bf16 v156, v132, v14
    v_dot2c_f32_bf16 v157, v133, v14
    v_dot2c_f32_bf16 v156, v134, v14
    v_dot2c_f32_bf16 v157, v135, v14
    v_dot2c_f32_bf16 v156, v136, v14
    v_dot2c_f32_bf16 v157, v137, v14
    v_dot2c_f32_bf16 v156, v138, v14
    v_dot2c_f32_bf16 v157, v139, v14
    v_dot2c_f32_bf16 v156, v140, v14
    v_dot2c_f32_bf16 v157, v141, v14
    v_dot2c_f32_bf16 v156, v142, v14
    v_dot2c_f32_bf16 v157, v143, v14
    s_waitcnt lgkmcnt(0)
    v_dot2c_f32_bf16 v156, v112, v14
    v_dot2c_f32_bf16 v157, v113, v14
    v_dot2c_f32_bf16 v156, v114, v14
    v_dot2c_f32_bf16 v157, v115, v14
    v_dot2c_f32_bf16 v156, v116, v14
    v_dot2c_f32_bf16 v157, v117, v14
    v_dot2c_f32_bf16 v156, v118, v14
    v_dot2c_f32_bf16 v157, v119, v14
    v_dot2c_f32_bf16 v156, v120, v14
    v_dot2c_f32_bf16 v157, v121, v14
    v_dot2c_f32_bf16 v156, v122, v14
    v_dot2c_f32_bf16 v157, v123, v14
    v_dot2c_f32_bf16 v156, v124, v14
    v_dot2c_f32_bf16 v157, v125, v14
    v_dot2c_f32_bf16 v156, v126, v14
    v_dot2c_f32_bf16 v157, v127, v14
    s_nop 2
    v_add_f32 v156, v156, v157
    v_mov_b32 v157, v156
    s_nop 1
    v_permlane32_swap_b32 v156, v157
    v_add_f32 v156, v156, v157
    v_lshlrev_b32 v80, 16, v224
    v_and_b32 v81, 0xffff0000, v224
    v_lshlrev_b32 v82, 16, v225
    v_and_b32 v83, 0xffff0000, v225
    v_lshlrev_b32 v84, 16, v226
    v_and_b32 v85, 0xffff0000, v226
    v_lshlrev_b32 v86, 16, v227
    v_and_b32 v87, 0xffff0000, v227
    v_lshlrev_b32 v88, 16, v228
    v_and_b32 v89, 0xffff0000, v228
    v_lshlrev_b32 v90, 16, v229
    v_and_b32 v91, 0xffff0000, v229
    v_lshlrev_b32 v92, 16, v230
    v_and_b32 v93, 0xffff0000, v230
    v_lshlrev_b32 v94, 16, v231
    v_and_b32 v95, 0xffff0000, v231
    v_add_u32 v159, v2, v5
    v_add_u32 v159, 114688, v159
    s_and_b32 s76, s23, 3
    s_lshl_b32 s77, s76, 5
    s_add_u32 s77, s77, s24
    s_lshl_b32 s77, s77, 2
    v_mov_b32 v4, s77
    v_min_u32 v5, 13, v1
    v_lshlrev_b32 v5, 2, v5
    v_and_b32 v15, 0xf0, v2
    v_bfe_u32 v13, v1, 4, 1
    v_lshl_add_u32 v15, v13, 2, v15
    v_and_b32 v7, 0x300, v2
    v_add_u32 v7, v7, v2
    s_xor_b32 m0, s62, 0
    s_nop 0
    buffer_load_dwordx4 v[16:19], v2, s[12:15], m0 offen offset:0 sc1
    buffer_load_dwordx4 v[20:23], v2, s[12:15], m0 offen offset:1024 sc1
    buffer_load_dwordx4 v[24:27], v2, s[12:15], m0 offen offset:2048 sc1
    buffer_load_dwordx4 v[28:31], v2, s[12:15], m0 offen offset:3072 sc1
    s_waitcnt vmcnt(15)
    v_mfma_f32_16x16x32_bf16 v[128:131], v[160:163], v[64:67], 0
    v_mfma_f32_16x16x32_bf16 v[132:135], v[164:167], v[64:67], 0
    s_add_u32 m0, s72, 20480
    s_nop 0
    buffer_load_dwordx4 a[92:95], v2, s[12:15], m0 offen offset:3072 sc1
    v_mfma_f32_16x16x32_bf16 v[136:139], v[168:171], v[64:67], 0
    v_mfma_f32_16x16x32_bf16 v[140:143], v[172:175], v[64:67], 0
    s_waitcnt vmcnt(15)
    v_mfma_f32_16x16x32_bf16 v[128:131], v[176:179], v[68:71], v[128:131]
    v_mfma_f32_16x16x32_bf16 v[132:135], v[180:183], v[68:71], v[132:135]
    s_add_u32 m0, s73, 24576
    s_nop 0
    buffer_load_dwordx4 a[96:99], v2, s[12:15], m0 offen offset:0 sc1
    v_mfma_f32_16x16x32_bf16 v[136:139], v[184:187], v[68:71], v[136:139]
    v_mfma_f32_16x16x32_bf16 v[140:143], v[188:191], v[68:71], v[140:143]
    s_waitcnt vmcnt(15)
    v_mfma_f32_16x16x32_bf16 v[128:131], v[192:195], v[72:75], v[128:131]
    v_mfma_f32_16x16x32_bf16 v[132:135], v[196:199], v[72:75], v[132:135]
    buffer_load_dwordx4 a[100:103], v2, s[12:15], m0 offen offset:1024 sc1
    v_mfma_f32_16x16x32_bf16 v[136:139], v[200:203], v[72:75], v[136:139]
    v_mfma_f32_16x16x32_bf16 v[140:143], v[204:207], v[72:75], v[140:143]
    s_waitcnt vmcnt(15)
    v_mfma_f32_16x16x32_bf16 v[128:131], v[208:211], v[76:79], v[128:131]
    v_mfma_f32_16x16x32_bf16 v[132:135], v[212:215], v[76:79], v[132:135]
    buffer_load_dwordx4 a[104:107], v2, s[12:15], m0 offen offset:2048 sc1
    v_mfma_f32_16x16x32_bf16 v[136:139], v[216:219], v[76:79], v[136:139]
    v_mfma_f32_16x16x32_bf16 v[140:143], v[220:223], v[76:79], v[140:143]
    s_waitcnt vmcnt(15)
    v_mfma_f32_16x16x32_bf16 v[112:115], v[160:163], v[48:51], 0
    v_mfma_f32_16x16x32_bf16 v[116:119], v[164:167], v[48:51], 0
    buffer_load_dwordx4 a[108:111], v2, s[12:15], m0 offen offset:3072 sc1
    v_mfma_f32_16x16x32_bf16 v[120:123], v[168:171], v[48:51], 0
    v_mfma_f32_16x16x32_bf16 v[124:127], v[172:175], v[48:51], 0
    ds_write_b128 v9, v[128:131] offset:0
    s_waitcnt vmcnt(15)
    v_mfma_f32_16x16x32_bf16 v[112:115], v[176:179], v[52:55], v[112:115]
    v_mfma_f32_16x16x32_bf16 v[116:119], v[180:183], v[52:55], v[116:119]
    s_add_u32 m0, s73, 28672
    s_nop 0
    buffer_load_dwordx4 a[112:115], v2, s[12:15], m0 offen offset:0 sc1
    v_mfma_f32_16x16x32_bf16 v[120:123], v[184:187], v[52:55], v[120:123]
    v_mfma_f32_16x16x32_bf16 v[124:127], v[188:191], v[52:55], v[124:127]
    ds_write_b128 v9, v[132:135] offset:1024
    s_waitcnt vmcnt(15)
    v_mfma_f32_16x16x32_bf16 v[112:115], v[192:195], v[56:59], v[112:115]
    v_mfma_f32_16x16x32_bf16 v[116:119], v[196:199], v[56:59], v[116:119]
    buffer_load_dwordx4 a[116:119], v2, s[12:15], m0 offen offset:1024 sc1
    v_mfma_f32_16x16x32_bf16 v[120:123], v[200:203], v[56:59], v[120:123]
    v_mfma_f32_16x16x32_bf16 v[124:127], v[204:207], v[56:59], v[124:127]
    ds_write_b128 v9, v[136:139] offset:2048
    s_waitcnt vmcnt(15)
    v_mfma_f32_16x16x32_bf16 v[112:115], v[208:211], v[60:63], v[112:115]
    v_mfma_f32_16x16x32_bf16 v[116:119], v[212:215], v[60:63], v[116:119]
    buffer_load_dwordx4 a[120:123], v2, s[12:15], m0 offen offset:2048 sc1
    v_mfma_f32_16x16x32_bf16 v[120:123], v[216:219], v[60:63], v[120:123]
    v_mfma_f32_16x16x32_bf16 v[124:127], v[220:223], v[60:63], v[124:127]
    ds_write_b128 v9, v[140:143] offset:3072
    s_waitcnt vmcnt(15)
    v_mfma_f32_16x16x32_bf16 v[96:99], v[160:163], v[32:35], 0
    v_mfma_f32_16x16x32_bf16 v[100:103], v[164:167], v[32:35], 0
    buffer_load_dwordx4 a[124:127], v2, s[12:15], m0 offen offset:3072 sc1
    v_mfma_f32_16x16x32_bf16 v[104:107], v[168:171], v[32:35], 0
    v_mfma_f32_16x16x32_bf16 v[108:111], v[172:175], v[32:35], 0
    ds_write_b128 v10, v[112:115] offset:4096
    s_waitcnt lgkmcnt(1)
    s_barrier
    ds_read_b128 v[128:131], v12 offset:0
    ds_read_b128 v[132:135], v12 offset:1024
    ds_read_b128 v[136:139], v12 offset:2048
    ds_read_b128 v[140:143], v12 offset:3072
    ds_write_b32 v3, v156
    s_waitcnt vmcnt(15)
    v_mfma_f32_16x16x32_bf16 v[96:99], v[176:179], v[36:39], v[96:99]
    v_mfma_f32_16x16x32_bf16 v[100:103], v[180:183], v[36:39], v[100:103]
    s_add_u32 m0, s72, 32768
    s_nop 0
    buffer_load_dwordx4 a[128:131], v2, s[12:15], m0 offen offset:0 sc1
    v_mfma_f32_16x16x32_bf16 v[104:107], v[184:187], v[36:39], v[104:107]
    v_mfma_f32_16x16x32_bf16 v[108:111], v[188:191], v[36:39], v[108:111]
    ds_write_b128 v10, v[116:119] offset:5120
    s_waitcnt vmcnt(15)
    v_mfma_f32_16x16x32_bf16 v[96:99], v[192:195], v[40:43], v[96:99]
    v_mfma_f32_16x16x32_bf16 v[100:103], v[196:199], v[40:43], v[100:103]
    buffer_load_dwordx4 a[132:135], v2, s[12:15], m0 offen offset:1024 sc1
    v_mfma_f32_16x16x32_bf16 v[104:107], v[200:203], v[40:43], v[104:107]
    v_mfma_f32_16x16x32_bf16 v[108:111], v[204:207], v[40:43], v[108:111]
    ds_write_b128 v10, v[120:123] offset:6144
    s_waitcnt vmcnt(15)
    v_mfma_f32_16x16x32_bf16 v[96:99], v[208:211], v[44:47], v[96:99]
    v_mfma_f32_16x16x32_bf16 v[100:103], v[212:215], v[44:47], v[100:103]
    buffer_load_dwordx4 a[136:139], v2, s[12:15], m0 offen offset:2048 sc1
    v_mfma_f32_16x16x32_bf16 v[104:107], v[216:219], v[44:47], v[104:107]
    v_mfma_f32_16x16x32_bf16 v[108:111], v[220:223], v[44:47], v[108:111]
    ds_write_b128 v10, v[124:127] offset:7168
    s_waitcnt vmcnt(15)
    v_mfma_f32_16x16x32_bf16 v[80:83], v[160:163], v[16:19], v[80:83]
    v_mfma_f32_16x16x32_bf16 v[84:87], v[164:167], v[16:19], v[84:87]
    buffer_load_dwordx4 a[140:143], v2, s[12:15], m0 offen offset:3072 sc1
    v_mfma_f32_16x16x32_bf16 v[88:91], v[168:171], v[16:19], v[88:91]
    v_mfma_f32_16x16x32_bf16 v[92:95], v[172:175], v[16:19], v[92:95]
    ds_write_b128 v11, v[96:99] offset:8192
    s_waitcnt lgkmcnt(1)
    s_barrier
    ds_write_b128 v11, v[100:103] offset:9216
    ds_write_b128 v11, v[104:107] offset:10240
    ds_write_b128 v11, v[108:111] offset:11264
    ds_read_b128 v[112:115], v12 offset:4096
    ds_read_b128 v[116:119], v12 offset:5120
    ds_read_b128 v[120:123], v12 offset:6144
    ds_read_b128 v[124:127], v12 offset:7168
    ds_read_b32 v156, v159 offset:0
    ds_read_b32 v157, v159 offset:12288
    ds_read_b32 v158, v159 offset:24576
    ds_read_b32 v159, v159 offset:36864
    s_waitcnt vmcnt(15)
    v_mfma_f32_16x16x32_bf16 v[80:83], v[176:179], v[20:23], v[80:83]
    v_mfma_f32_16x16x32_bf16 v[84:87], v[180:183], v[20:23], v[84:87]
    s_add_u32 m0, s72, 36864
    s_nop 0
    buffer_load_dwordx4 a[144:147], v2, s[12:15], m0 offen offset:0 sc1
    v_mfma_f32_16x16x32_bf16 v[88:91], v[184:187], v[20:23], v[88:91]
    v_mfma_f32_16x16x32_bf16 v[92:95], v[188:191], v[20:23], v[92:95]
    s_waitcnt vmcnt(15)
    v_mfma_f32_16x16x32_bf16 v[80:83], v[192:195], v[24:27], v[80:83]
    v_mfma_f32_16x16x32_bf16 v[84:87], v[196:199], v[24:27], v[84:87]
    buffer_load_dwordx4 a[148:151], v2, s[12:15], m0 offen offset:1024 sc1
    v_mfma_f32_16x16x32_bf16 v[88:91], v[200:203], v[24:27], v[88:91]
    v_mfma_f32_16x16x32_bf16 v[92:95], v[204:207], v[24:27], v[92:95]
    s_waitcnt lgkmcnt(8)
    s_barrier
    ds_read_b128 v[96:99], v12 offset:8192
    ds_read_b128 v[100:103], v12 offset:9216
    ds_read_b128 v[104:107], v12 offset:10240
    ds_read_b128 v[108:111], v12 offset:11264
    s_waitcnt vmcnt(15)
    v_mfma_f32_16x16x32_bf16 v[80:83], v[208:211], v[28:31], v[80:83]
    v_mfma_f32_16x16x32_bf16 v[84:87], v[212:215], v[28:31], v[84:87]
    buffer_load_dwordx4 a[152:155], v2, s[12:15], m0 offen offset:2048 sc1
    v_mfma_f32_16x16x32_bf16 v[88:91], v[216:219], v[28:31], v[88:91]
    v_mfma_f32_16x16x32_bf16 v[92:95], v[220:223], v[28:31], v[92:95]
    s_waitcnt lgkmcnt(8)
    v_add_f32 v112, v112, v128
    v_add_f32 v113, v113, v129
    v_add_f32 v114, v114, v130
    v_add_f32 v115, v115, v131
    v_add_f32 v116, v116, v132
    v_add_f32 v117, v117, v133
    v_add_f32 v118, v118, v134
    v_add_f32 v119, v119, v135
    v_pk_add_f32 v[80:81], v[80:81], v[112:113]
    v_pk_add_f32 v[82:83], v[82:83], v[114:115]
    v_pk_add_f32 v[84:85], v[84:85], v[116:117]
    v_pk_add_f32 v[86:87], v[86:87], v[118:119]
    s_waitcnt lgkmcnt(2)
    v_pk_add_f32 v[80:81], v[80:81], v[96:97]
    v_cvt_pk_bf16_f32 v48, v80, v81
    v_pk_add_f32 v[82:83], v[82:83], v[98:99]
    v_cvt_pk_bf16_f32 v49, v82, v83
    v_pk_add_f32 v[84:85], v[84:85], v[100:101]
    v_cvt_pk_bf16_f32 v50, v84, v85
    v_pk_add_f32 v[86:87], v[86:87], v[102:103]
    v_cvt_pk_bf16_f32 v51, v86, v87
    s_cmp_lg_u32 s31, 0
    s_cbranch_scc0 L_h0_s
    buffer_store_dwordx4 v[48:51], v7, s[12:15], s64 offen offset:0
L_h0_d:
    v_pk_add_f32 v[88:89], v[88:89], v[136:137]
    v_pk_add_f32 v[88:89], v[88:89], v[120:121]
    v_pk_add_f32 v[90:91], v[90:91], v[138:139]
    v_pk_add_f32 v[90:91], v[90:91], v[122:123]
    v_pk_add_f32 v[92:93], v[92:93], v[140:141]
    v_pk_add_f32 v[92:93], v[92:93], v[124:125]
    v_pk_add_f32 v[94:95], v[94:95], v[142:143]
    v_pk_add_f32 v[94:95], v[94:95], v[126:127]
    s_waitcnt lgkmcnt(0)
    v_pk_add_f32 v[88:89], v[88:89], v[104:105]
    v_cvt_pk_bf16_f32 v52, v88, v89
    v_pk_add_f32 v[90:91], v[90:91], v[106:107]
    v_cvt_pk_bf16_f32 v53, v90, v91
    v_pk_add_f32 v[92:93], v[92:93], v[108:109]
    v_cvt_pk_bf16_f32 v54, v92, v93
    v_pk_add_f32 v[94:95], v[94:95], v[110:111]
    v_cvt_pk_bf16_f32 v55, v94, v95
    s_cmp_lg_u32 s31, 0
    s_cbranch_scc0 L_h1_s
    buffer_store_dwordx4 v[52:55], v7, s[12:15], s64 offen offset:2048
L_h1_d:
    v_pk_mul_f32 v[58:59], v[80:81], v[80:81]
    v_pk_add_f32 v[56:57], v[80:81], v[82:83]
    v_pk_fma_f32 v[58:59], v[82:83], v[82:83], v[58:59]
    v_pk_add_f32 v[56:57], v[56:57], v[84:85]
    v_pk_fma_f32 v[58:59], v[84:85], v[84:85], v[58:59]
    v_pk_add_f32 v[56:57], v[56:57], v[86:87]
    v_pk_fma_f32 v[58:59], v[86:87], v[86:87], v[58:59]
    v_pk_add_f32 v[56:57], v[56:57], v[88:89]
    v_pk_fma_f32 v[58:59], v[88:89], v[88:89], v[58:59]
    v_pk_add_f32 v[56:57], v[56:57], v[90:91]
    v_pk_fma_f32 v[58:59], v[90:91], v[90:91], v[58:59]
    v_pk_add_f32 v[56:57], v[56:57], v[92:93]
    v_pk_fma_f32 v[58:59], v[92:93], v[92:93], v[58:59]
    v_pk_add_f32 v[56:57], v[56:57], v[94:95]
    v_pk_fma_f32 v[58:59], v[94:95], v[94:95], v[58:59]
    v_add_f32 v56, v56, v57
    v_add_f32 v57, v58, v59
    s_nop 1
    v_permlane16_swap_b32 v56, v57
    v_add_f32 v56, v56, v57
    v_mov_b32 v57, v56
    s_nop 1
    v_permlane32_swap_b32 v56, v57
    v_add_f32 v56, v56, v57
    s_cmp_lg_u32 s31, 0
    s_cbranch_scc0 L_s_s
    buffer_store_dword v56, v15, s[12:15], s65 offen
L_s_d:
    s_waitcnt lgkmcnt(0)
    v_and_b32 v13, 0xffff0000, v156
    v_sub_f32 v3, v156, v13
    v_cvt_pk_bf16_f32 v3, v13, v3
    v_lshrrev_b32 v13, 16, v13
    v_lshl_or_b32 v13, v244, 16, v13
    v_accvgpr_write_b32 a224, v3
    v_accvgpr_write_b32 a225, v13
    v_accvgpr_write_b32 a226, v244
    v_accvgpr_write_b32 a227, 0
    v_and_b32 v13, 0xffff0000, v157
    v_sub_f32 v3, v157, v13
    v_cvt_pk_bf16_f32 v3, v13, v3
    v_lshrrev_b32 v13, 16, v13
    v_lshl_or_b32 v13, v245, 16, v13
    v_accvgpr_write_b32 a228, v3
    v_accvgpr_write_b32 a229, v13
    v_accvgpr_write_b32 a230, v245
    v_accvgpr_write_b32 a231, 0
    v_and_b32 v13, 0xffff0000, v158
    v_sub_f32 v3, v158, v13
    v_cvt_pk_bf16_f32 v3, v13, v3
    v_lshrrev_b32 v13, 16, v13
    v_lshl_or_b32 v13, v246, 16, v13
    v_accvgpr_write_b32 a232, v3
    v_accvgpr_write_b32 a233, v13
    v_accvgpr_write_b32 a234, v246
    v_accvgpr_write_b32 a235, 0
    v_and_b32 v13, 0xffff0000, v159
    v_sub_f32 v3, v159, v13
    v_cvt_pk_bf16_f32 v3, v13, v3
    v_lshrrev_b32 v13, 16, v13
    v_lshl_or_b32 v13, v247, 16, v13
    v_accvgpr_write_b32 a236, v3
    v_accvgpr_write_b32 a237, v13
    v_accvgpr_write_b32 a238, v247
    v_accvgpr_write_b32 a239, 0
    s_lshl_b32 s77, s16, 6
    v_xor_b32 v240, s77, v249
    v_xor_b32 v244, s77, v254
    v_xor_b32 v241, 64, v240
    v_xor_b32 v245, 64, v244
    v_xor_b32 v242, 128, v240
    v_xor_b32 v246, 128, v244
    v_xor_b32 v243, 192, v240
    v_xor_b32 v247, 192, v244
    s_waitcnt vmcnt(0)
    s_cmp_lg_u32 s31, 0
    s_cbranch_scc0 L_f3_s
    buffer_store_dword v8, v4, s[12:15], s25 offen offset:2048
L_f3_d:
    ds_read_b64_tr_b16 v[192:193], v240 offset:0
    ds_read_b64_tr_b16 v[194:195], v240 offset:1024
    ds_read_b64_tr_b16 v[196:197], v241 offset:0
    ds_read_b64_tr_b16 v[198:199], v241 offset:1024
    ds_read_b64_tr_b16 v[200:201], v242 offset:0
    ds_read_b64_tr_b16 v[202:203], v242 offset:1024
    ds_read_b64_tr_b16 v[204:205], v240 offset:4096
    ds_read_b64_tr_b16 v[206:207], v240 offset:5120
    ds_read_b64_tr_b16 a[240:241], v241 offset:4096
    ds_read_b64_tr_b16 a[242:243], v241 offset:5120
    ds_read_b64_tr_b16 a[244:245], v240 offset:8192
    ds_read_b64_tr_b16 a[246:247], v240 offset:9216
    ds_read_b64_tr_b16 a[248:249], v241 offset:8192
    ds_read_b64_tr_b16 a[250:251], v241 offset:9216
    s_mov_b32 m0, s67
    v_lshlrev_b32 v144, 16, v232
    v_and_b32 v145, 0xffff0000, v232
    v_lshlrev_b32 v146, 16, v233
    v_and_b32 v147, 0xffff0000, v233
    v_lshlrev_b32 v148, 16, v234
    v_and_b32 v149, 0xffff0000, v234
    v_lshlrev_b32 v150, 16, v235
    v_and_b32 v151, 0xffff0000, v235
    v_lshlrev_b32 v152, 16, v236
    v_and_b32 v153, 0xffff0000, v236
    v_lshlrev_b32 v154, 16, v237
    v_and_b32 v155, 0xffff0000, v237
    v_lshlrev_b32 v156, 16, v238
    v_and_b32 v157, 0xffff0000, v238
    v_lshlrev_b32 v158, 16, v239
    v_and_b32 v159, 0xffff0000, v239
    v_pk_add_f32 v[224:225], v[144:145], v[80:81]
    v_pk_add_f32 v[226:227], v[146:147], v[82:83]
    v_pk_add_f32 v[228:229], v[148:149], v[84:85]
    v_pk_add_f32 v[230:231], v[150:151], v[86:87]
    v_pk_add_f32 v[232:233], v[152:153], v[88:89]
    v_pk_add_f32 v[234:235], v[154:155], v[90:91]
    v_pk_add_f32 v[236:237], v[156:157], v[92:93]
    v_pk_add_f32 v[238:239], v[158:159], v[94:95]
    s_branch L_near
L_pa:
    s_mov_b32 s26, 262144
L_pa_l:
    buffer_load_dword v13, v7, s[12:15], s69 offen offset:3200 sc1
    s_sub_u32 s26, s26, 1
    s_cbranch_scc1 L_pa_x
    s_waitcnt vmcnt(0)
    v_cmp_ne_u32 vcc, 1, v13
    s_cbranch_vccnz L_pa_l
L_w2_0:
    s_cbranch_execz L_w2_r
    s_branch L_pa_x
L_pb:
    s_mov_b32 s26, 262144
L_pb_l:
    buffer_load_dword v13, v7, s[12:15], s69 offen offset:2560 sc1
    s_sub_u32 s26, s26, 1
    s_cbranch_scc1 L_pb_x
    s_waitcnt vmcnt(0)
    v_cmp_ne_u32 vcc, 1, v13
    s_cbranch_vccnz L_pb_l
    s_branch L_pb_x
L_near:
    s_mov_b32 s26, 262144
L_p3:
    buffer_load_dword v13, v5, s[12:15], s66 offen offset:2048 sc1
    s_sub_u32 s26, s26, 1
    s_cbranch_scc1 L_p3_x
    s_waitcnt vmcnt(0)
    v_cmp_ne_u32 vcc, 1, v13
    s_cbranch_vccnz L_p3
L_p3_x:
    buffer_load_dwordx4 v[16:19], v2, s[12:15], m0 offen offset:0 sc1
    buffer_load_dwordx4 v[20:23], v2, s[12:15], m0 offen offset:1024 sc1
    buffer_load_dwordx4 v[24:27], v2, s[12:15], m0 offen offset:2048 sc1
    buffer_load_dwordx4 v[28:31], v2, s[12:15], m0 offen offset:3072 sc1
    s_add_u32 m0, s67, 4096
    s_nop 0
    buffer_load_dwordx4 v[32:35], v2, s[12:15], m0 offen offset:0 sc1
    buffer_load_dwordx4 v[36:39], v2, s[12:15], m0 offen offset:1024 sc1
    buffer_load_dwordx4 v[40:43], v2, s[12:15], m0 offen offset:2048 sc1
    buffer_load_dwordx4 v[44:47], v2, s[12:15], m0 offen offset:3072 sc1
    s_add_u32 m0, s67, 8192
    s_nop 0
    buffer_load_dwordx4 v[48:51], v2, s[12:15], m0 offen offset:0 sc1
    buffer_load_dwordx4 v[52:55], v2, s[12:15], m0 offen offset:1024 sc1
    s_cmp_lg_u32 s31, 0
    s_cselect_b64 vcc, -1, 0
    s_waitcnt vmcnt(9) lgkmcnt(10)
    v_mfma_f32_32x32x16_bf16 v[128:143], v[192:195], v[16:19], 0
    ds_read_b64_tr_b16 a[252:253], v240 offset:12288
    ds_read_b64_tr_b16 a[254:255], v240 offset:13312
    s_lshl_b32 s77, s16, 5
    s_add_u32 s77, s77, s20
    s_lshl_b32 s77, s77, 2
    v_mfma_f32_32x32x16_bf16 v[144:159], v[196:199], v[16:19], 0
    s_waitcnt lgkmcnt(8)
    buffer_load_dwordx4 v[208:211], v2, s[12:15], s68 offen offset:0 sc1
    ds_read_b64_tr_b16 v[192:193], v241 offset:12288
    ds_read_b64_tr_b16 v[194:195], v241 offset:13312
    v_mov_b32 v14, s77
    s_mul_i32 s77, s16, 7
    v_mfma_f32_32x32x16_bf16 v[160:175], v[200:203], v[16:19], 0
    s_waitcnt vmcnt(9)
    ds_read_b64_tr_b16 v[196:197], v240 offset:16384
    ds_read_b64_tr_b16 v[198:199], v240 offset:17408
    s_lshr_b32 s77, s77, 1
    v_and_b32 v7, 3, v1
    v_add_u32 v7, s77, v7
    v_mfma_f32_32x32x16_bf16 v[128:143], v[204:207], v[20:23], v[128:143]
    s_waitcnt lgkmcnt(8)
    buffer_load_dwordx4 v[212:215], v2, s[12:15], s68 offen offset:1024 sc1
    ds_read_b64_tr_b16 v[200:201], v241 offset:16384
    ds_read_b64_tr_b16 v[202:203], v241 offset:17408
    v_bfe_u32 v13, v1, 2, 1
    v_lshl_add_u32 v7, v13, 5, v7
    v_mfma_f32_32x32x16_bf16 v[144:159], a[240:243], v[20:23], v[144:159]
    s_waitcnt vmcnt(9)
    ds_read_b64_tr_b16 v[204:205], v240 offset:20480
    ds_read_b64_tr_b16 v[206:207], v240 offset:21504
    v_lshlrev_b32 v7, 2, v7
    v_lshrrev_b32 v250, 2, v2
    s_lshl_b32 s77, s16, 8
    v_mfma_f32_32x32x16_bf16 v[128:143], a[244:247], v[24:27], v[128:143]
    s_waitcnt lgkmcnt(8)
    buffer_load_dwordx4 v[56:59], v2, s[12:15], m0 offen offset:2048 sc1
    ds_read_b64_tr_b16 a[240:241], v241 offset:20480
    ds_read_b64_tr_b16 a[242:243], v241 offset:21504
    v_add_u32 v251, s77, v250
    v_and_b32 v250, 60, v250
    v_mfma_f32_32x32x16_bf16 v[144:159], a[248:251], v[24:27], v[144:159]
    s_waitcnt vmcnt(9)
    ds_read_b64_tr_b16 a[244:245], v240 offset:24576
    ds_read_b64_tr_b16 a[246:247], v240 offset:25600
    s_lshl_b32 s76, s76, 8
    s_lshr_b32 s77, s74, 5
    s_add_u32 s76, s76, s77
    v_mfma_f32_32x32x16_bf16 v[128:143], a[252:255], v[28:31], v[128:143]
    s_waitcnt lgkmcnt(8)
    buffer_load_dwordx4 v[60:63], v2, s[12:15], m0 offen offset:3072 sc1
    ds_read_b64_tr_b16 a[248:249], v241 offset:24576
    ds_read_b64_tr_b16 a[250:251], v241 offset:25600
    v_add_u32 v250, s76, v250
    s_mul_i32 s62, s63, 57344
    v_mfma_f32_32x32x16_bf16 v[144:159], v[192:195], v[28:31], v[144:159]
    s_waitcnt vmcnt(9)
    s_add_u32 m0, s67, 12288
    ds_read_b64_tr_b16 a[252:253], v240 offset:28672
    ds_read_b64_tr_b16 a[254:255], v240 offset:29696
    s_add_u32 s62, s62, s75
    s_xor_b32 s77, s63, 2
    s_mul_i32 s70, s77, 57344
    v_mfma_f32_32x32x16_bf16 v[128:143], v[196:199], v[32:35], v[128:143]
    s_waitcnt lgkmcnt(8)
    buffer_load_dwordx4 v[64:67], v2, s[12:15], m0 offen offset:0 sc1
    ds_read_b64_tr_b16 v[192:193], v241 offset:28672
    ds_read_b64_tr_b16 v[194:195], v241 offset:29696
    s_add_u32 s70, s70, s75
    s_xor_b32 s77, s63, 3
    v_mfma_f32_32x32x16_bf16 v[144:159], v[200:203], v[32:35], v[144:159]
    s_waitcnt vmcnt(9)
    ds_read_b64_tr_b16 v[196:197], v240 offset:32768
    ds_read_b64_tr_b16 v[198:199], v240 offset:33792
    s_mul_i32 s71, s77, 57344
    s_add_u32 s71, s71, s75
    s_xor_b32 s77, s63, 1
    v_mfma_f32_32x32x16_bf16 v[128:143], v[204:207], v[36:39], v[128:143]
    s_waitcnt lgkmcnt(8)
    buffer_load_dwordx4 v[68:71], v2, s[12:15], m0 offen offset:1024 sc1
    ds_read_b64_tr_b16 v[200:201], v241 offset:32768
    ds_read_b64_tr_b16 v[202:203], v241 offset:33792
    s_mul_i32 s63, s77, 57344
    s_add_u32 s63, s63, s75
    v_mfma_f32_32x32x16_bf16 v[144:159], a[240:243], v[36:39], v[144:159]
    s_waitcnt vmcnt(9)
    ds_read_b64_tr_b16 v[204:205], v242 offset:4096
    ds_read_b64_tr_b16 v[206:207], v242 offset:5120
    v_and_b32 v13, 16, v1
    v_mul_u32_u24 v13, 2560, v13
    v_add_u32 v255, v255, v13
    v_mfma_f32_32x32x16_bf16 v[128:143], a[244:247], v[40:43], v[128:143]
    s_waitcnt lgkmcnt(8)
    buffer_load_dwordx4 v[72:75], v2, s[12:15], m0 offen offset:2048 sc1
    ds_read_b64_tr_b16 a[240:241], v240 offset:36864
    ds_read_b64_tr_b16 a[242:243], v240 offset:37888
    v_add_u32 v255, s28, v255
    v_add_u32 v3, s74, v2
    v_mfma_f32_32x32x16_bf16 v[144:159], a[248:251], v[40:43], v[144:159]
    s_waitcnt vmcnt(9)
    ds_read_b64_tr_b16 a[244:245], v241 offset:36864
    ds_read_b64_tr_b16 a[246:247], v241 offset:37888
    v_xor_b32 v4, 2048, v3
    v_mfma_f32_32x32x16_bf16 v[128:143], a[252:255], v[44:47], v[128:143]
    s_waitcnt lgkmcnt(8)
    buffer_load_dwordx4 v[76:79], v2, s[12:15], m0 offen offset:3072 sc1
    ds_read_b64_tr_b16 a[248:249], v242 offset:8192
    ds_read_b64_tr_b16 a[250:251], v242 offset:9216
    v_mfma_f32_32x32x16_bf16 v[144:159], v[192:195], v[44:47], v[144:159]
    s_waitcnt vmcnt(9)
    s_add_u32 m0, s67, 16384
    ds_read_b64_tr_b16 a[252:253], v242 offset:12288
    ds_read_b64_tr_b16 a[254:255], v242 offset:13312
    v_mfma_f32_32x32x16_bf16 v[128:143], v[196:199], v[48:51], v[128:143]
    s_waitcnt lgkmcnt(8)
    buffer_load_dwordx4 v[80:83], v2, s[12:15], m0 offen offset:0 sc1
    ds_read_b64_tr_b16 v[192:193], v242 offset:16384
    ds_read_b64_tr_b16 v[194:195], v242 offset:17408
    v_mfma_f32_32x32x16_bf16 v[144:159], v[200:203], v[48:51], v[144:159]
    ds_read_b64_tr_b16 v[196:197], v242 offset:20480
    ds_read_b64_tr_b16 v[198:199], v242 offset:21504
    v_mfma_f32_32x32x16_bf16 v[160:175], v[204:207], v[20:23], v[160:175]
    s_waitcnt vmcnt(9) lgkmcnt(8)
    buffer_load_dwordx4 v[84:87], v2, s[12:15], m0 offen offset:1024 sc1
    ds_read_b64_tr_b16 v[200:201], v240 offset:40960
    ds_read_b64_tr_b16 v[202:203], v240 offset:41984
    v_mfma_f32_32x32x16_bf16 v[128:143], a[240:243], v[52:55], v[128:143]
    ds_read_b64_tr_b16 v[204:205], v241 offset:40960
    ds_read_b64_tr_b16 v[206:207], v241 offset:41984
    v_mfma_f32_32x32x16_bf16 v[144:159], a[244:247], v[52:55], v[144:159]
    s_waitcnt lgkmcnt(8)
    buffer_load_dwordx4 v[88:91], v2, s[12:15], m0 offen offset:2048 sc1
    ds_read_b64_tr_b16 a[240:241], v240 offset:45056
    ds_read_b64_tr_b16 a[242:243], v240 offset:46080
    v_mfma_f32_32x32x16_bf16 v[160:175], a[248:251], v[24:27], v[160:175]
    ds_read_b64_tr_b16 a[244:245], v241 offset:45056
    ds_read_b64_tr_b16 a[246:247], v241 offset:46080
    v_mfma_f32_32x32x16_bf16 v[160:175], a[252:255], v[28:31], v[160:175]
    s_waitcnt lgkmcnt(8)
    buffer_load_dwordx4 v[92:95], v2, s[12:15], m0 offen offset:3072 sc1
    ds_read_b64_tr_b16 a[248:249], v240 offset:49152
    ds_read_b64_tr_b16 a[250:251], v240 offset:50176
    v_mfma_f32_32x32x16_bf16 v[160:175], v[192:195], v[32:35], v[160:175]
    s_add_u32 m0, s67, 20480
    ds_read_b64_tr_b16 a[252:253], v241 offset:49152
    ds_read_b64_tr_b16 a[254:255], v241 offset:50176
    v_mfma_f32_32x32x16_bf16 v[160:175], v[196:199], v[36:39], v[160:175]
    s_waitcnt vmcnt(9) lgkmcnt(8)
    buffer_load_dwordx4 v[96:99], v2, s[12:15], m0 offen offset:0 sc1
    ds_read_b64_tr_b16 v[192:193], v240 offset:53248
    ds_read_b64_tr_b16 v[194:195], v240 offset:54272
    v_mfma_f32_32x32x16_bf16 v[128:143], v[200:203], v[56:59], v[128:143]
    ds_read_b64_tr_b16 v[196:197], v241 offset:53248
    ds_read_b64_tr_b16 v[198:199], v241 offset:54272
    v_mfma_f32_32x32x16_bf16 v[144:159], v[204:207], v[56:59], v[144:159]
    s_waitcnt vmcnt(9) lgkmcnt(8)
    buffer_load_dwordx4 v[100:103], v2, s[12:15], m0 offen offset:1024 sc1
    ds_read_b64_tr_b16 v[200:201], v240 offset:57344
    ds_read_b64_tr_b16 v[202:203], v240 offset:58368
    v_mfma_f32_32x32x16_bf16 v[128:143], a[240:243], v[60:63], v[128:143]
    ds_read_b64_tr_b16 v[204:205], v241 offset:57344
    ds_read_b64_tr_b16 v[206:207], v241 offset:58368
    v_and_b32 v214, v6, v214
    v_and_b32 v215, v6, v215
    v_mfma_f32_32x32x16_bf16 v[144:159], a[244:247], v[60:63], v[144:159]
    s_waitcnt vmcnt(9) lgkmcnt(8)
    buffer_load_dwordx4 v[104:107], v2, s[12:15], m0 offen offset:2048 sc1
    ds_read_b64_tr_b16 a[240:241], v242 offset:24576
    ds_read_b64_tr_b16 a[242:243], v242 offset:25600
    v_add_f32 v208, v208, v210
    v_add_f32 v209, v209, v211
    v_mfma_f32_32x32x16_bf16 v[128:143], a[248:251], v[64:67], v[128:143]
    ds_read_b64_tr_b16 a[244:245], v240 offset:61440
    ds_read_b64_tr_b16 a[246:247], v240 offset:62464
    v_add_f32 v208, v208, v212
    v_add_f32 v209, v209, v213
    v_add_f32 v208, v208, v214
    v_mfma_f32_32x32x16_bf16 v[144:159], a[252:255], v[64:67], v[144:159]
    s_waitcnt vmcnt(9) lgkmcnt(8)
    buffer_load_dwordx4 v[108:111], v2, s[12:15], m0 offen offset:3072 sc1
    ds_read_b64_tr_b16 a[248:249], v241 offset:61440
    ds_read_b64_tr_b16 a[250:251], v241 offset:62464
    v_add_f32 v209, v209, v215
    v_mov_b32 v210, v208
    v_mfma_f32_32x32x16_bf16 v[128:143], v[192:195], v[68:71], v[128:143]
    s_add_u32 m0, s67, 24576
    ds_read_b64_tr_b16 a[252:253], v244 offset:0
    ds_read_b64_tr_b16 a[254:255], v244 offset:1024
    v_mov_b32 v211, v209
    v_permlane32_swap_b32 v208, v210
    s_nop 0
    v_permlane32_swap_b32 v209, v211
    v_mfma_f32_32x32x16_bf16 v[144:159], v[196:199], v[68:71], v[144:159]
    s_waitcnt vmcnt(9) lgkmcnt(8)
    buffer_load_dwordx4 v[112:115], v2, s[12:15], m0 offen offset:0 sc1
    ds_read_b64_tr_b16 v[192:193], v245 offset:0
    ds_read_b64_tr_b16 v[194:195], v245 offset:1024
    v_add_f32 v208, v208, v210
    v_add_f32 v209, v209, v211
    v_mfma_f32_32x32x16_bf16 v[128:143], v[200:203], v[72:75], v[128:143]
    ds_read_b64_tr_b16 v[196:197], v244 offset:4096
    ds_read_b64_tr_b16 v[198:199], v244 offset:5120
    v_mul_f32 v211, 0x3b124925, v208
    v_mul_f32 v210, v211, v211
    v_mov_b32 v212, 0x3b124925
    v_mfma_f32_32x32x16_bf16 v[144:159], v[204:207], v[72:75], v[144:159]
    s_waitcnt lgkmcnt(8)
    buffer_load_dwordx4 v[116:119], v2, s[12:15], m0 offen offset:1024 sc1
    ds_read_b64_tr_b16 v[200:201], v245 offset:4096
    ds_read_b64_tr_b16 v[202:203], v245 offset:5120
    v_fma_f32 v210, v209, v212, -v210
    v_max_f32 v210, 0, v210
    v_mfma_f32_32x32x16_bf16 v[160:175], a[240:243], v[40:43], v[160:175]
    s_waitcnt vmcnt(10)
    ds_read_b64_tr_b16 v[204:205], v244 offset:8192
    ds_read_b64_tr_b16 v[206:207], v244 offset:9216
    v_add_f32 v210, 0x3727c5ac, v210
    v_rsq_f32 v212, v210
    s_nop 0
    v_mul_f32 v213, v210, v212
    v_mfma_f32_32x32x16_bf16 v[128:143], a[244:247], v[76:79], v[128:143]
    s_waitcnt lgkmcnt(8)
    buffer_load_dwordx4 v[120:123], v2, s[12:15], m0 offen offset:2048 sc1
    ds_read_b64_tr_b16 a[240:241], v245 offset:8192
    ds_read_b64_tr_b16 a[242:243], v245 offset:9216
    v_sub_f32 v211, 0, v211
    v_and_b32 v211, v6, v211
    v_mfma_f32_32x32x16_bf16 v[144:159], a[248:251], v[76:79], v[144:159]
    s_waitcnt vmcnt(10)
    ds_read_b64_tr_b16 a[244:245], v244 offset:12288
    ds_read_b64_tr_b16 a[246:247], v244 offset:13312
    v_and_b32 v213, v6, v213
    v_and_b32 v214, 0xffff0000, v211
    v_sub_f32 v215, v211, v214
    v_mfma_f32_32x32x16_bf16 v[128:143], a[252:255], v[80:83], v[128:143]
    s_waitcnt lgkmcnt(8)
    buffer_load_dwordx4 v[124:127], v2, s[12:15], m0 offen offset:3072 sc1
    ds_read_b64_tr_b16 a[248:249], v245 offset:12288
    ds_read_b64_tr_b16 a[250:251], v245 offset:13312
    v_cvt_pk_bf16_f32 v216, v214, v214
    v_and_b32 v214, 0xffff0000, v213
    v_mfma_f32_32x32x16_bf16 v[144:159], v[192:195], v[80:83], v[144:159]
    s_waitcnt vmcnt(10)
    s_add_u32 m0, s72, 36864
    ds_read_b64_tr_b16 a[252:253], v244 offset:16384
    ds_read_b64_tr_b16 a[254:255], v244 offset:17408
    v_cvt_pk_bf16_f32 v217, v215, v214
    v_sub_f32 v215, v213, v214
    v_cvt_pk_bf16_f32 v218, v215, 0
    v_mfma_f32_32x32x16_bf16 v[128:143], v[196:199], v[84:87], v[128:143]
    s_waitcnt lgkmcnt(8)
    buffer_load_dwordx4 a[156:159], v2, s[12:15], m0 offen offset:3072 sc1
    ds_read_b64_tr_b16 v[192:193], v245 offset:16384
    ds_read_b64_tr_b16 v[194:195], v245 offset:17408
    v_mov_b32 v219, 0
    v_mul_f32 v248, v212, v212
    v_mfma_f32_32x32x16_bf16 v[144:159], v[200:203], v[84:87], v[144:159]
    s_waitcnt vmcnt(10)
    s_add_u32 m0, s73, 40960
    ds_read_b64_tr_b16 v[196:197], v244 offset:20480
    ds_read_b64_tr_b16 v[198:199], v244 offset:21504
    v_mfma_f32_32x32x16_bf16 v[128:143], v[204:207], v[88:91], v[128:143]
    s_waitcnt lgkmcnt(8)
    buffer_load_dwordx4 a[160:163], v2, s[12:15], m0 offen offset:0 sc1
    ds_read_b64_tr_b16 v[200:201], v245 offset:20480
    ds_read_b64_tr_b16 v[202:203], v245 offset:21504
    v_mfma_f32_32x32x16_bf16 v[144:159], a[240:243], v[88:91], v[144:159]
    s_waitcnt vmcnt(10)
    ds_read_b64_tr_b16 v[204:205], v244 offset:24576
    ds_read_b64_tr_b16 v[206:207], v244 offset:25600
    v_mfma_f32_32x32x16_bf16 v[128:143], a[244:247], v[92:95], v[128:143]
    s_waitcnt lgkmcnt(8)
    buffer_load_dwordx4 a[164:167], v2, s[12:15], m0 offen offset:1024 sc1
    ds_read_b64_tr_b16 a[240:241], v245 offset:24576
    ds_read_b64_tr_b16 a[242:243], v245 offset:25600
    v_mfma_f32_32x32x16_bf16 v[144:159], a[248:251], v[92:95], v[144:159]
    s_waitcnt vmcnt(10)
    ds_read_b64_tr_b16 a[244:245], v242 offset:28672
    ds_read_b64_tr_b16 a[246:247], v242 offset:29696
    v_mfma_f32_32x32x16_bf16 v[128:143], a[252:255], v[96:99], v[128:143]
    s_waitcnt lgkmcnt(8)
    buffer_load_dwordx4 a[168:171], v2, s[12:15], m0 offen offset:2048 sc1
    ds_read_b64_tr_b16 a[248:249], v244 offset:28672
    ds_read_b64_tr_b16 a[250:251], v244 offset:29696
    v_mfma_f32_32x32x16_bf16 v[144:159], v[192:195], v[96:99], v[144:159]
    s_waitcnt vmcnt(10)
    ds_read_b64_tr_b16 a[252:253], v245 offset:28672
    ds_read_b64_tr_b16 a[254:255], v245 offset:29696
    v_mfma_f32_32x32x16_bf16 v[128:143], v[196:199], v[100:103], v[128:143]
    s_waitcnt lgkmcnt(8)
    buffer_load_dwordx4 a[172:175], v2, s[12:15], m0 offen offset:3072 sc1
    ds_read_b64_tr_b16 v[192:193], v244 offset:32768
    ds_read_b64_tr_b16 v[194:195], v244 offset:33792
    v_mfma_f32_32x32x16_bf16 v[144:159], v[200:203], v[100:103], v[144:159]
    s_waitcnt vmcnt(10)
    s_add_u32 m0, s73, 45056
    ds_read_b64_tr_b16 v[196:197], v245 offset:32768
    ds_read_b64_tr_b16 v[198:199], v245 offset:33792
    v_mfma_f32_32x32x16_bf16 v[128:143], v[204:207], v[104:107], v[128:143]
    s_waitcnt lgkmcnt(8)
    buffer_load_dwordx4 a[176:179], v2, s[12:15], m0 offen offset:0 sc1
    ds_read_b64_tr_b16 v[200:201], v244 offset:36864
    ds_read_b64_tr_b16 v[202:203], v244 offset:37888
    v_mfma_f32_32x32x16_bf16 v[144:159], a[240:243], v[104:107], v[144:159]
    ds_read_b64_tr_b16 v[204:205], v245 offset:36864
    ds_read_b64_tr_b16 v[206:207], v245 offset:37888
    v_mfma_f32_32x32x16_bf16 v[160:175], a[244:247], v[44:47], v[160:175]
    s_waitcnt vmcnt(10) lgkmcnt(8)
    buffer_load_dwordx4 a[180:183], v2, s[12:15], m0 offen offset:1024 sc1
    ds_read_b64_tr_b16 a[240:241], v244 offset:40960
    ds_read_b64_tr_b16 a[242:243], v244 offset:41984
    v_mfma_f32_32x32x16_bf16 v[128:143], a[248:251], v[108:111], v[128:143]
    ds_read_b64_tr_b16 a[244:245], v245 offset:40960
    ds_read_b64_tr_b16 a[246:247], v245 offset:41984
    v_mfma_f32_32x32x16_bf16 v[144:159], a[252:255], v[108:111], v[144:159]
    s_waitcnt vmcnt(10) lgkmcnt(8)
    buffer_load_dwordx4 a[184:187], v2, s[12:15], m0 offen offset:2048 sc1
    ds_read_b64_tr_b16 a[248:249], v244 offset:45056
    ds_read_b64_tr_b16 a[250:251], v244 offset:46080
    v_mfma_f32_32x32x16_bf16 v[128:143], v[192:195], v[112:115], v[128:143]
    ds_read_b64_tr_b16 a[252:253], v245 offset:45056
    ds_read_b64_tr_b16 a[254:255], v245 offset:46080
    v_mfma_f32_32x32x16_bf16 v[144:159], v[196:199], v[112:115], v[144:159]
    s_waitcnt vmcnt(10) lgkmcnt(8)
    buffer_load_dwordx4 a[188:191], v2, s[12:15], m0 offen offset:3072 sc1
    ds_read_b64_tr_b16 v[192:193], v242 offset:32768
    ds_read_b64_tr_b16 v[194:195], v242 offset:33792
    v_mfma_f32_32x32x16_bf16 v[128:143], v[200:203], v[116:119], v[128:143]
    s_add_u32 m0, s45, 49152
    ds_read_b64_tr_b16 v[196:197], v242 offset:36864
    ds_read_b64_tr_b16 v[198:199], v242 offset:37888
    v_mfma_f32_32x32x16_bf16 v[144:159], v[204:207], v[116:119], v[144:159]
    s_waitcnt vmcnt(10) lgkmcnt(8)
    buffer_load_dwordx4 a[192:195], v2, s[12:15], m0 offen offset:0 sc1
    ds_read_b64_tr_b16 v[200:201], v242 offset:40960
    ds_read_b64_tr_b16 v[202:203], v242 offset:41984
    v_mfma_f32_32x32x16_bf16 v[128:143], a[240:243], v[120:123], v[128:143]
    ds_read_b64_tr_b16 v[204:205], v242 offset:45056
    ds_read_b64_tr_b16 v[206:207], v242 offset:46080
    v_mfma_f32_32x32x16_bf16 v[144:159], a[244:247], v[120:123], v[144:159]
    s_waitcnt vmcnt(10) lgkmcnt(8)
    buffer_load_dwordx4 a[196:199], v2, s[12:15], m0 offen offset:1024 sc1
    ds_read_b64_tr_b16 a[240:241], v242 offset:49152
    ds_read_b64_tr_b16 a[242:243], v242 offset:50176
    v_mfma_f32_32x32x16_bf16 v[128:143], a[224:227], v[216:219], v[128:143]
    v_mfma_f32_32x32x16_bf16 v[144:159], a[228:231], v[216:219], v[144:159]
    v_mfma_f32_32x32x16_bf16 v[160:175], a[232:235], v[216:219], v[160:175]
    v_mfma_f32_32x32x16_bf16 v[128:143], a[248:251], v[124:127], v[128:143]
    ds_read_b64_tr_b16 a[244:245], v242 offset:53248
    ds_read_b64_tr_b16 a[246:247], v242 offset:54272
    v_mfma_f32_32x32x16_bf16 v[144:159], a[252:255], v[124:127], v[144:159]
    s_waitcnt lgkmcnt(8)
    buffer_load_dwordx4 a[200:203], v2, s[12:15], m0 offen offset:2048 sc1
    ds_read_b64_tr_b16 a[248:249], v242 offset:57344
    ds_read_b64_tr_b16 a[250:251], v242 offset:58368
    v_mfma_f32_32x32x16_bf16 v[160:175], v[192:195], v[48:51], v[160:175]
    ds_read_b64_tr_b16 a[252:253], v242 offset:61440
    ds_read_b64_tr_b16 a[254:255], v242 offset:62464
    v_mfma_f32_32x32x16_bf16 v[160:175], v[196:199], v[52:55], v[160:175]
    s_waitcnt lgkmcnt(8)
    buffer_load_dwordx4 a[204:207], v2, s[12:15], m0 offen offset:3072 sc1
    ds_read_b64_tr_b16 v[192:193], v246 offset:0
    ds_read_b64_tr_b16 v[194:195], v246 offset:1024
    v_mfma_f32_32x32x16_bf16 v[160:175], v[200:203], v[56:59], v[160:175]
    s_add_u32 m0, s45, 53248
    ds_read_b64_tr_b16 v[196:197], v246 offset:4096
    ds_read_b64_tr_b16 v[198:199], v246 offset:5120
    v_mul_f32 v128, v128, abs(v128)
    v_mul_f32 v129, v129, abs(v129)
    v_cvt_pk_bf16_f32 v128, v128, v129
    v_mfma_f32_32x32x16_bf16 v[160:175], v[204:207], v[60:63], v[160:175]
    s_waitcnt lgkmcnt(8)
    buffer_load_dwordx4 a[208:211], v2, s[12:15], m0 offen offset:0 sc1
    ds_read_b64_tr_b16 v[200:201], v246 offset:8192
    ds_read_b64_tr_b16 v[202:203], v246 offset:9216
    v_pk_max_i16 v128, v128, 0
    v_mul_f32 v130, v130, abs(v130)
    v_mfma_f32_32x32x16_bf16 v[160:175], a[240:243], v[64:67], v[160:175]
    ds_read_b64_tr_b16 v[204:205], v246 offset:12288
    ds_read_b64_tr_b16 v[206:207], v246 offset:13312
    v_mul_f32 v131, v131, abs(v131)
    v_cvt_pk_bf16_f32 v129, v130, v131
    v_pk_max_i16 v129, v129, 0
    v_mfma_f32_32x32x16_bf16 v[160:175], a[244:247], v[68:71], v[160:175]
    s_waitcnt lgkmcnt(8)
    buffer_load_dwordx4 a[212:215], v2, s[12:15], m0 offen offset:1024 sc1
    ds_read_b64_tr_b16 a[240:241], v246 offset:16384
    ds_read_b64_tr_b16 a[242:243], v246 offset:17408
    v_mul_f32 v132, v132, abs(v132)
    v_mul_f32 v133, v133, abs(v133)
    v_mfma_f32_32x32x16_bf16 v[160:175], a[248:251], v[72:75], v[160:175]
    ds_read_b64_tr_b16 a[244:245], v246 offset:20480
    ds_read_b64_tr_b16 a[246:247], v246 offset:21504
    v_cvt_pk_bf16_f32 v130, v132, v133
    v_pk_max_i16 v130, v130, 0
    v_mul_f32 v134, v134, abs(v134)
    v_mfma_f32_32x32x16_bf16 v[160:175], a[252:255], v[76:79], v[160:175]
    s_waitcnt lgkmcnt(8)
    buffer_load_dwordx4 a[216:219], v2, s[12:15], m0 offen offset:2048 sc1
    ds_read_b64_tr_b16 a[248:249], v246 offset:24576
    ds_read_b64_tr_b16 a[250:251], v246 offset:25600
    v_mul_f32 v135, v135, abs(v135)
    v_cvt_pk_bf16_f32 v131, v134, v135
    v_mfma_f32_32x32x16_bf16 v[160:175], v[192:195], v[80:83], v[160:175]
    ds_read_b64_tr_b16 a[252:253], v246 offset:28672
    ds_read_b64_tr_b16 a[254:255], v246 offset:29696
    v_pk_max_i16 v131, v131, 0
    s_cbranch_vccz L_e0_s
    buffer_store_dwordx4 v[128:131], v255, s[12:15], 0 offen offset:0 nt
L_e0_d:
    v_mul_f32 v136, v136, abs(v136)
    v_mfma_f32_32x32x16_bf16 v[160:175], v[196:199], v[84:87], v[160:175]
    s_waitcnt lgkmcnt(8)
    buffer_load_dwordx4 a[220:223], v2, s[12:15], m0 offen offset:3072 sc1
    ds_read_b64_tr_b16 v[192:193], v246 offset:32768
    ds_read_b64_tr_b16 v[194:195], v246 offset:33792
    v_mul_f32 v137, v137, abs(v137)
    v_cvt_pk_bf16_f32 v132, v136, v137
    v_mfma_f32_32x32x16_bf16 v[160:175], v[200:203], v[88:91], v[160:175]
    ds_read_b64_tr_b16 v[196:197], v246 offset:36864
    ds_read_b64_tr_b16 v[198:199], v246 offset:37888
    v_pk_max_i16 v132, v132, 0
    v_mul_f32 v138, v138, abs(v138)
    v_mul_f32 v139, v139, abs(v139)
    v_mfma_f32_32x32x16_bf16 v[160:175], v[204:207], v[92:95], v[160:175]
    s_waitcnt lgkmcnt(8)
    ds_read_b64_tr_b16 v[200:201], v246 offset:40960
    ds_read_b64_tr_b16 v[202:203], v246 offset:41984
    v_cvt_pk_bf16_f32 v133, v138, v139
    v_pk_max_i16 v133, v133, 0
    v_mul_f32 v140, v140, abs(v140)
    v_mfma_f32_32x32x16_bf16 v[160:175], a[240:243], v[96:99], v[160:175]
    ds_read_b64_tr_b16 v[204:205], v246 offset:45056
    ds_read_b64_tr_b16 v[206:207], v246 offset:46080
    v_mul_f32 v141, v141, abs(v141)
    v_cvt_pk_bf16_f32 v134, v140, v141
    v_pk_max_i16 v134, v134, 0
    v_mfma_f32_32x32x16_bf16 v[160:175], a[244:247], v[100:103], v[160:175]
    s_waitcnt lgkmcnt(8)
    ds_read_b64_tr_b16 a[240:241], v243 offset:0
    ds_read_b64_tr_b16 a[242:243], v243 offset:1024
    v_mul_f32 v142, v142, abs(v142)
    v_mul_f32 v143, v143, abs(v143)
    v_cvt_pk_bf16_f32 v135, v142, v143
    v_mfma_f32_32x32x16_bf16 v[160:175], a[248:251], v[104:107], v[160:175]
    ds_read_b64_tr_b16 a[244:245], v243 offset:4096
    ds_read_b64_tr_b16 a[246:247], v243 offset:5120
    v_pk_max_i16 v135, v135, 0
    s_cbranch_vccz L_e1_s
    buffer_store_dwordx4 v[132:135], v255, s[12:15], 0 offen offset:512 nt
L_e1_d:
    v_mul_f32 v144, v144, abs(v144)
    v_mfma_f32_32x32x16_bf16 v[160:175], a[252:255], v[108:111], v[160:175]
    s_waitcnt lgkmcnt(8)
    ds_read_b64_tr_b16 a[248:249], v243 offset:8192
    ds_read_b64_tr_b16 a[250:251], v243 offset:9216
    v_mul_f32 v145, v145, abs(v145)
    v_cvt_pk_bf16_f32 v144, v144, v145
    v_pk_max_i16 v144, v144, 0
    v_mfma_f32_32x32x16_bf16 v[160:175], v[192:195], v[112:115], v[160:175]
    ds_read_b64_tr_b16 a[252:253], v243 offset:12288
    ds_read_b64_tr_b16 a[254:255], v243 offset:13312
    v_mul_f32 v146, v146, abs(v146)
    v_mul_f32 v147, v147, abs(v147)
    v_cvt_pk_bf16_f32 v145, v146, v147
    v_mfma_f32_32x32x16_bf16 v[160:175], v[196:199], v[116:119], v[160:175]
    s_waitcnt lgkmcnt(8)
    ds_read_b64_tr_b16 v[192:193], v243 offset:16384
    ds_read_b64_tr_b16 v[194:195], v243 offset:17408
    v_pk_max_i16 v145, v145, 0
    v_mul_f32 v148, v148, abs(v148)
    v_mul_f32 v149, v149, abs(v149)
    v_mfma_f32_32x32x16_bf16 v[160:175], v[200:203], v[120:123], v[160:175]
    ds_read_b64_tr_b16 v[196:197], v243 offset:20480
    ds_read_b64_tr_b16 v[198:199], v243 offset:21504
    v_cvt_pk_bf16_f32 v146, v148, v149
    v_pk_max_i16 v146, v146, 0
    v_mul_f32 v150, v150, abs(v150)
    v_mfma_f32_32x32x16_bf16 v[160:175], v[204:207], v[124:127], v[160:175]
    s_waitcnt lgkmcnt(8)
    ds_read_b64_tr_b16 v[200:201], v243 offset:24576
    ds_read_b64_tr_b16 v[202:203], v243 offset:25600
    v_mul_f32 v151, v151, abs(v151)
    v_cvt_pk_bf16_f32 v147, v150, v151
    v_pk_max_i16 v147, v147, 0
    v_mfma_f32_32x32x16_bf16 v[176:191], a[236:239], v[216:219], 0
    v_mfma_f32_32x32x16_bf16 v[176:191], a[240:243], v[16:19], v[176:191]
    ds_read_b64_tr_b16 v[204:205], v243 offset:28672
    ds_read_b64_tr_b16 v[206:207], v243 offset:29696
    s_cbranch_vccz L_e2_s
    buffer_store_dwordx4 v[144:147], v255, s[12:15], 0 offen offset:1024 nt
L_e2_d:
    v_mul_f32 v152, v152, abs(v152)
    v_mul_f32 v153, v153, abs(v153)
    v_mfma_f32_32x32x16_bf16 v[176:191], a[244:247], v[20:23], v[176:191]
    s_waitcnt lgkmcnt(8)
    ds_read_b64_tr_b16 a[240:241], v243 offset:32768
    ds_read_b64_tr_b16 a[242:243], v243 offset:33792
    v_cvt_pk_bf16_f32 v148, v152, v153
    v_pk_max_i16 v148, v148, 0
    v_mul_f32 v154, v154, abs(v154)
    v_mfma_f32_32x32x16_bf16 v[176:191], a[248:251], v[24:27], v[176:191]
    ds_read_b64_tr_b16 a[244:245], v243 offset:36864
    ds_read_b64_tr_b16 a[246:247], v243 offset:37888
    v_mul_f32 v155, v155, abs(v155)
    v_cvt_pk_bf16_f32 v149, v154, v155
    v_pk_max_i16 v149, v149, 0
    v_mfma_f32_32x32x16_bf16 v[176:191], a[252:255], v[28:31], v[176:191]
    s_waitcnt lgkmcnt(8)
    ds_read_b64_tr_b16 a[248:249], v243 offset:40960
    ds_read_b64_tr_b16 a[250:251], v243 offset:41984
    v_mul_f32 v156, v156, abs(v156)
    v_mul_f32 v157, v157, abs(v157)
    v_cvt_pk_bf16_f32 v150, v156, v157
    v_mfma_f32_32x32x16_bf16 v[176:191], v[192:195], v[32:35], v[176:191]
    ds_read_b64_tr_b16 a[252:253], v243 offset:45056
    ds_read_b64_tr_b16 a[254:255], v243 offset:46080
    v_pk_max_i16 v150, v150, 0
    v_mul_f32 v158, v158, abs(v158)
    v_mul_f32 v159, v159, abs(v159)
    v_mfma_f32_32x32x16_bf16 v[176:191], v[196:199], v[36:39], v[176:191]
    s_waitcnt lgkmcnt(8)
    ds_read_b64_tr_b16 v[192:193], v243 offset:49152
    ds_read_b64_tr_b16 v[194:195], v243 offset:50176
    v_cvt_pk_bf16_f32 v151, v158, v159
    v_pk_max_i16 v151, v151, 0
    s_cbranch_vccz L_e3_s
    buffer_store_dwordx4 v[148:151], v255, s[12:15], 0 offen offset:1536 nt
L_e3_d:
    v_mfma_f32_32x32x16_bf16 v[176:191], v[200:203], v[40:43], v[176:191]
    ds_read_b64_tr_b16 v[196:197], v243 offset:53248
    ds_read_b64_tr_b16 v[198:199], v243 offset:54272
    v_mul_f32 v160, v160, abs(v160)
    v_mul_f32 v161, v161, abs(v161)
    v_cvt_pk_bf16_f32 v160, v160, v161
    v_mfma_f32_32x32x16_bf16 v[176:191], v[204:207], v[44:47], v[176:191]
    s_waitcnt lgkmcnt(8)
    ds_read_b64_tr_b16 v[200:201], v243 offset:57344
    ds_read_b64_tr_b16 v[202:203], v243 offset:58368
    v_pk_max_i16 v160, v160, 0
    v_mul_f32 v162, v162, abs(v162)
    v_mul_f32 v163, v163, abs(v163)
    v_mfma_f32_32x32x16_bf16 v[176:191], a[240:243], v[48:51], v[176:191]
    ds_read_b64_tr_b16 v[204:205], v243 offset:61440
    ds_read_b64_tr_b16 v[206:207], v243 offset:62464
    v_cvt_pk_bf16_f32 v161, v162, v163
    v_pk_max_i16 v161, v161, 0
    v_mul_f32 v164, v164, abs(v164)
    v_mfma_f32_32x32x16_bf16 v[176:191], a[244:247], v[52:55], v[176:191]
    s_waitcnt lgkmcnt(8)
    ds_read_b64_tr_b16 a[240:241], v247 offset:0
    ds_read_b64_tr_b16 a[242:243], v247 offset:1024
    v_mul_f32 v165, v165, abs(v165)
    v_cvt_pk_bf16_f32 v162, v164, v165
    v_pk_max_i16 v162, v162, 0
    v_mfma_f32_32x32x16_bf16 v[176:191], a[248:251], v[56:59], v[176:191]
L_w2_1:
    s_cbranch_execz L_w2_r
    ds_read_b64_tr_b16 a[244:245], v247 offset:4096
    ds_read_b64_tr_b16 a[246:247], v247 offset:5120
    v_mul_f32 v166, v166, abs(v166)
    v_mul_f32 v167, v167, abs(v167)
    v_cvt_pk_bf16_f32 v163, v166, v167
    v_mfma_f32_32x32x16_bf16 v[176:191], a[252:255], v[60:63], v[176:191]
    s_waitcnt lgkmcnt(8)
    ds_read_b64_tr_b16 a[248:249], v247 offset:8192
    ds_read_b64_tr_b16 a[250:251], v247 offset:9216
    v_pk_max_i16 v163, v163, 0
    s_cbranch_vccz L_e4_s
    buffer_store_dwordx4 v[160:163], v255, s[12:15], 0 offen offset:2048 nt
L_e4_d:
    v_mul_f32 v168, v168, abs(v168)
    v_mfma_f32_32x32x16_bf16 v[176:191], v[192:195], v[64:67], v[176:191]
    ds_read_b64_tr_b16 a[252:253], v247 offset:12288
    ds_read_b64_tr_b16 a[254:255], v247 offset:13312
    v_mul_f32 v169, v169, abs(v169)
    v_cvt_pk_bf16_f32 v164, v168, v169
    v_pk_max_i16 v164, v164, 0
    v_mfma_f32_32x32x16_bf16 v[176:191], v[196:199], v[68:71], v[176:191]
    s_waitcnt lgkmcnt(8)
    ds_read_b64_tr_b16 v[192:193], v247 offset:16384
    ds_read_b64_tr_b16 v[194:195], v247 offset:17408
    v_mul_f32 v170, v170, abs(v170)
    v_mul_f32 v171, v171, abs(v171)
    v_cvt_pk_bf16_f32 v165, v170, v171
    v_mfma_f32_32x32x16_bf16 v[176:191], v[200:203], v[72:75], v[176:191]
    ds_read_b64_tr_b16 v[196:197], v247 offset:20480
    ds_read_b64_tr_b16 v[198:199], v247 offset:21504
    v_pk_max_i16 v165, v165, 0
    v_mul_f32 v172, v172, abs(v172)
    v_mul_f32 v173, v173, abs(v173)
    v_mfma_f32_32x32x16_bf16 v[176:191], v[204:207], v[76:79], v[176:191]
    s_waitcnt lgkmcnt(8)
    ds_read_b64_tr_b16 v[200:201], v247 offset:24576
    ds_read_b64_tr_b16 v[202:203], v247 offset:25600
    v_cvt_pk_bf16_f32 v166, v172, v173
    v_pk_max_i16 v166, v166, 0
    v_mul_f32 v174, v174, abs(v174)
    v_mfma_f32_32x32x16_bf16 v[176:191], a[240:243], v[80:83], v[176:191]
    ds_read_b64_tr_b16 v[204:205], v247 offset:28672
    ds_read_b64_tr_b16 v[206:207], v247 offset:29696
    v_mul_f32 v175, v175, abs(v175)
    v_cvt_pk_bf16_f32 v167, v174, v175
    v_pk_max_i16 v167, v167, 0
    v_mfma_f32_32x32x16_bf16 v[176:191], a[244:247], v[84:87], v[176:191]
    s_waitcnt lgkmcnt(8)
    ds_read_b64_tr_b16 a[240:241], v247 offset:32768
    ds_read_b64_tr_b16 a[242:243], v247 offset:33792
    s_cbranch_vccz L_e5_s
    buffer_store_dwordx4 v[164:167], v255, s[12:15], 0 offen offset:2560 nt
L_e5_d:
    s_waitcnt vmcnt(2)
    s_cmp_lg_u32 s31, 0
    s_cbranch_scc0 L_fa_s
    buffer_store_dword v8, v14, s[12:15], s25 offen offset:3200
L_fa_d:
    v_mfma_f32_32x32x16_bf16 v[176:191], a[248:251], v[88:91], v[176:191]
    ds_read_b64_tr_b16 a[244:245], v247 offset:36864
    ds_read_b64_tr_b16 a[246:247], v247 offset:37888
    v_mfma_f32_32x32x16_bf16 v[176:191], a[252:255], v[92:95], v[176:191]
    s_waitcnt lgkmcnt(8)
    ds_read_b64_tr_b16 a[248:249], v247 offset:40960
    ds_read_b64_tr_b16 a[250:251], v247 offset:41984
    v_mfma_f32_32x32x16_bf16 v[176:191], v[192:195], v[96:99], v[176:191]
    ds_read_b64_tr_b16 a[252:253], v247 offset:45056
    ds_read_b64_tr_b16 a[254:255], v247 offset:46080
    v_mfma_f32_32x32x16_bf16 v[176:191], v[196:199], v[100:103], v[176:191]
    s_waitcnt lgkmcnt(8)
    v_mfma_f32_32x32x16_bf16 v[176:191], v[200:203], v[104:107], v[176:191]
    v_mfma_f32_32x32x16_bf16 v[176:191], v[204:207], v[108:111], v[176:191]
    s_waitcnt lgkmcnt(4)
    v_mfma_f32_32x32x16_bf16 v[176:191], a[240:243], v[112:115], v[176:191]
    v_mfma_f32_32x32x16_bf16 v[176:191], a[244:247], v[116:119], v[176:191]
    s_waitcnt lgkmcnt(0)
    v_mfma_f32_32x32x16_bf16 v[176:191], a[248:251], v[120:123], v[176:191]
    v_mfma_f32_32x32x16_bf16 v[176:191], a[252:255], v[124:127], v[176:191]
    buffer_load_dword v13, v7, s[12:15], s69 offen offset:3200 sc1
    s_nop 10
    v_mul_f32 v176, v176, abs(v176)
    v_mul_f32 v177, v177, abs(v177)
    v_cvt_pk_bf16_f32 v176, v176, v177
    v_pk_max_i16 v176, v176, 0
    v_mul_f32 v178, v178, abs(v178)
    v_mul_f32 v179, v179, abs(v179)
    v_cvt_pk_bf16_f32 v177, v178, v179
    v_pk_max_i16 v177, v177, 0
    v_mul_f32 v180, v180, abs(v180)
    v_mul_f32 v181, v181, abs(v181)
    v_cvt_pk_bf16_f32 v178, v180, v181
    v_pk_max_i16 v178, v178, 0
    v_mul_f32 v182, v182, abs(v182)
    v_mul_f32 v183, v183, abs(v183)
    v_cvt_pk_bf16_f32 v179, v182, v183
    v_pk_max_i16 v179, v179, 0
    s_cbranch_vccz L_e6_s
    buffer_store_dwordx4 v[176:179], v255, s[12:15], 0 offen offset:3072 nt
L_e6_d:
    v_mul_f32 v184, v184, abs(v184)
    v_mul_f32 v185, v185, abs(v185)
    v_cvt_pk_bf16_f32 v180, v184, v185
    v_pk_max_i16 v180, v180, 0
    v_mul_f32 v186, v186, abs(v186)
    v_mul_f32 v187, v187, abs(v187)
    v_cvt_pk_bf16_f32 v181, v186, v187
    v_pk_max_i16 v181, v181, 0
    v_mul_f32 v188, v188, abs(v188)
    v_mul_f32 v189, v189, abs(v189)
    v_cvt_pk_bf16_f32 v182, v188, v189
    v_pk_max_i16 v182, v182, 0
    v_mul_f32 v190, v190, abs(v190)
    v_mul_f32 v191, v191, abs(v191)
    v_cvt_pk_bf16_f32 v183, v190, v191
    v_pk_max_i16 v183, v183, 0
    s_cbranch_vccz L_e7_s
    buffer_store_dwordx4 v[180:183], v255, s[12:15], 0 offen offset:3584 nt
L_e7_d:
    s_mov_b32 m0, s71
    s_waitcnt vmcnt(2)
    v_cmp_ne_u32 vcc, 1, v13
    s_cbranch_vccnz L_pa
L_pa_x:
    buffer_load_dwordx4 v[16:19], v3, s[12:15], m0 offen offset:0 sc1
    buffer_load_dwordx4 v[20:23], v3, s[12:15], m0 offen offset:1024 sc1
    s_add_u32 m0, s71, 4096
    s_nop 0
    buffer_load_dwordx4 v[24:27], v3, s[12:15], m0 offen offset:0 sc1
    buffer_load_dwordx4 v[28:31], v3, s[12:15], m0 offen offset:1024 sc1
    s_add_u32 m0, s71, 8192
    s_nop 0
    buffer_load_dwordx4 v[32:35], v3, s[12:15], m0 offen offset:0 sc1
    s_waitcnt vmcnt(5)
    s_cmp_lg_u32 s31, 0
    s_cbranch_scc0 L_f4_s
    buffer_store_dword v8, v14, s[12:15], s25 offen offset:2560
L_f4_d:
    s_waitcnt vmcnt(5)
    v_mfma_f32_16x16x32_bf16 v[192:195], a[0:3], v[16:19], 0
    buffer_load_dwordx4 v[36:39], v3, s[12:15], m0 offen offset:1024 sc1
    v_mfma_f32_16x16x32_bf16 v[196:199], a[4:7], v[16:19], 0
    s_add_u32 m0, s70, 0
    v_mfma_f32_16x16x32_bf16 v[200:203], a[8:11], v[16:19], 0
    v_mfma_f32_16x16x32_bf16 v[204:207], a[12:15], v[16:19], 0
    s_waitcnt vmcnt(5)
    v_mfma_f32_16x16x32_bf16 v[192:195], a[16:19], v[20:23], v[192:195]
    buffer_load_dwordx4 v[40:43], v3, s[12:15], m0 offen offset:0 sc1
    v_mfma_f32_16x16x32_bf16 v[196:199], a[20:23], v[20:23], v[196:199]
    v_mfma_f32_16x16x32_bf16 v[200:203], a[24:27], v[20:23], v[200:203]
    v_mfma_f32_16x16x32_bf16 v[204:207], a[28:31], v[20:23], v[204:207]
    s_waitcnt vmcnt(5)
    v_mfma_f32_16x16x32_bf16 v[192:195], a[64:67], v[24:27], v[192:195]
    buffer_load_dwordx4 v[44:47], v3, s[12:15], m0 offen offset:1024 sc1
    v_mfma_f32_16x16x32_bf16 v[196:199], a[68:71], v[24:27], v[196:199]
    s_add_u32 m0, s70, 4096
    v_mfma_f32_16x16x32_bf16 v[200:203], a[72:75], v[24:27], v[200:203]
    v_mfma_f32_16x16x32_bf16 v[204:207], a[76:79], v[24:27], v[204:207]
    s_waitcnt vmcnt(5)
    v_mfma_f32_16x16x32_bf16 v[192:195], a[80:83], v[28:31], v[192:195]
    buffer_load_dwordx4 v[48:51], v3, s[12:15], m0 offen offset:0 sc1
    v_mfma_f32_16x16x32_bf16 v[196:199], a[84:87], v[28:31], v[196:199]
    v_mfma_f32_16x16x32_bf16 v[200:203], a[88:91], v[28:31], v[200:203]
    v_mfma_f32_16x16x32_bf16 v[204:207], a[92:95], v[28:31], v[204:207]
    s_waitcnt vmcnt(5)
    v_mfma_f32_16x16x32_bf16 v[192:195], a[128:131], v[32:35], v[192:195]
    buffer_load_dwordx4 v[52:55], v3, s[12:15], m0 offen offset:1024 sc1
    v_mfma_f32_16x16x32_bf16 v[196:199], a[132:135], v[32:35], v[196:199]
    s_add_u32 m0, s70, 8192
    v_mfma_f32_16x16x32_bf16 v[200:203], a[136:139], v[32:35], v[200:203]
    v_mfma_f32_16x16x32_bf16 v[204:207], a[140:143], v[32:35], v[204:207]
    s_waitcnt vmcnt(4)
    v_mfma_f32_16x16x32_bf16 v[192:195], a[144:147], v[36:39], v[192:195]
    buffer_load_dwordx4 v[56:59], v3, s[12:15], m0 offen offset:0 sc1
    v_mfma_f32_16x16x32_bf16 v[196:199], a[148:151], v[36:39], v[196:199]
    v_mfma_f32_16x16x32_bf16 v[200:203], a[152:155], v[36:39], v[200:203]
    v_mfma_f32_16x16x32_bf16 v[204:207], a[156:159], v[36:39], v[204:207]
    s_waitcnt vmcnt(4)
    v_mfma_f32_16x16x32_bf16 v[176:179], a[0:3], v[40:43], 0
    buffer_load_dwordx4 v[60:63], v3, s[12:15], m0 offen offset:1024 sc1
    v_mfma_f32_16x16x32_bf16 v[180:183], a[4:7], v[40:43], 0
    s_add_u32 m0, s63, 0
    v_mfma_f32_16x16x32_bf16 v[184:187], a[8:11], v[40:43], 0
    v_mfma_f32_16x16x32_bf16 v[188:191], a[12:15], v[40:43], 0
    s_waitcnt vmcnt(4)
    v_mfma_f32_16x16x32_bf16 v[176:179], a[16:19], v[44:47], v[176:179]
    buffer_load_dwordx4 v[64:67], v3, s[12:15], m0 offen offset:0 sc1
    v_mfma_f32_16x16x32_bf16 v[180:183], a[20:23], v[44:47], v[180:183]
    v_mfma_f32_16x16x32_bf16 v[184:187], a[24:27], v[44:47], v[184:187]
    buffer_load_dword v13, v7, s[12:15], s69 offen offset:2560 sc1
    v_mfma_f32_16x16x32_bf16 v[188:191], a[28:31], v[44:47], v[188:191]
    s_waitcnt vmcnt(5)
    v_mfma_f32_16x16x32_bf16 v[176:179], a[64:67], v[48:51], v[176:179]
    buffer_load_dwordx4 v[68:71], v3, s[12:15], m0 offen offset:1024 sc1
    v_mfma_f32_16x16x32_bf16 v[180:183], a[68:71], v[48:51], v[180:183]
    s_add_u32 m0, s63, 4096
    v_mfma_f32_16x16x32_bf16 v[184:187], a[72:75], v[48:51], v[184:187]
    v_mfma_f32_16x16x32_bf16 v[188:191], a[76:79], v[48:51], v[188:191]
    s_waitcnt vmcnt(5)
    v_mfma_f32_16x16x32_bf16 v[176:179], a[80:83], v[52:55], v[176:179]
    buffer_load_dwordx4 v[72:75], v3, s[12:15], m0 offen offset:0 sc1
    v_mfma_f32_16x16x32_bf16 v[180:183], a[84:87], v[52:55], v[180:183]
    v_mfma_f32_16x16x32_bf16 v[184:187], a[88:91], v[52:55], v[184:187]
    v_mfma_f32_16x16x32_bf16 v[188:191], a[92:95], v[52:55], v[188:191]
    s_waitcnt vmcnt(5)
    v_mfma_f32_16x16x32_bf16 v[176:179], a[128:131], v[56:59], v[176:179]
    buffer_load_dwordx4 v[76:79], v3, s[12:15], m0 offen offset:1024 sc1
    v_mfma_f32_16x16x32_bf16 v[180:183], a[132:135], v[56:59], v[180:183]
    s_add_u32 m0, s63, 8192
    v_mfma_f32_16x16x32_bf16 v[184:187], a[136:139], v[56:59], v[184:187]
    v_mfma_f32_16x16x32_bf16 v[188:191], a[140:143], v[56:59], v[188:191]
    s_waitcnt vmcnt(5)
    v_mfma_f32_16x16x32_bf16 v[176:179], a[144:147], v[60:63], v[176:179]
    buffer_load_dwordx4 v[80:83], v3, s[12:15], m0 offen offset:0 sc1
    v_mfma_f32_16x16x32_bf16 v[180:183], a[148:151], v[60:63], v[180:183]
    v_mfma_f32_16x16x32_bf16 v[184:187], a[152:155], v[60:63], v[184:187]
    v_mfma_f32_16x16x32_bf16 v[188:191], a[156:159], v[60:63], v[188:191]
    s_waitcnt vmcnt(5)
    v_mfma_f32_16x16x32_bf16 v[160:163], a[0:3], v[64:67], 0
    buffer_load_dwordx4 v[84:87], v3, s[12:15], m0 offen offset:1024 sc1
    v_mfma_f32_16x16x32_bf16 v[164:167], a[4:7], v[64:67], 0
    s_add_u32 m0, s71, 0
    v_mfma_f32_16x16x32_bf16 v[168:171], a[8:11], v[64:67], 0
    v_mfma_f32_16x16x32_bf16 v[172:175], a[12:15], v[64:67], 0
    s_waitcnt vmcnt(4)
    v_mfma_f32_16x16x32_bf16 v[160:163], a[16:19], v[68:71], v[160:163]
    v_cmp_ne_u32 vcc, 1, v13
    s_cbranch_vccnz L_pb
L_pb_x:
    buffer_load_dwordx4 v[88:91], v4, s[12:15], m0 offen offset:0 sc1
    v_mfma_f32_16x16x32_bf16 v[164:167], a[20:23], v[68:71], v[164:167]
    v_mfma_f32_16x16x32_bf16 v[168:171], a[24:27], v[68:71], v[168:171]
    v_mfma_f32_16x16x32_bf16 v[172:175], a[28:31], v[68:71], v[172:175]
    s_waitcnt vmcnt(4)
    v_mfma_f32_16x16x32_bf16 v[160:163], a[64:67], v[72:75], v[160:163]
    buffer_load_dwordx4 v[92:95], v4, s[12:15], m0 offen offset:1024 sc1
    v_mfma_f32_16x16x32_bf16 v[164:167], a[68:71], v[72:75], v[164:167]
    s_add_u32 m0, s71, 4096
    v_mfma_f32_16x16x32_bf16 v[168:171], a[72:75], v[72:75], v[168:171]
    v_mfma_f32_16x16x32_bf16 v[172:175], a[76:79], v[72:75], v[172:175]
    s_waitcnt vmcnt(4)
    v_mfma_f32_16x16x32_bf16 v[160:163], a[80:83], v[76:79], v[160:163]
    buffer_load_dwordx4 v[96:99], v4, s[12:15], m0 offen offset:0 sc1
    v_mfma_f32_16x16x32_bf16 v[164:167], a[84:87], v[76:79], v[164:167]
    v_mfma_f32_16x16x32_bf16 v[168:171], a[88:91], v[76:79], v[168:171]
    v_mfma_f32_16x16x32_bf16 v[172:175], a[92:95], v[76:79], v[172:175]
    s_waitcnt vmcnt(4)
    v_mfma_f32_16x16x32_bf16 v[160:163], a[128:131], v[80:83], v[160:163]
    buffer_load_dwordx4 v[100:103], v4, s[12:15], m0 offen offset:1024 sc1
    v_mfma_f32_16x16x32_bf16 v[164:167], a[132:135], v[80:83], v[164:167]
    s_add_u32 m0, s71, 8192
    v_mfma_f32_16x16x32_bf16 v[168:171], a[136:139], v[80:83], v[168:171]
    v_mfma_f32_16x16x32_bf16 v[172:175], a[140:143], v[80:83], v[172:175]
    s_waitcnt vmcnt(4)
    v_mfma_f32_16x16x32_bf16 v[160:163], a[144:147], v[84:87], v[160:163]
    buffer_load_dwordx4 v[104:107], v4, s[12:15], m0 offen offset:0 sc1
    v_mfma_f32_16x16x32_bf16 v[164:167], a[148:151], v[84:87], v[164:167]
    v_mfma_f32_16x16x32_bf16 v[168:171], a[152:155], v[84:87], v[168:171]
    v_mfma_f32_16x16x32_bf16 v[172:175], a[156:159], v[84:87], v[172:175]
    s_waitcnt vmcnt(4)
    v_mfma_f32_16x16x32_bf16 v[192:195], a[32:35], v[88:91], v[192:195]
    buffer_load_dwordx4 v[108:111], v4, s[12:15], m0 offen offset:1024 sc1
    v_mfma_f32_16x16x32_bf16 v[196:199], a[36:39], v[88:91], v[196:199]
    s_add_u32 m0, s71, 12288
    v_mfma_f32_16x16x32_bf16 v[200:203], a[40:43], v[88:91], v[200:203]
    v_mfma_f32_16x16x32_bf16 v[204:207], a[44:47], v[88:91], v[204:207]
    s_waitcnt vmcnt(4)
    v_mfma_f32_16x16x32_bf16 v[192:195], a[48:51], v[92:95], v[192:195]
    buffer_load_dwordx4 v[112:115], v2, s[12:15], m0 offen offset:0 sc1
    v_mfma_f32_16x16x32_bf16 v[196:199], a[52:55], v[92:95], v[196:199]
    v_mfma_f32_16x16x32_bf16 v[200:203], a[56:59], v[92:95], v[200:203]
    v_mfma_f32_16x16x32_bf16 v[204:207], a[60:63], v[92:95], v[204:207]
    s_waitcnt vmcnt(4)
    v_mfma_f32_16x16x32_bf16 v[192:195], a[96:99], v[96:99], v[192:195]
    buffer_load_dwordx4 v[116:119], v2, s[12:15], m0 offen offset:1024 sc1
    v_mfma_f32_16x16x32_bf16 v[196:199], a[100:103], v[96:99], v[196:199]
    s_add_u32 m0, s70, 0
    v_mfma_f32_16x16x32_bf16 v[200:203], a[104:107], v[96:99], v[200:203]
    v_mfma_f32_16x16x32_bf16 v[204:207], a[108:111], v[96:99], v[204:207]
    s_waitcnt vmcnt(4)
    v_mfma_f32_16x16x32_bf16 v[192:195], a[112:115], v[100:103], v[192:195]
    buffer_load_dwordx4 v[120:123], v4, s[12:15], m0 offen offset:0 sc1
    v_mfma_f32_16x16x32_bf16 v[196:199], a[116:119], v[100:103], v[196:199]
    v_mfma_f32_16x16x32_bf16 v[200:203], a[120:123], v[100:103], v[200:203]
    v_mfma_f32_16x16x32_bf16 v[204:207], a[124:127], v[100:103], v[204:207]
    s_waitcnt vmcnt(4)
    v_mfma_f32_16x16x32_bf16 v[192:195], a[160:163], v[104:107], v[192:195]
    buffer_load_dwordx4 v[124:127], v4, s[12:15], m0 offen offset:1024 sc1
    v_mfma_f32_16x16x32_bf16 v[196:199], a[164:167], v[104:107], v[196:199]
    s_add_u32 m0, s70, 4096
    v_mfma_f32_16x16x32_bf16 v[200:203], a[168:171], v[104:107], v[200:203]
    v_mfma_f32_16x16x32_bf16 v[204:207], a[172:175], v[104:107], v[204:207]
    s_waitcnt vmcnt(4)
    v_mfma_f32_16x16x32_bf16 v[192:195], a[176:179], v[108:111], v[192:195]
    buffer_load_dwordx4 v[128:131], v4, s[12:15], m0 offen offset:0 sc1
    v_mfma_f32_16x16x32_bf16 v[196:199], a[180:183], v[108:111], v[196:199]
    v_mfma_f32_16x16x32_bf16 v[200:203], a[184:187], v[108:111], v[200:203]
    v_mfma_f32_16x16x32_bf16 v[204:207], a[188:191], v[108:111], v[204:207]
    s_waitcnt vmcnt(4)
    v_mfma_f32_16x16x32_bf16 v[192:195], a[192:195], v[112:115], v[192:195]
    buffer_load_dwordx4 v[132:135], v4, s[12:15], m0 offen offset:1024 sc1
    v_mfma_f32_16x16x32_bf16 v[196:199], a[196:199], v[112:115], v[196:199]
    s_add_u32 m0, s70, 8192
    v_mfma_f32_16x16x32_bf16 v[200:203], a[200:203], v[112:115], v[200:203]
    v_mfma_f32_16x16x32_bf16 v[204:207], a[204:207], v[112:115], v[204:207]
    s_waitcnt vmcnt(4)
    v_mfma_f32_16x16x32_bf16 v[192:195], a[208:211], v[116:119], v[192:195]
    buffer_load_dwordx4 v[136:139], v4, s[12:15], m0 offen offset:0 sc1
    v_mfma_f32_16x16x32_bf16 v[196:199], a[212:215], v[116:119], v[196:199]
    v_mfma_f32_16x16x32_bf16 v[200:203], a[216:219], v[116:119], v[200:203]
    v_mfma_f32_16x16x32_bf16 v[204:207], a[220:223], v[116:119], v[204:207]
    s_waitcnt vmcnt(4)
    v_mfma_f32_16x16x32_bf16 v[176:179], a[32:35], v[120:123], v[176:179]
    buffer_load_dwordx4 v[140:143], v4, s[12:15], m0 offen offset:1024 sc1
    v_mfma_f32_16x16x32_bf16 v[180:183], a[36:39], v[120:123], v[180:183]
    s_add_u32 m0, s70, 12288
    v_mfma_f32_16x16x32_bf16 v[184:187], a[40:43], v[120:123], v[184:187]
    v_mfma_f32_16x16x32_bf16 v[188:191], a[44:47], v[120:123], v[188:191]
    s_waitcnt vmcnt(4)
    v_mfma_f32_16x16x32_bf16 v[176:179], a[48:51], v[124:127], v[176:179]
    buffer_load_dwordx4 v[16:19], v2, s[12:15], m0 offen offset:0 sc1
    v_mfma_f32_16x16x32_bf16 v[180:183], a[52:55], v[124:127], v[180:183]
    v_mfma_f32_16x16x32_bf16 v[184:187], a[56:59], v[124:127], v[184:187]
    ds_write_b128 v9, v[192:195] offset:0
    v_mfma_f32_16x16x32_bf16 v[188:191], a[60:63], v[124:127], v[188:191]
    s_waitcnt vmcnt(4)
    v_mfma_f32_16x16x32_bf16 v[176:179], a[96:99], v[128:131], v[176:179]
    buffer_load_dwordx4 v[20:23], v2, s[12:15], m0 offen offset:1024 sc1
    v_mfma_f32_16x16x32_bf16 v[180:183], a[100:103], v[128:131], v[180:183]
    s_add_u32 m0, s63, 0
    v_mfma_f32_16x16x32_bf16 v[184:187], a[104:107], v[128:131], v[184:187]
    ds_write_b128 v9, v[196:199] offset:1024
    v_mfma_f32_16x16x32_bf16 v[188:191], a[108:111], v[128:131], v[188:191]
    s_waitcnt vmcnt(4)
    v_mfma_f32_16x16x32_bf16 v[176:179], a[112:115], v[132:135], v[176:179]
    buffer_load_dwordx4 v[24:27], v4, s[12:15], m0 offen offset:0 sc1
    v_mfma_f32_16x16x32_bf16 v[180:183], a[116:119], v[132:135], v[180:183]
    v_mfma_f32_16x16x32_bf16 v[184:187], a[120:123], v[132:135], v[184:187]
    ds_write_b128 v9, v[200:203] offset:2048
    v_mfma_f32_16x16x32_bf16 v[188:191], a[124:127], v[132:135], v[188:191]
    s_waitcnt vmcnt(4)
    v_mfma_f32_16x16x32_bf16 v[176:179], a[160:163], v[136:139], v[176:179]
    buffer_load_dwordx4 v[28:31], v4, s[12:15], m0 offen offset:1024 sc1
    v_mfma_f32_16x16x32_bf16 v[180:183], a[164:167], v[136:139], v[180:183]
    s_add_u32 m0, s63, 4096
    v_mfma_f32_16x16x32_bf16 v[184:187], a[168:171], v[136:139], v[184:187]
    ds_write_b128 v9, v[204:207] offset:3072
    v_mfma_f32_16x16x32_bf16 v[188:191], a[172:175], v[136:139], v[188:191]
    s_waitcnt vmcnt(4)
    v_mfma_f32_16x16x32_bf16 v[176:179], a[176:179], v[140:143], v[176:179]
    buffer_load_dwordx4 v[32:35], v4, s[12:15], m0 offen offset:0 sc1
    v_mfma_f32_16x16x32_bf16 v[180:183], a[180:183], v[140:143], v[180:183]
    v_mfma_f32_16x16x32_bf16 v[184:187], a[184:187], v[140:143], v[184:187]
    v_mfma_f32_16x16x32_bf16 v[188:191], a[188:191], v[140:143], v[188:191]
    s_waitcnt vmcnt(4)
    v_mfma_f32_16x16x32_bf16 v[176:179], a[192:195], v[16:19], v[176:179]
    buffer_load_dwordx4 v[36:39], v4, s[12:15], m0 offen offset:1024 sc1
    v_mfma_f32_16x16x32_bf16 v[180:183], a[196:199], v[16:19], v[180:183]
    s_add_u32 m0, s63, 8192
    v_mfma_f32_16x16x32_bf16 v[184:187], a[200:203], v[16:19], v[184:187]
    v_mfma_f32_16x16x32_bf16 v[188:191], a[204:207], v[16:19], v[188:191]
    s_waitcnt vmcnt(4)
    v_mfma_f32_16x16x32_bf16 v[176:179], a[208:211], v[20:23], v[176:179]
    buffer_load_dwordx4 v[40:43], v4, s[12:15], m0 offen offset:0 sc1
    v_mfma_f32_16x16x32_bf16 v[180:183], a[212:215], v[20:23], v[180:183]
    v_mfma_f32_16x16x32_bf16 v[184:187], a[216:219], v[20:23], v[184:187]
    s_barrier
    ds_write_b32 v251, v248
    v_mfma_f32_16x16x32_bf16 v[188:191], a[220:223], v[20:23], v[188:191]
    s_waitcnt vmcnt(4)
    v_mfma_f32_16x16x32_bf16 v[160:163], a[32:35], v[24:27], v[160:163]
    buffer_load_dwordx4 v[44:47], v4, s[12:15], m0 offen offset:1024 sc1
    v_mfma_f32_16x16x32_bf16 v[164:167], a[36:39], v[24:27], v[164:167]
    s_add_u32 m0, s63, 12288
    v_mfma_f32_16x16x32_bf16 v[168:171], a[40:43], v[24:27], v[168:171]
    v_mfma_f32_16x16x32_bf16 v[172:175], a[44:47], v[24:27], v[172:175]
    s_waitcnt vmcnt(4)
    v_mfma_f32_16x16x32_bf16 v[160:163], a[48:51], v[28:31], v[160:163]
    buffer_load_dwordx4 v[48:51], v2, s[12:15], m0 offen offset:0 sc1
    v_mfma_f32_16x16x32_bf16 v[164:167], a[52:55], v[28:31], v[164:167]
    v_mfma_f32_16x16x32_bf16 v[168:171], a[56:59], v[28:31], v[168:171]
    ds_write_b128 v10, v[176:179] offset:4096
    v_mfma_f32_16x16x32_bf16 v[172:175], a[60:63], v[28:31], v[172:175]
    s_waitcnt vmcnt(4)
    v_mfma_f32_16x16x32_bf16 v[160:163], a[96:99], v[32:35], v[160:163]
    buffer_load_dwordx4 v[52:55], v2, s[12:15], m0 offen offset:1024 sc1
    v_mfma_f32_16x16x32_bf16 v[164:167], a[100:103], v[32:35], v[164:167]
    s_add_u32 m0, s62, 0
    v_mfma_f32_16x16x32_bf16 v[168:171], a[104:107], v[32:35], v[168:171]
    ds_write_b128 v10, v[180:183] offset:5120
    v_mfma_f32_16x16x32_bf16 v[172:175], a[108:111], v[32:35], v[172:175]
    s_waitcnt vmcnt(4)
    v_mfma_f32_16x16x32_bf16 v[160:163], a[112:115], v[36:39], v[160:163]
    buffer_load_dwordx4 v[56:59], v3, s[12:15], m0 offen offset:0 sc1
    v_mfma_f32_16x16x32_bf16 v[164:167], a[116:119], v[36:39], v[164:167]
    v_mfma_f32_16x16x32_bf16 v[168:171], a[120:123], v[36:39], v[168:171]
    ds_write_b128 v10, v[184:187] offset:6144
    v_mfma_f32_16x16x32_bf16 v[172:175], a[124:127], v[36:39], v[172:175]
    s_waitcnt vmcnt(4)
    v_mfma_f32_16x16x32_bf16 v[160:163], a[160:163], v[40:43], v[160:163]
    buffer_load_dwordx4 v[60:63], v3, s[12:15], m0 offen offset:1024 sc1
    v_mfma_f32_16x16x32_bf16 v[164:167], a[164:167], v[40:43], v[164:167]
    v_mfma_f32_16x16x32_bf16 v[168:171], a[168:171], v[40:43], v[168:171]
    ds_write_b128 v10, v[188:191] offset:7168
    v_mfma_f32_16x16x32_bf16 v[172:175], a[172:175], v[40:43], v[172:175]
    s_waitcnt vmcnt(4)
    v_mfma_f32_16x16x32_bf16 v[160:163], a[176:179], v[44:47], v[160:163]
    buffer_load_dwordx4 v[64:67], v4, s[12:15], m0 offen offset:0 sc1
    v_mfma_f32_16x16x32_bf16 v[164:167], a[180:183], v[44:47], v[164:167]
    v_mfma_f32_16x16x32_bf16 v[168:171], a[184:187], v[44:47], v[168:171]
    v_mfma_f32_16x16x32_bf16 v[172:175], a[188:191], v[44:47], v[172:175]
    s_waitcnt vmcnt(4)
    v_mfma_f32_16x16x32_bf16 v[160:163], a[192:195], v[48:51], v[160:163]
    buffer_load_dwordx4 v[68:71], v4, s[12:15], m0 offen offset:1024 sc1
    v_mfma_f32_16x16x32_bf16 v[164:167], a[196:199], v[48:51], v[164:167]
    s_add_u32 m0, s62, 4096
    v_mfma_f32_16x16x32_bf16 v[168:171], a[200:203], v[48:51], v[168:171]
    v_mfma_f32_16x16x32_bf16 v[172:175], a[204:207], v[48:51], v[172:175]
    s_waitcnt vmcnt(4)
    v_mfma_f32_16x16x32_bf16 v[160:163], a[208:211], v[52:55], v[160:163]
    buffer_load_dwordx4 v[72:75], v3, s[12:15], m0 offen offset:0 sc1
    v_mfma_f32_16x16x32_bf16 v[164:167], a[212:215], v[52:55], v[164:167]
    v_mfma_f32_16x16x32_bf16 v[168:171], a[216:219], v[52:55], v[168:171]
    v_mfma_f32_16x16x32_bf16 v[172:175], a[220:223], v[52:55], v[172:175]
    s_waitcnt vmcnt(4)
    v_mfma_f32_16x16x32_bf16 v[144:147], a[0:3], v[56:59], 0
    buffer_load_dwordx4 v[76:79], v3, s[12:15], m0 offen offset:1024 sc1
    v_mfma_f32_16x16x32_bf16 v[148:151], a[4:7], v[56:59], 0
    v_mfma_f32_16x16x32_bf16 v[152:155], a[8:11], v[56:59], 0
    ds_write_b128 v11, v[160:163] offset:8192
    v_mfma_f32_16x16x32_bf16 v[156:159], a[12:15], v[56:59], 0
    s_waitcnt vmcnt(4)
    v_mfma_f32_16x16x32_bf16 v[144:147], a[16:19], v[60:63], v[144:147]
    buffer_load_dwordx4 v[80:83], v4, s[12:15], m0 offen offset:0 sc1
    v_mfma_f32_16x16x32_bf16 v[148:151], a[20:23], v[60:63], v[148:151]
    v_mfma_f32_16x16x32_bf16 v[152:155], a[24:27], v[60:63], v[152:155]
    ds_write_b128 v11, v[164:167] offset:9216
    v_mfma_f32_16x16x32_bf16 v[156:159], a[28:31], v[60:63], v[156:159]
    s_waitcnt vmcnt(4)
    v_mfma_f32_16x16x32_bf16 v[144:147], a[32:35], v[64:67], v[144:147]
    buffer_load_dwordx4 v[84:87], v4, s[12:15], m0 offen offset:1024 sc1
    v_mfma_f32_16x16x32_bf16 v[148:151], a[36:39], v[64:67], v[148:151]
    s_add_u32 m0, s62, 8192
    v_mfma_f32_16x16x32_bf16 v[152:155], a[40:43], v[64:67], v[152:155]
    ds_write_b128 v11, v[168:171] offset:10240
    v_mfma_f32_16x16x32_bf16 v[156:159], a[44:47], v[64:67], v[156:159]
    s_waitcnt vmcnt(4)
    v_mfma_f32_16x16x32_bf16 v[144:147], a[48:51], v[68:71], v[144:147]
    buffer_load_dwordx4 v[88:91], v3, s[12:15], m0 offen offset:0 sc1
    v_mfma_f32_16x16x32_bf16 v[148:151], a[52:55], v[68:71], v[148:151]
    v_mfma_f32_16x16x32_bf16 v[152:155], a[56:59], v[68:71], v[152:155]
    ds_write_b128 v11, v[172:175] offset:11264
    v_mfma_f32_16x16x32_bf16 v[156:159], a[60:63], v[68:71], v[156:159]
    s_waitcnt vmcnt(4)
    v_mfma_f32_16x16x32_bf16 v[144:147], a[64:67], v[72:75], v[144:147]
    buffer_load_dwordx4 v[92:95], v3, s[12:15], m0 offen offset:1024 sc1
    v_mfma_f32_16x16x32_bf16 v[148:151], a[68:71], v[72:75], v[148:151]
    v_mfma_f32_16x16x32_bf16 v[152:155], a[72:75], v[72:75], v[152:155]
    v_mfma_f32_16x16x32_bf16 v[156:159], a[76:79], v[72:75], v[156:159]
    s_waitcnt vmcnt(4)
    v_mfma_f32_16x16x32_bf16 v[144:147], a[80:83], v[76:79], v[144:147]
    buffer_load_dwordx4 v[96:99], v4, s[12:15], m0 offen offset:0 sc1
    s_waitcnt lgkmcnt(0)
    s_barrier
    ds_read_b32 v248, v250
    v_mfma_f32_16x16x32_bf16 v[148:151], a[84:87], v[76:79], v[148:151]
    ds_read_b128 v[192:195], v12 offset:0
    ds_read_b128 v[176:179], v12 offset:4096
    v_mfma_f32_16x16x32_bf16 v[152:155], a[88:91], v[76:79], v[152:155]
    ds_read_b128 v[160:163], v12 offset:8192
    ds_read_b128 v[196:199], v12 offset:1024
    v_mfma_f32_16x16x32_bf16 v[156:159], a[92:95], v[76:79], v[156:159]
    s_waitcnt vmcnt(4)
    ds_read_b128 v[180:183], v12 offset:5120
    ds_read_b128 v[164:167], v12 offset:9216
    v_mfma_f32_16x16x32_bf16 v[144:147], a[96:99], v[80:83], v[144:147]
    buffer_load_dwordx4 v[100:103], v4, s[12:15], m0 offen offset:1024 sc1
    ds_read_b128 v[200:203], v12 offset:2048
    ds_read_b128 v[184:187], v12 offset:6144
    v_mfma_f32_16x16x32_bf16 v[148:151], a[100:103], v[80:83], v[148:151]
    s_add_u32 m0, s62, 12288
    ds_read_b128 v[168:171], v12 offset:10240
    ds_read_b128 v[204:207], v12 offset:3072
    v_mfma_f32_16x16x32_bf16 v[152:155], a[104:107], v[80:83], v[152:155]
    ds_read_b128 v[188:191], v12 offset:7168
    ds_read_b128 v[172:175], v12 offset:11264
    v_mfma_f32_16x16x32_bf16 v[156:159], a[108:111], v[80:83], v[156:159]
    s_waitcnt vmcnt(4)
    s_waitcnt lgkmcnt(9)
    v_add_f32 v160, v160, v176
    v_mfma_f32_16x16x32_bf16 v[144:147], a[112:115], v[84:87], v[144:147]
    buffer_load_dwordx4 v[104:107], v2, s[12:15], m0 offen offset:0 sc1
    v_fmac_f32 v224, v248, v192
    v_fmac_f32 v224, v248, v160
    v_mfma_f32_16x16x32_bf16 v[148:151], a[116:119], v[84:87], v[148:151]
    v_add_f32 v161, v161, v177
    v_fmac_f32 v225, v248, v193
    v_mfma_f32_16x16x32_bf16 v[152:155], a[120:123], v[84:87], v[152:155]
    v_fmac_f32 v225, v248, v161
    v_add_f32 v162, v162, v178
    v_mfma_f32_16x16x32_bf16 v[156:159], a[124:127], v[84:87], v[156:159]
    s_waitcnt vmcnt(4)
    v_fmac_f32 v226, v248, v194
    v_fmac_f32 v226, v248, v162
    v_mfma_f32_16x16x32_bf16 v[144:147], a[128:131], v[88:91], v[144:147]
    buffer_load_dwordx4 v[108:111], v2, s[12:15], m0 offen offset:1024 sc1
    v_add_f32 v163, v163, v179
    v_fmac_f32 v227, v248, v195
    v_mfma_f32_16x16x32_bf16 v[148:151], a[132:135], v[88:91], v[148:151]
    v_fmac_f32 v227, v248, v163
    s_waitcnt lgkmcnt(6)
    v_mfma_f32_16x16x32_bf16 v[152:155], a[136:139], v[88:91], v[152:155]
    v_add_f32 v164, v164, v180
    v_fmac_f32 v228, v248, v196
    v_mfma_f32_16x16x32_bf16 v[156:159], a[140:143], v[88:91], v[156:159]
    s_waitcnt vmcnt(4)
    v_fmac_f32 v228, v248, v164
    v_add_f32 v165, v165, v181
    v_mfma_f32_16x16x32_bf16 v[144:147], a[144:147], v[92:95], v[144:147]
    v_fmac_f32 v229, v248, v197
    v_fmac_f32 v229, v248, v165
    v_mfma_f32_16x16x32_bf16 v[148:151], a[148:151], v[92:95], v[148:151]
    v_add_f32 v166, v166, v182
    v_fmac_f32 v230, v248, v198
    v_mfma_f32_16x16x32_bf16 v[152:155], a[152:155], v[92:95], v[152:155]
    v_fmac_f32 v230, v248, v166
    v_add_f32 v167, v167, v183
    v_mfma_f32_16x16x32_bf16 v[156:159], a[156:159], v[92:95], v[156:159]
    s_waitcnt vmcnt(3)
    v_fmac_f32 v231, v248, v199
    v_fmac_f32 v231, v248, v167
    v_mfma_f32_16x16x32_bf16 v[144:147], a[160:163], v[96:99], v[144:147]
    s_waitcnt lgkmcnt(3)
    v_add_f32 v168, v168, v184
    v_mfma_f32_16x16x32_bf16 v[148:151], a[164:167], v[96:99], v[148:151]
    v_fmac_f32 v232, v248, v200
    v_fmac_f32 v232, v248, v168
    v_mfma_f32_16x16x32_bf16 v[152:155], a[168:171], v[96:99], v[152:155]
    v_add_f32 v169, v169, v185
    v_fmac_f32 v233, v248, v201
    v_mfma_f32_16x16x32_bf16 v[156:159], a[172:175], v[96:99], v[156:159]
    s_waitcnt vmcnt(2)
    v_fmac_f32 v233, v248, v169
    v_add_f32 v170, v170, v186
    v_mfma_f32_16x16x32_bf16 v[144:147], a[176:179], v[100:103], v[144:147]
    v_fmac_f32 v234, v248, v202
    v_fmac_f32 v234, v248, v170
    v_mfma_f32_16x16x32_bf16 v[148:151], a[180:183], v[100:103], v[148:151]
    v_add_f32 v171, v171, v187
    v_fmac_f32 v235, v248, v203
    v_mfma_f32_16x16x32_bf16 v[152:155], a[184:187], v[100:103], v[152:155]
    v_fmac_f32 v235, v248, v171
    s_waitcnt lgkmcnt(0)
    v_mfma_f32_16x16x32_bf16 v[156:159], a[188:191], v[100:103], v[156:159]
    s_waitcnt vmcnt(1)
    v_add_f32 v172, v172, v188
    v_fmac_f32 v236, v248, v204
    v_mfma_f32_16x16x32_bf16 v[144:147], a[192:195], v[104:107], v[144:147]
    v_fmac_f32 v236, v248, v172
    v_add_f32 v173, v173, v189
    v_mfma_f32_16x16x32_bf16 v[148:151], a[196:199], v[104:107], v[148:151]
    v_fmac_f32 v237, v248, v205
    v_fmac_f32 v237, v248, v173
    v_mfma_f32_16x16x32_bf16 v[152:155], a[200:203], v[104:107], v[152:155]
    v_add_f32 v174, v174, v190
    v_fmac_f32 v238, v248, v206
    v_mfma_f32_16x16x32_bf16 v[156:159], a[204:207], v[104:107], v[156:159]
    s_waitcnt vmcnt(0)
    v_fmac_f32 v238, v248, v174
    v_add_f32 v175, v175, v191
    v_mfma_f32_16x16x32_bf16 v[144:147], a[208:211], v[108:111], v[144:147]
    v_fmac_f32 v239, v248, v207
    v_fmac_f32 v239, v248, v175
    v_mfma_f32_16x16x32_bf16 v[148:151], a[212:215], v[108:111], v[148:151]
    v_mfma_f32_16x16x32_bf16 v[152:155], a[216:219], v[108:111], v[152:155]
    v_mfma_f32_16x16x32_bf16 v[156:159], a[220:223], v[108:111], v[156:159]
    s_nop 2
    v_pk_fma_f32 v[224:225], v[144:145], v[248:249], v[224:225] op_sel_hi:[1,0,1]
    v_cvt_pk_bf16_f32 v208, v224, v225
    v_pk_fma_f32 v[226:227], v[146:147], v[248:249], v[226:227] op_sel_hi:[1,0,1]
    v_cvt_pk_bf16_f32 v209, v226, v227
    v_pk_fma_f32 v[228:229], v[148:149], v[248:249], v[228:229] op_sel_hi:[1,0,1]
    v_cvt_pk_bf16_f32 v210, v228, v229
    v_pk_fma_f32 v[230:231], v[150:151], v[248:249], v[230:231] op_sel_hi:[1,0,1]
    v_cvt_pk_bf16_f32 v211, v230, v231
    buffer_store_dwordx4 v[208:211], v0, s[40:43], s27 offen offset:0
    v_pk_fma_f32 v[232:233], v[152:153], v[248:249], v[232:233] op_sel_hi:[1,0,1]
    v_cvt_pk_bf16_f32 v212, v232, v233
    v_pk_fma_f32 v[234:235], v[154:155], v[248:249], v[234:235] op_sel_hi:[1,0,1]
L_w2_2:
    s_cbranch_execz L_w2_r
    v_cvt_pk_bf16_f32 v213, v234, v235
    v_pk_fma_f32 v[236:237], v[156:157], v[248:249], v[236:237] op_sel_hi:[1,0,1]
    v_cvt_pk_bf16_f32 v214, v236, v237
    v_pk_fma_f32 v[238:239], v[158:159], v[248:249], v[238:239] op_sel_hi:[1,0,1]
    v_cvt_pk_bf16_f32 v215, v238, v239
    buffer_store_dwordx4 v[212:215], v0, s[40:43], s27 offen offset:64
    s_endpgm
L_rlp:
    s_mov_b32 s26, 262144
L_rll:
    global_load_dword v245, v219, s[100:101] sc1
    s_sub_u32 s26, s26, 1
    s_cbranch_scc1 L_rld
    s_waitcnt vmcnt(0)
    v_cmp_gt_u32 vcc, 32, v245
    s_cbranch_vccnz L_rll
    s_branch L_rld
L_rdp:
    s_mov_b32 s26, 262144
L_rdl:
    global_load_dword v245, v219, s[100:101] sc1
    s_sub_u32 s26, s26, 1
    s_cbranch_scc1 L_rdd
    s_waitcnt vmcnt(0)
    v_cmp_gt_u32 vcc, 32, v245
    s_cbranch_vccnz L_rdl
    s_branch L_rdd
L_wf:
    s_mov_b32 s26, 262144
L_wfp:
    buffer_load_dword v243, v241, s[12:15], 0 offen sc1
    s_sub_u32 s26, s26, 1
    s_cbranch_scc1 L_wfd
    s_waitcnt vmcnt(0)
    v_cmp_gt_u32 vcc, 2, v243
    s_nop 1
    s_lshr_b32 s78, vcc_hi, 16
    s_cbranch_scc1 L_wfp
    s_branch L_wfd
L_h0_s:
    s_nop 1
    buffer_store_dwordx4 v[48:51], v7, s[12:15], s64 offen offset:0 sc1
    s_nop 1
    s_branch L_h0_d
L_h1_s:
    s_nop 1
    buffer_store_dwordx4 v[52:55], v7, s[12:15], s64 offen offset:2048 sc1
    s_nop 1
    s_branch L_h1_d
L_s_s:
    s_nop 1
    buffer_store_dword v56, v15, s[12:15], s65 offen sc1
    s_nop 1
    s_branch L_s_d
L_f3_s:
    s_nop 1
    buffer_store_dword v8, v4, s[12:15], s25 offen offset:2048 sc1
    s_nop 1
    s_branch L_f3_d
L_e0_s:
    s_nop 1
    buffer_store_dwordx4 v[128:131], v255, s[12:15], 0 offen offset:0 sc1
    s_nop 1
    s_branch L_e0_d
L_e1_s:
    s_nop 1
    buffer_store_dwordx4 v[132:135], v255, s[12:15], 0 offen offset:512 sc1
    s_nop 1
    s_branch L_e1_d
L_e2_s:
    s_nop 1
    buffer_store_dwordx4 v[144:147], v255, s[12:15], 0 offen offset:1024 sc1
    s_nop 1
    s_branch L_e2_d
L_e3_s:
    s_nop 1
    buffer_store_dwordx4 v[148:151], v255, s[12:15], 0 offen offset:1536 sc1
    s_nop 1
    s_branch L_e3_d
L_e4_s:
    s_nop 1
    buffer_store_dwordx4 v[160:163], v255, s[12:15], 0 offen offset:2048 sc1
    s_nop 1
    s_branch L_e4_d
L_e5_s:
    s_nop 1
    buffer_store_dwordx4 v[164:167], v255, s[12:15], 0 offen offset:2560 sc1
    s_nop 1
    s_branch L_e5_d
L_fa_s:
    s_nop 1
    buffer_store_dword v8, v14, s[12:15], s25 offen offset:3200 sc1
    s_nop 1
    s_branch L_fa_d
L_e6_s:
    s_nop 1
    buffer_store_dwordx4 v[176:179], v255, s[12:15], 0 offen offset:3072 sc1
    s_nop 1
    s_branch L_e6_d
L_e7_s:
    s_nop 1
    buffer_store_dwordx4 v[180:183], v255, s[12:15], 0 offen offset:3584 sc1
    s_nop 1
    s_branch L_e7_d
L_f4_s:
    s_nop 1
    buffer_store_dword v8, v14, s[12:15], s25 offen offset:2560 sc1
    s_nop 1
    s_branch L_f4_d
L_fallback:
    s_mov_b32 s30, 1
    s_waitcnt vmcnt(0) lgkmcnt(0)
    s_barrier
    s_add_u32 m0, s46, 0
    s_nop 0
    buffer_load_dwordx4 a[0:3], v3, s[12:15], m0 offen offset:0 sc1
    buffer_load_dwordx4 a[4:7], v3, s[12:15], m0 offen offset:1024 sc1
    buffer_load_dwordx4 a[8:11], v4, s[12:15], m0 offen sc1
    buffer_load_dwordx4 a[12:15], v248, s[12:15], m0 offen sc1
    s_add_u32 m0, s46, 57600
    s_nop 0
    buffer_load_dwordx4 a[16:19], v3, s[12:15], m0 offen offset:0 sc1
    buffer_load_dwordx4 a[20:23], v3, s[12:15], m0 offen offset:1024 sc1
    buffer_load_dwordx4 a[24:27], v4, s[12:15], m0 offen sc1
    buffer_load_dwordx4 a[28:31], v248, s[12:15], m0 offen sc1
    s_add_u32 m0, s46, 115200
    s_nop 0
    buffer_load_dwordx4 a[32:35], v3, s[12:15], m0 offen offset:0 sc1
    buffer_load_dwordx4 a[36:39], v3, s[12:15], m0 offen offset:1024 sc1
    buffer_load_dwordx4 a[40:43], v4, s[12:15], m0 offen sc1
    buffer_load_dwordx4 a[44:47], v248, s[12:15], m0 offen sc1
    s_add_u32 m0, s46, 172800
    s_nop 0
    buffer_load_dwordx4 a[48:51], v3, s[12:15], m0 offen offset:0 sc1
    buffer_load_dwordx4 a[52:55], v3, s[12:15], m0 offen offset:1024 sc1
    buffer_load_dwordx4 a[56:59], v4, s[12:15], m0 offen sc1
    buffer_load_dwordx4 a[60:63], v248, s[12:15], m0 offen sc1
    s_add_u32 m0, s46, 230400
    s_nop 0
    buffer_load_dwordx4 a[64:67], v3, s[12:15], m0 offen offset:0 sc1
    buffer_load_dwordx4 a[68:71], v3, s[12:15], m0 offen offset:1024 sc1
    buffer_load_dwordx4 a[72:75], v4, s[12:15], m0 offen sc1
    buffer_load_dwordx4 a[76:79], v248, s[12:15], m0 offen sc1
    s_add_u32 m0, s46, 288000
    s_nop 0
    buffer_load_dwordx4 a[80:83], v3, s[12:15], m0 offen offset:0 sc1
    buffer_load_dwordx4 a[84:87], v3, s[12:15], m0 offen offset:1024 sc1
    buffer_load_dwordx4 a[88:91], v4, s[12:15], m0 offen sc1
    buffer_load_dwordx4 a[92:95], v248, s[12:15], m0 offen sc1
    s_add_u32 m0, s46, 345600
    s_nop 0
    buffer_load_dwordx4 a[96:99], v3, s[12:15], m0 offen offset:0 sc1
    buffer_load_dwordx4 a[100:103], v3, s[12:15], m0 offen offset:1024 sc1
    buffer_load_dwordx4 a[104:107], v4, s[12:15], m0 offen sc1
    buffer_load_dwordx4 a[108:111], v248, s[12:15], m0 offen sc1
    s_add_u32 m0, s46, 403200
    s_nop 0
    buffer_load_dwordx4 a[112:115], v3, s[12:15], m0 offen offset:0 sc1
    buffer_load_dwordx4 a[116:119], v3, s[12:15], m0 offen offset:1024 sc1
    buffer_load_dwordx4 a[120:123], v4, s[12:15], m0 offen sc1
    buffer_load_dwordx4 a[124:127], v248, s[12:15], m0 offen sc1
    s_waitcnt vmcnt(0)
    s_add_u32 m0, s47, 0
    s_nop 0
    buffer_load_dwordx4 a[128:131], v3, s[12:15], m0 offen offset:0 sc1
    buffer_load_dwordx4 a[132:135], v3, s[12:15], m0 offen offset:1024 sc1
    buffer_load_dwordx4 a[136:139], v4, s[12:15], m0 offen sc1
    buffer_load_dwordx4 a[140:143], v248, s[12:15], m0 offen sc1
    s_add_u32 m0, s47, 57600
    s_nop 0
    buffer_load_dwordx4 a[144:147], v3, s[12:15], m0 offen offset:0 sc1
    buffer_load_dwordx4 a[148:151], v3, s[12:15], m0 offen offset:1024 sc1
    buffer_load_dwordx4 a[152:155], v4, s[12:15], m0 offen sc1
    buffer_load_dwordx4 a[156:159], v248, s[12:15], m0 offen sc1
    s_add_u32 m0, s47, 115200
    s_nop 0
    buffer_load_dwordx4 a[160:163], v3, s[12:15], m0 offen offset:0 sc1
    buffer_load_dwordx4 a[164:167], v3, s[12:15], m0 offen offset:1024 sc1
    buffer_load_dwordx4 a[168:171], v4, s[12:15], m0 offen sc1
    buffer_load_dwordx4 a[172:175], v248, s[12:15], m0 offen sc1
    s_add_u32 m0, s47, 172800
    s_nop 0
    buffer_load_dwordx4 a[176:179], v3, s[12:15], m0 offen offset:0 sc1
    buffer_load_dwordx4 a[180:183], v3, s[12:15], m0 offen offset:1024 sc1
    buffer_load_dwordx4 a[184:187], v4, s[12:15], m0 offen sc1
    buffer_load_dwordx4 a[188:191], v248, s[12:15], m0 offen sc1
    s_add_u32 m0, s47, 230400
    s_nop 0
    buffer_load_dwordx4 a[192:195], v3, s[12:15], m0 offen offset:0 sc1
    buffer_load_dwordx4 a[196:199], v3, s[12:15], m0 offen offset:1024 sc1
    buffer_load_dwordx4 a[200:203], v4, s[12:15], m0 offen sc1
    buffer_load_dwordx4 a[204:207], v248, s[12:15], m0 offen sc1
    s_add_u32 m0, s47, 288000
    s_nop 0
    buffer_load_dwordx4 a[208:211], v3, s[12:15], m0 offen offset:0 sc1
    buffer_load_dwordx4 a[212:215], v3, s[12:15], m0 offen offset:1024 sc1
    buffer_load_dwordx4 a[216:219], v4, s[12:15], m0 offen sc1
    buffer_load_dwordx4 a[220:223], v248, s[12:15], m0 offen sc1
    s_add_u32 m0, s47, 345600
    s_nop 0
    buffer_load_dwordx4 a[224:227], v3, s[12:15], m0 offen offset:0 sc1
    buffer_load_dwordx4 a[228:231], v3, s[12:15], m0 offen offset:1024 sc1
    buffer_load_dwordx4 a[232:235], v4, s[12:15], m0 offen sc1
    buffer_load_dwordx4 a[236:239], v248, s[12:15], m0 offen sc1
    s_add_u32 m0, s47, 403200
    s_nop 0
    buffer_load_dwordx4 a[240:243], v3, s[12:15], m0 offen offset:0 sc1
    buffer_load_dwordx4 a[244:247], v3, s[12:15], m0 offen offset:1024 sc1
    buffer_load_dwordx4 a[248:251], v4, s[12:15], m0 offen sc1
    buffer_load_dwordx4 a[252:255], v248, s[12:15], m0 offen sc1
    s_waitcnt vmcnt(0)
    v_mov_b32 v128, 0xff800000
    v_mfma_f32_32x32x16_bf16 v[112:127], a[0:3], v[16:19], 0
    v_mfma_f32_32x32x16_bf16 v[112:127], a[4:7], v[20:23], v[112:127]
    s_nop 11
    v_max3_f32 v128, v112, v113, v128
    v_max3_f32 v128, v114, v115, v128
    v_max3_f32 v128, v116, v117, v128
    v_max3_f32 v128, v118, v119, v128
    v_max3_f32 v128, v120, v121, v128
    v_max3_f32 v128, v122, v123, v128
    v_max3_f32 v128, v124, v125, v128
    v_max3_f32 v128, v126, v127, v128
    v_mfma_f32_32x32x16_bf16 v[112:127], a[16:19], v[16:19], 0
    v_mfma_f32_32x32x16_bf16 v[112:127], a[20:23], v[20:23], v[112:127]
    s_nop 11
    v_max3_f32 v128, v112, v113, v128
    v_max3_f32 v128, v114, v115, v128
    v_max3_f32 v128, v116, v117, v128
    v_max3_f32 v128, v118, v119, v128
    v_max3_f32 v128, v120, v121, v128
    v_max3_f32 v128, v122, v123, v128
    v_max3_f32 v128, v124, v125, v128
    v_max3_f32 v128, v126, v127, v128
    v_mfma_f32_32x32x16_bf16 v[112:127], a[32:35], v[16:19], 0
    v_mfma_f32_32x32x16_bf16 v[112:127], a[36:39], v[20:23], v[112:127]
    s_nop 11
    v_max3_f32 v128, v112, v113, v128
    v_max3_f32 v128, v114, v115, v128
    v_max3_f32 v128, v116, v117, v128
    v_max3_f32 v128, v118, v119, v128
    v_max3_f32 v128, v120, v121, v128
    v_max3_f32 v128, v122, v123, v128
    v_max3_f32 v128, v124, v125, v128
    v_max3_f32 v128, v126, v127, v128
    v_mfma_f32_32x32x16_bf16 v[112:127], a[48:51], v[16:19], 0
    v_mfma_f32_32x32x16_bf16 v[112:127], a[52:55], v[20:23], v[112:127]
    s_nop 11
    v_max3_f32 v128, v112, v113, v128
    v_max3_f32 v128, v114, v115, v128
    v_max3_f32 v128, v116, v117, v128
    v_max3_f32 v128, v118, v119, v128
    v_max3_f32 v128, v120, v121, v128
    v_max3_f32 v128, v122, v123, v128
    v_max3_f32 v128, v124, v125, v128
    v_max3_f32 v128, v126, v127, v128
    v_mfma_f32_32x32x16_bf16 v[112:127], a[64:67], v[16:19], 0
    v_mfma_f32_32x32x16_bf16 v[112:127], a[68:71], v[20:23], v[112:127]
    s_nop 11
    v_max3_f32 v128, v112, v113, v128
    v_max3_f32 v128, v114, v115, v128
    v_max3_f32 v128, v116, v117, v128
    v_max3_f32 v128, v118, v119, v128
    v_max3_f32 v128, v120, v121, v128
    v_max3_f32 v128, v122, v123, v128
    v_max3_f32 v128, v124, v125, v128
    v_max3_f32 v128, v126, v127, v128
    v_mfma_f32_32x32x16_bf16 v[112:127], a[80:83], v[16:19], 0
    v_mfma_f32_32x32x16_bf16 v[112:127], a[84:87], v[20:23], v[112:127]
    s_nop 11
    v_max3_f32 v128, v112, v113, v128
    v_max3_f32 v128, v114, v115, v128
    v_max3_f32 v128, v116, v117, v128
    v_max3_f32 v128, v118, v119, v128
    v_max3_f32 v128, v120, v121, v128
    v_max3_f32 v128, v122, v123, v128
    v_max3_f32 v128, v124, v125, v128
    v_max3_f32 v128, v126, v127, v128
    v_mfma_f32_32x32x16_bf16 v[112:127], a[96:99], v[16:19], 0
    v_mfma_f32_32x32x16_bf16 v[112:127], a[100:103], v[20:23], v[112:127]
    s_nop 11
    v_max3_f32 v128, v112, v113, v128
    v_max3_f32 v128, v114, v115, v128
    v_max3_f32 v128, v116, v117, v128
    v_max3_f32 v128, v118, v119, v128
    v_max3_f32 v128, v120, v121, v128
    v_max3_f32 v128, v122, v123, v128
    v_max3_f32 v128, v124, v125, v128
    v_max3_f32 v128, v126, v127, v128
    v_mfma_f32_32x32x16_bf16 v[112:127], a[112:115], v[16:19], 0
    v_mfma_f32_32x32x16_bf16 v[112:127], a[116:119], v[20:23], v[112:127]
    s_nop 11
    v_max3_f32 v128, v112, v113, v128
    v_max3_f32 v128, v114, v115, v128
    v_max3_f32 v128, v116, v117, v128
    v_max3_f32 v128, v118, v119, v128
    v_max3_f32 v128, v120, v121, v128
    v_max3_f32 v128, v122, v123, v128
    v_max3_f32 v128, v124, v125, v128
    v_max3_f32 v128, v126, v127, v128
    v_mfma_f32_32x32x16_bf16 v[112:127], a[128:131], v[16:19], 0
    v_mfma_f32_32x32x16_bf16 v[112:127], a[132:135], v[20:23], v[112:127]
    s_nop 11
    v_max3_f32 v128, v112, v113, v128
    v_max3_f32 v128, v114, v115, v128
    v_max3_f32 v128, v116, v117, v128
    v_max3_f32 v128, v118, v119, v128
    v_max3_f32 v128, v120, v121, v128
    v_max3_f32 v128, v122, v123, v128
    v_max3_f32 v128, v124, v125, v128
    v_max3_f32 v128, v126, v127, v128
    v_mfma_f32_32x32x16_bf16 v[112:127], a[144:147], v[16:19], 0
    v_mfma_f32_32x32x16_bf16 v[112:127], a[148:151], v[20:23], v[112:127]
    s_nop 11
    v_max3_f32 v128, v112, v113, v128
    v_max3_f32 v128, v114, v115, v128
    v_max3_f32 v128, v116, v117, v128
    v_max3_f32 v128, v118, v119, v128
    v_max3_f32 v128, v120, v121, v128
    v_max3_f32 v128, v122, v123, v128
    v_max3_f32 v128, v124, v125, v128
    v_max3_f32 v128, v126, v127, v128
    v_mfma_f32_32x32x16_bf16 v[112:127], a[160:163], v[16:19], 0
    v_mfma_f32_32x32x16_bf16 v[112:127], a[164:167], v[20:23], v[112:127]
    s_nop 11
    v_max3_f32 v128, v112, v113, v128
    v_max3_f32 v128, v114, v115, v128
    v_max3_f32 v128, v116, v117, v128
    v_max3_f32 v128, v118, v119, v128
    v_max3_f32 v128, v120, v121, v128
    v_max3_f32 v128, v122, v123, v128
    v_max3_f32 v128, v124, v125, v128
    v_max3_f32 v128, v126, v127, v128
    v_mfma_f32_32x32x16_bf16 v[112:127], a[176:179], v[16:19], 0
    v_mfma_f32_32x32x16_bf16 v[112:127], a[180:183], v[20:23], v[112:127]
    s_nop 11
    v_max3_f32 v128, v112, v113, v128
    v_max3_f32 v128, v114, v115, v128
    v_max3_f32 v128, v116, v117, v128
    v_max3_f32 v128, v118, v119, v128
    v_max3_f32 v128, v120, v121, v128
    v_max3_f32 v128, v122, v123, v128
    v_max3_f32 v128, v124, v125, v128
    v_max3_f32 v128, v126, v127, v128
    v_mfma_f32_32x32x16_bf16 v[112:127], a[192:195], v[16:19], 0
    v_mfma_f32_32x32x16_bf16 v[112:127], a[196:199], v[20:23], v[112:127]
    s_nop 11
    v_max3_f32 v128, v112, v113, v128
    v_max3_f32 v128, v114, v115, v128
    v_max3_f32 v128, v116, v117, v128
    v_max3_f32 v128, v118, v119, v128
    v_max3_f32 v128, v120, v121, v128
    v_max3_f32 v128, v122, v123, v128
    v_max3_f32 v128, v124, v125, v128
    v_max3_f32 v128, v126, v127, v128
    v_mfma_f32_32x32x16_bf16 v[112:127], a[208:211], v[16:19], 0
    v_mfma_f32_32x32x16_bf16 v[112:127], a[212:215], v[20:23], v[112:127]
    s_nop 11
    v_max3_f32 v128, v112, v113, v128
    v_max3_f32 v128, v114, v115, v128
    v_max3_f32 v128, v116, v117, v128
    v_max3_f32 v128, v118, v119, v128
    v_max3_f32 v128, v120, v121, v128
    v_max3_f32 v128, v122, v123, v128
    v_max3_f32 v128, v124, v125, v128
    v_max3_f32 v128, v126, v127, v128
    v_mfma_f32_32x32x16_bf16 v[112:127], a[224:227], v[16:19], 0
    v_mfma_f32_32x32x16_bf16 v[112:127], a[228:231], v[20:23], v[112:127]
    s_nop 11
    v_max3_f32 v128, v112, v113, v128
    v_max3_f32 v128, v114, v115, v128
    v_max3_f32 v128, v116, v117, v128
    v_max3_f32 v128, v118, v119, v128
    v_max3_f32 v128, v120, v121, v128
    v_max3_f32 v128, v122, v123, v128
    v_max3_f32 v128, v124, v125, v128
    v_max3_f32 v128, v126, v127, v128
    v_mfma_f32_32x32x16_bf16 v[112:127], a[240:243], v[16:19], 0
    v_mfma_f32_32x32x16_bf16 v[112:127], a[244:247], v[20:23], v[112:127]
    s_nop 11
    v_max3_f32 v128, v112, v113, v128
    v_max3_f32 v128, v114, v115, v128
    v_max3_f32 v128, v116, v117, v128
    v_max3_f32 v128, v118, v119, v128
    v_max3_f32 v128, v120, v121, v128
    v_max3_f32 v128, v122, v123, v128
    v_max3_f32 v128, v124, v125, v128
    v_max3_f32 v128, v126, v127, v128
    v_mov_b32 v13, v128
    s_nop 1
    v_permlane32_swap_b32 v128, v13
    v_max_f32 v128, v128, v13
    s_xor_b32 s76, s16, 3
    s_lshl_b32 s76, s76, 9
    s_add_u32 s76, s76, 114688
    v_and_b32 v13, 31, v1
    v_lshlrev_b32 v13, 4, v13
    v_add_u32 v132, s76, v13
    s_lshl_b32 s76, s16, 2
    v_add_u32 v13, s76, v132
    ds_write_b32 v13, v128
    v_mov_b32 v129, 0xff800000
    v_mfma_f32_32x32x16_bf16 v[112:127], a[0:3], v[24:27], 0
    v_mfma_f32_32x32x16_bf16 v[112:127], a[4:7], v[28:31], v[112:127]
    s_nop 11
    v_max3_f32 v129, v112, v113, v129
    v_max3_f32 v129, v114, v115, v129
    v_max3_f32 v129, v116, v117, v129
    v_max3_f32 v129, v118, v119, v129
    v_max3_f32 v129, v120, v121, v129
    v_max3_f32 v129, v122, v123, v129
    v_max3_f32 v129, v124, v125, v129
    v_max3_f32 v129, v126, v127, v129
    v_mfma_f32_32x32x16_bf16 v[112:127], a[16:19], v[24:27], 0
    v_mfma_f32_32x32x16_bf16 v[112:127], a[20:23], v[28:31], v[112:127]
    s_nop 11
    v_max3_f32 v129, v112, v113, v129
    v_max3_f32 v129, v114, v115, v129
    v_max3_f32 v129, v116, v117, v129
    v_max3_f32 v129, v118, v119, v129
    v_max3_f32 v129, v120, v121, v129
    v_max3_f32 v129, v122, v123, v129
    v_max3_f32 v129, v124, v125, v129
    v_max3_f32 v129, v126, v127, v129
    v_mfma_f32_32x32x16_bf16 v[112:127], a[32:35], v[24:27], 0
    v_mfma_f32_32x32x16_bf16 v[112:127], a[36:39], v[28:31], v[112:127]
    s_nop 11
    v_max3_f32 v129, v112, v113, v129
    v_max3_f32 v129, v114, v115, v129
    v_max3_f32 v129, v116, v117, v129
    v_max3_f32 v129, v118, v119, v129
    v_max3_f32 v129, v120, v121, v129
    v_max3_f32 v129, v122, v123, v129
    v_max3_f32 v129, v124, v125, v129
    v_max3_f32 v129, v126, v127, v129
    v_mfma_f32_32x32x16_bf16 v[112:127], a[48:51], v[24:27], 0
    v_mfma_f32_32x32x16_bf16 v[112:127], a[52:55], v[28:31], v[112:127]
    s_nop 11
    v_max3_f32 v129, v112, v113, v129
    v_max3_f32 v129, v114, v115, v129
    v_max3_f32 v129, v116, v117, v129
    v_max3_f32 v129, v118, v119, v129
    v_max3_f32 v129, v120, v121, v129
    v_max3_f32 v129, v122, v123, v129
    v_max3_f32 v129, v124, v125, v129
    v_max3_f32 v129, v126, v127, v129
    v_mfma_f32_32x32x16_bf16 v[112:127], a[64:67], v[24:27], 0
    v_mfma_f32_32x32x16_bf16 v[112:127], a[68:71], v[28:31], v[112:127]
    s_nop 11
    v_max3_f32 v129, v112, v113, v129
    v_max3_f32 v129, v114, v115, v129
    v_max3_f32 v129, v116, v117, v129
    v_max3_f32 v129, v118, v119, v129
    v_max3_f32 v129, v120, v121, v129
    v_max3_f32 v129, v122, v123, v129
    v_max3_f32 v129, v124, v125, v129
    v_max3_f32 v129, v126, v127, v129
    v_mfma_f32_32x32x16_bf16 v[112:127], a[80:83], v[24:27], 0
    v_mfma_f32_32x32x16_bf16 v[112:127], a[84:87], v[28:31], v[112:127]
    s_nop 11
    v_max3_f32 v129, v112, v113, v129
    v_max3_f32 v129, v114, v115, v129
    v_max3_f32 v129, v116, v117, v129
    v_max3_f32 v129, v118, v119, v129
    v_max3_f32 v129, v120, v121, v129
    v_max3_f32 v129, v122, v123, v129
    v_max3_f32 v129, v124, v125, v129
    v_max3_f32 v129, v126, v127, v129
    v_mfma_f32_32x32x16_bf16 v[112:127], a[96:99], v[24:27], 0
    v_mfma_f32_32x32x16_bf16 v[112:127], a[100:103], v[28:31], v[112:127]
    s_nop 11
    v_max3_f32 v129, v112, v113, v129
    v_max3_f32 v129, v114, v115, v129
    v_max3_f32 v129, v116, v117, v129
    v_max3_f32 v129, v118, v119, v129
    v_max3_f32 v129, v120, v121, v129
    v_max3_f32 v129, v122, v123, v129
    v_max3_f32 v129, v124, v125, v129
    v_max3_f32 v129, v126, v127, v129
    v_mfma_f32_32x32x16_bf16 v[112:127], a[112:115], v[24:27], 0
    v_mfma_f32_32x32x16_bf16 v[112:127], a[116:119], v[28:31], v[112:127]
    s_nop 11
    v_max3_f32 v129, v112, v113, v129
    v_max3_f32 v129, v114, v115, v129
    v_max3_f32 v129, v116, v117, v129
    v_max3_f32 v129, v118, v119, v129
    v_max3_f32 v129, v120, v121, v129
    v_max3_f32 v129, v122, v123, v129
    v_max3_f32 v129, v124, v125, v129
    v_max3_f32 v129, v126, v127, v129
    v_mfma_f32_32x32x16_bf16 v[112:127], a[128:131], v[24:27], 0
    v_mfma_f32_32x32x16_bf16 v[112:127], a[132:135], v[28:31], v[112:127]
    s_nop 11
    v_max3_f32 v129, v112, v113, v129
    v_max3_f32 v129, v114, v115, v129
    v_max3_f32 v129, v116, v117, v129
    v_max3_f32 v129, v118, v119, v129
    v_max3_f32 v129, v120, v121, v129
    v_max3_f32 v129, v122, v123, v129
    v_max3_f32 v129, v124, v125, v129
    v_max3_f32 v129, v126, v127, v129
    v_mfma_f32_32x32x16_bf16 v[112:127], a[144:147], v[24:27], 0
    v_mfma_f32_32x32x16_bf16 v[112:127], a[148:151], v[28:31], v[112:127]
    s_nop 11
    v_max3_f32 v129, v112, v113, v129
    v_max3_f32 v129, v114, v115, v129
    v_max3_f32 v129, v116, v117, v129
    v_max3_f32 v129, v118, v119, v129
    v_max3_f32 v129, v120, v121, v129
    v_max3_f32 v129, v122, v123, v129
    v_max3_f32 v129, v124, v125, v129
    v_max3_f32 v129, v126, v127, v129
    v_mfma_f32_32x32x16_bf16 v[112:127], a[160:163], v[24:27], 0
    v_mfma_f32_32x32x16_bf16 v[112:127], a[164:167], v[28:31], v[112:127]
    s_nop 11
    v_max3_f32 v129, v112, v113, v129
    v_max3_f32 v129, v114, v115, v129
    v_max3_f32 v129, v116, v117, v129
    v_max3_f32 v129, v118, v119, v129
    v_max3_f32 v129, v120, v121, v129
    v_max3_f32 v129, v122, v123, v129
    v_max3_f32 v129, v124, v125, v129
    v_max3_f32 v129, v126, v127, v129
    v_mfma_f32_32x32x16_bf16 v[112:127], a[176:179], v[24:27], 0
    v_mfma_f32_32x32x16_bf16 v[112:127], a[180:183], v[28:31], v[112:127]
    s_nop 11
    v_max3_f32 v129, v112, v113, v129
    v_max3_f32 v129, v114, v115, v129
    v_max3_f32 v129, v116, v117, v129
    v_max3_f32 v129, v118, v119, v129
    v_max3_f32 v129, v120, v121, v129
    v_max3_f32 v129, v122, v123, v129
    v_max3_f32 v129, v124, v125, v129
    v_max3_f32 v129, v126, v127, v129
    v_mfma_f32_32x32x16_bf16 v[112:127], a[192:195], v[24:27], 0
    v_mfma_f32_32x32x16_bf16 v[112:127], a[196:199], v[28:31], v[112:127]
    s_nop 11
    v_max3_f32 v129, v112, v113, v129
    v_max3_f32 v129, v114, v115, v129
    v_max3_f32 v129, v116, v117, v129
    v_max3_f32 v129, v118, v119, v129
    v_max3_f32 v129, v120, v121, v129
    v_max3_f32 v129, v122, v123, v129
    v_max3_f32 v129, v124, v125, v129
    v_max3_f32 v129, v126, v127, v129
    v_mfma_f32_32x32x16_bf16 v[112:127], a[208:211], v[24:27], 0
    v_mfma_f32_32x32x16_bf16 v[112:127], a[212:215], v[28:31], v[112:127]
    s_nop 11
    v_max3_f32 v129, v112, v113, v129
    v_max3_f32 v129, v114, v115, v129
    v_max3_f32 v129, v116, v117, v129
    v_max3_f32 v129, v118, v119, v129
    v_max3_f32 v129, v120, v121, v129
    v_max3_f32 v129, v122, v123, v129
    v_max3_f32 v129, v124, v125, v129
    v_max3_f32 v129, v126, v127, v129
    v_mfma_f32_32x32x16_bf16 v[112:127], a[224:227], v[24:27], 0
    v_mfma_f32_32x32x16_bf16 v[112:127], a[228:231], v[28:31], v[112:127]
    s_nop 11
    v_max3_f32 v129, v112, v113, v129
    v_max3_f32 v129, v114, v115, v129
    v_max3_f32 v129, v116, v117, v129
    v_max3_f32 v129, v118, v119, v129
    v_max3_f32 v129, v120, v121, v129
    v_max3_f32 v129, v122, v123, v129
    v_max3_f32 v129, v124, v125, v129
    v_max3_f32 v129, v126, v127, v129
    v_mfma_f32_32x32x16_bf16 v[112:127], a[240:243], v[24:27], 0
    v_mfma_f32_32x32x16_bf16 v[112:127], a[244:247], v[28:31], v[112:127]
    s_nop 11
    v_max3_f32 v129, v112, v113, v129
    v_max3_f32 v129, v114, v115, v129
    v_max3_f32 v129, v116, v117, v129
    v_max3_f32 v129, v118, v119, v129
    v_max3_f32 v129, v120, v121, v129
    v_max3_f32 v129, v122, v123, v129
    v_max3_f32 v129, v124, v125, v129
    v_max3_f32 v129, v126, v127, v129
    v_mov_b32 v13, v129
    s_nop 1
    v_permlane32_swap_b32 v129, v13
    v_max_f32 v129, v129, v13
    s_xor_b32 s76, s16, 2
    s_lshl_b32 s76, s76, 9
    s_add_u32 s76, s76, 114688
    v_and_b32 v13, 31, v1
    v_lshlrev_b32 v13, 4, v13
    v_add_u32 v133, s76, v13
    s_lshl_b32 s76, s16, 2
    v_add_u32 v13, s76, v133
    ds_write_b32 v13, v129
    v_mov_b32 v130, 0xff800000
    v_mfma_f32_32x32x16_bf16 v[112:127], a[0:3], v[32:35], 0
    v_mfma_f32_32x32x16_bf16 v[112:127], a[4:7], v[36:39], v[112:127]
    s_nop 11
    v_max3_f32 v130, v112, v113, v130
    v_max3_f32 v130, v114, v115, v130
    v_max3_f32 v130, v116, v117, v130
    v_max3_f32 v130, v118, v119, v130
    v_max3_f32 v130, v120, v121, v130
    v_max3_f32 v130, v122, v123, v130
    v_max3_f32 v130, v124, v125, v130
    v_max3_f32 v130, v126, v127, v130
    v_mfma_f32_32x32x16_bf16 v[112:127], a[16:19], v[32:35], 0
    v_mfma_f32_32x32x16_bf16 v[112:127], a[20:23], v[36:39], v[112:127]
    s_nop 11
    v_max3_f32 v130, v112, v113, v130
    v_max3_f32 v130, v114, v115, v130
    v_max3_f32 v130, v116, v117, v130
    v_max3_f32 v130, v118, v119, v130
    v_max3_f32 v130, v120, v121, v130
    v_max3_f32 v130, v122, v123, v130
    v_max3_f32 v130, v124, v125, v130
    v_max3_f32 v130, v126, v127, v130
    v_mfma_f32_32x32x16_bf16 v[112:127], a[32:35], v[32:35], 0
    v_mfma_f32_32x32x16_bf16 v[112:127], a[36:39], v[36:39], v[112:127]
    s_nop 11
    v_max3_f32 v130, v112, v113, v130
    v_max3_f32 v130, v114, v115, v130
    v_max3_f32 v130, v116, v117, v130
    v_max3_f32 v130, v118, v119, v130
    v_max3_f32 v130, v120, v121, v130
    v_max3_f32 v130, v122, v123, v130
    v_max3_f32 v130, v124, v125, v130
    v_max3_f32 v130, v126, v127, v130
    v_mfma_f32_32x32x16_bf16 v[112:127], a[48:51], v[32:35], 0
    v_mfma_f32_32x32x16_bf16 v[112:127], a[52:55], v[36:39], v[112:127]
    s_nop 11
    v_max3_f32 v130, v112, v113, v130
    v_max3_f32 v130, v114, v115, v130
    v_max3_f32 v130, v116, v117, v130
    v_max3_f32 v130, v118, v119, v130
    v_max3_f32 v130, v120, v121, v130
    v_max3_f32 v130, v122, v123, v130
    v_max3_f32 v130, v124, v125, v130
    v_max3_f32 v130, v126, v127, v130
    v_mfma_f32_32x32x16_bf16 v[112:127], a[64:67], v[32:35], 0
    v_mfma_f32_32x32x16_bf16 v[112:127], a[68:71], v[36:39], v[112:127]
    s_nop 11
    v_max3_f32 v130, v112, v113, v130
    v_max3_f32 v130, v114, v115, v130
    v_max3_f32 v130, v116, v117, v130
    v_max3_f32 v130, v118, v119, v130
    v_max3_f32 v130, v120, v121, v130
    v_max3_f32 v130, v122, v123, v130
    v_max3_f32 v130, v124, v125, v130
    v_max3_f32 v130, v126, v127, v130
    v_mfma_f32_32x32x16_bf16 v[112:127], a[80:83], v[32:35], 0
    v_mfma_f32_32x32x16_bf16 v[112:127], a[84:87], v[36:39], v[112:127]
    s_nop 11
    v_max3_f32 v130, v112, v113, v130
    v_max3_f32 v130, v114, v115, v130
    v_max3_f32 v130, v116, v117, v130
    v_max3_f32 v130, v118, v119, v130
    v_max3_f32 v130, v120, v121, v130
    v_max3_f32 v130, v122, v123, v130
    v_max3_f32 v130, v124, v125, v130
    v_max3_f32 v130, v126, v127, v130
    v_mfma_f32_32x32x16_bf16 v[112:127], a[96:99], v[32:35], 0
    v_mfma_f32_32x32x16_bf16 v[112:127], a[100:103], v[36:39], v[112:127]
    s_nop 11
    v_max3_f32 v130, v112, v113, v130
    v_max3_f32 v130, v114, v115, v130
    v_max3_f32 v130, v116, v117, v130
    v_max3_f32 v130, v118, v119, v130
    v_max3_f32 v130, v120, v121, v130
    v_max3_f32 v130, v122, v123, v130
    v_max3_f32 v130, v124, v125, v130
    v_max3_f32 v130, v126, v127, v130
    v_mfma_f32_32x32x16_bf16 v[112:127], a[112:115], v[32:35], 0
    v_mfma_f32_32x32x16_bf16 v[112:127], a[116:119], v[36:39], v[112:127]
    s_nop 11
    v_max3_f32 v130, v112, v113, v130
    v_max3_f32 v130, v114, v115, v130
    v_max3_f32 v130, v116, v117, v130
    v_max3_f32 v130, v118, v119, v130
    v_max3_f32 v130, v120, v121, v130
    v_max3_f32 v130, v122, v123, v130
    v_max3_f32 v130, v124, v125, v130
    v_max3_f32 v130, v126, v127, v130
    v_mfma_f32_32x32x16_bf16 v[112:127], a[128:131], v[32:35], 0
    v_mfma_f32_32x32x16_bf16 v[112:127], a[132:135], v[36:39], v[112:127]
    s_nop 11
    v_max3_f32 v130, v112, v113, v130
    v_max3_f32 v130, v114, v115, v130
    v_max3_f32 v130, v116, v117, v130
    v_max3_f32 v130, v118, v119, v130
    v_max3_f32 v130, v120, v121, v130
    v_max3_f32 v130, v122, v123, v130
    v_max3_f32 v130, v124, v125, v130
    v_max3_f32 v130, v126, v127, v130
    v_mfma_f32_32x32x16_bf16 v[112:127], a[144:147], v[32:35], 0
    v_mfma_f32_32x32x16_bf16 v[112:127], a[148:151], v[36:39], v[112:127]
    s_nop 11
    v_max3_f32 v130, v112, v113, v130
    v_max3_f32 v130, v114, v115, v130
    v_max3_f32 v130, v116, v117, v130
    v_max3_f32 v130, v118, v119, v130
    v_max3_f32 v130, v120, v121, v130
    v_max3_f32 v130, v122, v123, v130
    v_max3_f32 v130, v124, v125, v130
    v_max3_f32 v130, v126, v127, v130
    v_mfma_f32_32x32x16_bf16 v[112:127], a[160:163], v[32:35], 0
    v_mfma_f32_32x32x16_bf16 v[112:127], a[164:167], v[36:39], v[112:127]
    s_nop 11
    v_max3_f32 v130, v112, v113, v130
    v_max3_f32 v130, v114, v115, v130
    v_max3_f32 v130, v116, v117, v130
    v_max3_f32 v130, v118, v119, v130
    v_max3_f32 v130, v120, v121, v130
    v_max3_f32 v130, v122, v123, v130
    v_max3_f32 v130, v124, v125, v130
    v_max3_f32 v130, v126, v127, v130
    v_mfma_f32_32x32x16_bf16 v[112:127], a[176:179], v[32:35], 0
    v_mfma_f32_32x32x16_bf16 v[112:127], a[180:183], v[36:39], v[112:127]
    s_nop 11
    v_max3_f32 v130, v112, v113, v130
    v_max3_f32 v130, v114, v115, v130
    v_max3_f32 v130, v116, v117, v130
    v_max3_f32 v130, v118, v119, v130
    v_max3_f32 v130, v120, v121, v130
    v_max3_f32 v130, v122, v123, v130
    v_max3_f32 v130, v124, v125, v130
    v_max3_f32 v130, v126, v127, v130
    v_mfma_f32_32x32x16_bf16 v[112:127], a[192:195], v[32:35], 0
    v_mfma_f32_32x32x16_bf16 v[112:127], a[196:199], v[36:39], v[112:127]
    s_nop 11
    v_max3_f32 v130, v112, v113, v130
    v_max3_f32 v130, v114, v115, v130
    v_max3_f32 v130, v116, v117, v130
    v_max3_f32 v130, v118, v119, v130
    v_max3_f32 v130, v120, v121, v130
    v_max3_f32 v130, v122, v123, v130
    v_max3_f32 v130, v124, v125, v130
    v_max3_f32 v130, v126, v127, v130
    v_mfma_f32_32x32x16_bf16 v[112:127], a[208:211], v[32:35], 0
    v_mfma_f32_32x32x16_bf16 v[112:127], a[212:215], v[36:39], v[112:127]
    s_nop 11
    v_max3_f32 v130, v112, v113, v130
    v_max3_f32 v130, v114, v115, v130
    v_max3_f32 v130, v116, v117, v130
    v_max3_f32 v130, v118, v119, v130
    v_max3_f32 v130, v120, v121, v130
    v_max3_f32 v130, v122, v123, v130
    v_max3_f32 v130, v124, v125, v130
    v_max3_f32 v130, v126, v127, v130
    v_mfma_f32_32x32x16_bf16 v[112:127], a[224:227], v[32:35], 0
    v_mfma_f32_32x32x16_bf16 v[112:127], a[228:231], v[36:39], v[112:127]
    s_nop 11
    v_max3_f32 v130, v112, v113, v130
    v_max3_f32 v130, v114, v115, v130
    v_max3_f32 v130, v116, v117, v130
    v_max3_f32 v130, v118, v119, v130
    v_max3_f32 v130, v120, v121, v130
    v_max3_f32 v130, v122, v123, v130
    v_max3_f32 v130, v124, v125, v130
    v_max3_f32 v130, v126, v127, v130
    v_mfma_f32_32x32x16_bf16 v[112:127], a[240:243], v[32:35], 0
    v_mfma_f32_32x32x16_bf16 v[112:127], a[244:247], v[36:39], v[112:127]
    s_nop 11
    v_max3_f32 v130, v112, v113, v130
    v_max3_f32 v130, v114, v115, v130
    v_max3_f32 v130, v116, v117, v130
    v_max3_f32 v130, v118, v119, v130
    v_max3_f32 v130, v120, v121, v130
    v_max3_f32 v130, v122, v123, v130
    v_max3_f32 v130, v124, v125, v130
    v_max3_f32 v130, v126, v127, v130
    v_mov_b32 v13, v130
    s_nop 1
    v_permlane32_swap_b32 v130, v13
    v_max_f32 v130, v130, v13
    s_xor_b32 s76, s16, 1
    s_lshl_b32 s76, s76, 9
    s_add_u32 s76, s76, 114688
    v_and_b32 v13, 31, v1
    v_lshlrev_b32 v13, 4, v13
    v_add_u32 v134, s76, v13
    s_lshl_b32 s76, s16, 2
    v_add_u32 v13, s76, v134
    ds_write_b32 v13, v130
    v_mov_b32 v131, 0xff800000
    v_mfma_f32_32x32x16_bf16 v[112:127], a[0:3], v[40:43], 0
    v_mfma_f32_32x32x16_bf16 v[112:127], a[4:7], v[44:47], v[112:127]
    s_nop 11
    v_max3_f32 v131, v112, v113, v131
    v_max3_f32 v131, v114, v115, v131
    v_max3_f32 v131, v116, v117, v131
    v_max3_f32 v131, v118, v119, v131
    v_max3_f32 v131, v120, v121, v131
    v_max3_f32 v131, v122, v123, v131
    v_max3_f32 v131, v124, v125, v131
    v_max3_f32 v131, v126, v127, v131
    v_mfma_f32_32x32x16_bf16 v[112:127], a[16:19], v[40:43], 0
    v_mfma_f32_32x32x16_bf16 v[112:127], a[20:23], v[44:47], v[112:127]
    s_nop 11
    v_max3_f32 v131, v112, v113, v131
    v_max3_f32 v131, v114, v115, v131
    v_max3_f32 v131, v116, v117, v131
    v_max3_f32 v131, v118, v119, v131
    v_max3_f32 v131, v120, v121, v131
    v_max3_f32 v131, v122, v123, v131
    v_max3_f32 v131, v124, v125, v131
    v_max3_f32 v131, v126, v127, v131
    v_mfma_f32_32x32x16_bf16 v[112:127], a[32:35], v[40:43], 0
    v_mfma_f32_32x32x16_bf16 v[112:127], a[36:39], v[44:47], v[112:127]
    s_nop 11
    v_max3_f32 v131, v112, v113, v131
    v_max3_f32 v131, v114, v115, v131
    v_max3_f32 v131, v116, v117, v131
    v_max3_f32 v131, v118, v119, v131
    v_max3_f32 v131, v120, v121, v131
    v_max3_f32 v131, v122, v123, v131
    v_max3_f32 v131, v124, v125, v131
    v_max3_f32 v131, v126, v127, v131
    v_mfma_f32_32x32x16_bf16 v[112:127], a[48:51], v[40:43], 0
    v_mfma_f32_32x32x16_bf16 v[112:127], a[52:55], v[44:47], v[112:127]
    s_nop 11
    v_max3_f32 v131, v112, v113, v131
    v_max3_f32 v131, v114, v115, v131
    v_max3_f32 v131, v116, v117, v131
    v_max3_f32 v131, v118, v119, v131
    v_max3_f32 v131, v120, v121, v131
    v_max3_f32 v131, v122, v123, v131
    v_max3_f32 v131, v124, v125, v131
    v_max3_f32 v131, v126, v127, v131
    v_mfma_f32_32x32x16_bf16 v[112:127], a[64:67], v[40:43], 0
    v_mfma_f32_32x32x16_bf16 v[112:127], a[68:71], v[44:47], v[112:127]
    s_nop 11
    v_max3_f32 v131, v112, v113, v131
    v_max3_f32 v131, v114, v115, v131
    v_max3_f32 v131, v116, v117, v131
    v_max3_f32 v131, v118, v119, v131
    v_max3_f32 v131, v120, v121, v131
    v_max3_f32 v131, v122, v123, v131
    v_max3_f32 v131, v124, v125, v131
    v_max3_f32 v131, v126, v127, v131
    v_mfma_f32_32x32x16_bf16 v[112:127], a[80:83], v[40:43], 0
    v_mfma_f32_32x32x16_bf16 v[112:127], a[84:87], v[44:47], v[112:127]
    s_nop 11
    v_max3_f32 v131, v112, v113, v131
    v_max3_f32 v131, v114, v115, v131
    v_max3_f32 v131, v116, v117, v131
    v_max3_f32 v131, v118, v119, v131
    v_max3_f32 v131, v120, v121, v131
    v_max3_f32 v131, v122, v123, v131
    v_max3_f32 v131, v124, v125, v131
    v_max3_f32 v131, v126, v127, v131
    v_mfma_f32_32x32x16_bf16 v[112:127], a[96:99], v[40:43], 0
    v_mfma_f32_32x32x16_bf16 v[112:127], a[100:103], v[44:47], v[112:127]
    s_nop 11
    v_max3_f32 v131, v112, v113, v131
    v_max3_f32 v131, v114, v115, v131
    v_max3_f32 v131, v116, v117, v131
    v_max3_f32 v131, v118, v119, v131
    v_max3_f32 v131, v120, v121, v131
    v_max3_f32 v131, v122, v123, v131
    v_max3_f32 v131, v124, v125, v131
    v_max3_f32 v131, v126, v127, v131
    v_mfma_f32_32x32x16_bf16 v[112:127], a[112:115], v[40:43], 0
    v_mfma_f32_32x32x16_bf16 v[112:127], a[116:119], v[44:47], v[112:127]
    s_nop 11
    v_max3_f32 v131, v112, v113, v131
    v_max3_f32 v131, v114, v115, v131
    v_max3_f32 v131, v116, v117, v131
    v_max3_f32 v131, v118, v119, v131
    v_max3_f32 v131, v120, v121, v131
    v_max3_f32 v131, v122, v123, v131
    v_max3_f32 v131, v124, v125, v131
    v_max3_f32 v131, v126, v127, v131
    v_mfma_f32_32x32x16_bf16 v[112:127], a[128:131], v[40:43], 0
    v_mfma_f32_32x32x16_bf16 v[112:127], a[132:135], v[44:47], v[112:127]
    s_nop 11
    v_max3_f32 v131, v112, v113, v131
    v_max3_f32 v131, v114, v115, v131
    v_max3_f32 v131, v116, v117, v131
    v_max3_f32 v131, v118, v119, v131
    v_max3_f32 v131, v120, v121, v131
    v_max3_f32 v131, v122, v123, v131
    v_max3_f32 v131, v124, v125, v131
    v_max3_f32 v131, v126, v127, v131
    v_mfma_f32_32x32x16_bf16 v[112:127], a[144:147], v[40:43], 0
    v_mfma_f32_32x32x16_bf16 v[112:127], a[148:151], v[44:47], v[112:127]
    s_nop 11
    v_max3_f32 v131, v112, v113, v131
    v_max3_f32 v131, v114, v115, v131
    v_max3_f32 v131, v116, v117, v131
    v_max3_f32 v131, v118, v119, v131
    v_max3_f32 v131, v120, v121, v131
    v_max3_f32 v131, v122, v123, v131
    v_max3_f32 v131, v124, v125, v131
    v_max3_f32 v131, v126, v127, v131
    v_mfma_f32_32x32x16_bf16 v[112:127], a[160:163], v[40:43], 0
    v_mfma_f32_32x32x16_bf16 v[112:127], a[164:167], v[44:47], v[112:127]
    s_nop 11
    v_max3_f32 v131, v112, v113, v131
    v_max3_f32 v131, v114, v115, v131
    v_max3_f32 v131, v116, v117, v131
    v_max3_f32 v131, v118, v119, v131
    v_max3_f32 v131, v120, v121, v131
    v_max3_f32 v131, v122, v123, v131
    v_max3_f32 v131, v124, v125, v131
    v_max3_f32 v131, v126, v127, v131
    v_mfma_f32_32x32x16_bf16 v[112:127], a[176:179], v[40:43], 0
    v_mfma_f32_32x32x16_bf16 v[112:127], a[180:183], v[44:47], v[112:127]
    s_nop 11
    v_max3_f32 v131, v112, v113, v131
    v_max3_f32 v131, v114, v115, v131
    v_max3_f32 v131, v116, v117, v131
    v_max3_f32 v131, v118, v119, v131
    v_max3_f32 v131, v120, v121, v131
    v_max3_f32 v131, v122, v123, v131
    v_max3_f32 v131, v124, v125, v131
    v_max3_f32 v131, v126, v127, v131
    v_mfma_f32_32x32x16_bf16 v[112:127], a[192:195], v[40:43], 0
    v_mfma_f32_32x32x16_bf16 v[112:127], a[196:199], v[44:47], v[112:127]
    s_nop 11
    v_max3_f32 v131, v112, v113, v131
    v_max3_f32 v131, v114, v115, v131
    v_max3_f32 v131, v116, v117, v131
    v_max3_f32 v131, v118, v119, v131
    v_max3_f32 v131, v120, v121, v131
    v_max3_f32 v131, v122, v123, v131
    v_max3_f32 v131, v124, v125, v131
    v_max3_f32 v131, v126, v127, v131
    v_mfma_f32_32x32x16_bf16 v[112:127], a[208:211], v[40:43], 0
    v_mfma_f32_32x32x16_bf16 v[112:127], a[212:215], v[44:47], v[112:127]
    s_nop 11
    v_max3_f32 v131, v112, v113, v131
    v_max3_f32 v131, v114, v115, v131
    v_max3_f32 v131, v116, v117, v131
    v_max3_f32 v131, v118, v119, v131
    v_max3_f32 v131, v120, v121, v131
    v_max3_f32 v131, v122, v123, v131
    v_max3_f32 v131, v124, v125, v131
    v_max3_f32 v131, v126, v127, v131
    v_mfma_f32_32x32x16_bf16 v[112:127], a[224:227], v[40:43], 0
    v_mfma_f32_32x32x16_bf16 v[112:127], a[228:231], v[44:47], v[112:127]
    s_nop 11
    v_max3_f32 v131, v112, v113, v131
    v_max3_f32 v131, v114, v115, v131
    v_max3_f32 v131, v116, v117, v131
    v_max3_f32 v131, v118, v119, v131
    v_max3_f32 v131, v120, v121, v131
    v_max3_f32 v131, v122, v123, v131
    v_max3_f32 v131, v124, v125, v131
    v_max3_f32 v131, v126, v127, v131
    v_mfma_f32_32x32x16_bf16 v[112:127], a[240:243], v[40:43], 0
    v_mfma_f32_32x32x16_bf16 v[112:127], a[244:247], v[44:47], v[112:127]
    s_nop 11
    v_max3_f32 v131, v112, v113, v131
    v_max3_f32 v131, v114, v115, v131
    v_max3_f32 v131, v116, v117, v131
    v_max3_f32 v131, v118, v119, v131
    v_max3_f32 v131, v120, v121, v131
    v_max3_f32 v131, v122, v123, v131
    v_max3_f32 v131, v124, v125, v131
    v_max3_f32 v131, v126, v127, v131
    v_mov_b32 v13, v131
    s_nop 1
    v_permlane32_swap_b32 v131, v13
    v_max_f32 v131, v131, v13
    s_xor_b32 s76, s16, 0
    s_lshl_b32 s76, s76, 9
    s_add_u32 s76, s76, 114688
    v_and_b32 v13, 31, v1
    v_lshlrev_b32 v13, 4, v13
    v_add_u32 v135, s76, v13
    s_lshl_b32 s76, s16, 2
    v_add_u32 v13, s76, v135
    ds_write_b32 v13, v131
    s_waitcnt lgkmcnt(0)
    s_barrier
    ds_read_b128 v[112:115], v132
    ds_read_b128 v[116:119], v133
    ds_read_b128 v[120:123], v134
    ds_read_b128 v[124:127], v135
    s_waitcnt lgkmcnt(0)
    s_barrier
    v_max3_f32 v128, v112, v113, v114
    v_max_f32 v128, v128, v115
    v_max3_f32 v129, v116, v117, v118
    v_max_f32 v129, v129, v119
    v_max3_f32 v130, v120, v121, v122
    v_max_f32 v130, v130, v123
    v_max3_f32 v131, v124, v125, v126
    v_max_f32 v131, v131, v127
    v_sub_f32 v144, 0, v128
    v_mov_b32 v48, 0
    v_sub_f32 v145, 0, v128
    v_mov_b32 v49, 0
    v_sub_f32 v146, 0, v128
    v_mov_b32 v50, 0
    v_sub_f32 v147, 0, v128
    v_mov_b32 v51, 0
    v_sub_f32 v148, 0, v128
    v_mov_b32 v52, 0
    v_sub_f32 v149, 0, v128
    v_mov_b32 v53, 0
    v_sub_f32 v150, 0, v128
    v_mov_b32 v54, 0
    v_sub_f32 v151, 0, v128
    v_mov_b32 v55, 0
    v_sub_f32 v152, 0, v128
    v_mov_b32 v56, 0
    v_sub_f32 v153, 0, v128
    v_mov_b32 v57, 0
    v_sub_f32 v154, 0, v128
    v_mov_b32 v58, 0
    v_sub_f32 v155, 0, v128
    v_mov_b32 v59, 0
    v_sub_f32 v156, 0, v128
    v_mov_b32 v60, 0
    v_sub_f32 v157, 0, v128
    v_mov_b32 v61, 0
    v_sub_f32 v158, 0, v128
    v_mov_b32 v62, 0
    v_sub_f32 v159, 0, v128
    v_mov_b32 v63, 0
    s_nop 0
    v_mfma_f32_32x32x16_bf16 v[112:127], a[0:3], v[16:19], v[144:159]
    v_mfma_f32_32x32x16_bf16 v[112:127], a[4:7], v[20:23], v[112:127]
    s_nop 11
    v_exp_f32 v112, v112
    v_exp_f32 v113, v113
    v_exp_f32 v114, v114
    v_exp_f32 v115, v115
    v_exp_f32 v116, v116
    v_exp_f32 v117, v117
    v_exp_f32 v118, v118
    v_exp_f32 v119, v119
    v_exp_f32 v120, v120
    v_exp_f32 v121, v121
    v_exp_f32 v122, v122
    v_exp_f32 v123, v123
    v_exp_f32 v124, v124
    v_exp_f32 v125, v125
    v_exp_f32 v126, v126
    v_exp_f32 v127, v127
    v_smfmac_f32_32x32x32_bf16 v[48:63], a[8:11], v[112:119], v7
    s_nop 0
    v_smfmac_f32_32x32x32_bf16 v[48:63], a[12:15], v[120:127], v7
    s_nop 7
    v_mfma_f32_32x32x16_bf16 v[112:127], a[16:19], v[16:19], v[144:159]
    v_mfma_f32_32x32x16_bf16 v[112:127], a[20:23], v[20:23], v[112:127]
    s_nop 11
    v_exp_f32 v112, v112
    v_exp_f32 v113, v113
    v_exp_f32 v114, v114
    v_exp_f32 v115, v115
    v_exp_f32 v116, v116
    v_exp_f32 v117, v117
    v_exp_f32 v118, v118
    v_exp_f32 v119, v119
    v_exp_f32 v120, v120
    v_exp_f32 v121, v121
    v_exp_f32 v122, v122
    v_exp_f32 v123, v123
    v_exp_f32 v124, v124
    v_exp_f32 v125, v125
    v_exp_f32 v126, v126
    v_exp_f32 v127, v127
    v_smfmac_f32_32x32x32_bf16 v[48:63], a[24:27], v[112:119], v7
    s_nop 0
    v_smfmac_f32_32x32x32_bf16 v[48:63], a[28:31], v[120:127], v7
    s_nop 7
    v_mfma_f32_32x32x16_bf16 v[112:127], a[32:35], v[16:19], v[144:159]
    v_mfma_f32_32x32x16_bf16 v[112:127], a[36:39], v[20:23], v[112:127]
    s_nop 11
    v_exp_f32 v112, v112
    v_exp_f32 v113, v113
    v_exp_f32 v114, v114
    v_exp_f32 v115, v115
    v_exp_f32 v116, v116
    v_exp_f32 v117, v117
    v_exp_f32 v118, v118
    v_exp_f32 v119, v119
    v_exp_f32 v120, v120
    v_exp_f32 v121, v121
    v_exp_f32 v122, v122
    v_exp_f32 v123, v123
    v_exp_f32 v124, v124
    v_exp_f32 v125, v125
    v_exp_f32 v126, v126
    v_exp_f32 v127, v127
    v_smfmac_f32_32x32x32_bf16 v[48:63], a[40:43], v[112:119], v7
    s_nop 0
    v_smfmac_f32_32x32x32_bf16 v[48:63], a[44:47], v[120:127], v7
    s_nop 7
    v_mfma_f32_32x32x16_bf16 v[112:127], a[48:51], v[16:19], v[144:159]
    v_mfma_f32_32x32x16_bf16 v[112:127], a[52:55], v[20:23], v[112:127]
    s_nop 11
    v_exp_f32 v112, v112
    v_exp_f32 v113, v113
    v_exp_f32 v114, v114
    v_exp_f32 v115, v115
    v_exp_f32 v116, v116
    v_exp_f32 v117, v117
    v_exp_f32 v118, v118
    v_exp_f32 v119, v119
    v_exp_f32 v120, v120
    v_exp_f32 v121, v121
    v_exp_f32 v122, v122
    v_exp_f32 v123, v123
    v_exp_f32 v124, v124
    v_exp_f32 v125, v125
    v_exp_f32 v126, v126
    v_exp_f32 v127, v127
    v_smfmac_f32_32x32x32_bf16 v[48:63], a[56:59], v[112:119], v7
    s_nop 0
    v_smfmac_f32_32x32x32_bf16 v[48:63], a[60:63], v[120:127], v7
    s_nop 7
    v_mfma_f32_32x32x16_bf16 v[112:127], a[64:67], v[16:19], v[144:159]
    v_mfma_f32_32x32x16_bf16 v[112:127], a[68:71], v[20:23], v[112:127]
    s_nop 11
    v_exp_f32 v112, v112
    v_exp_f32 v113, v113
    v_exp_f32 v114, v114
    v_exp_f32 v115, v115
    v_exp_f32 v116, v116
    v_exp_f32 v117, v117
    v_exp_f32 v118, v118
    v_exp_f32 v119, v119
    v_exp_f32 v120, v120
    v_exp_f32 v121, v121
    v_exp_f32 v122, v122
    v_exp_f32 v123, v123
    v_exp_f32 v124, v124
    v_exp_f32 v125, v125
    v_exp_f32 v126, v126
    v_exp_f32 v127, v127
    v_smfmac_f32_32x32x32_bf16 v[48:63], a[72:75], v[112:119], v7
    s_nop 0
    v_smfmac_f32_32x32x32_bf16 v[48:63], a[76:79], v[120:127], v7
    s_nop 7
    v_mfma_f32_32x32x16_bf16 v[112:127], a[80:83], v[16:19], v[144:159]
    v_mfma_f32_32x32x16_bf16 v[112:127], a[84:87], v[20:23], v[112:127]
    s_nop 11
    v_exp_f32 v112, v112
    v_exp_f32 v113, v113
    v_exp_f32 v114, v114
    v_exp_f32 v115, v115
    v_exp_f32 v116, v116
    v_exp_f32 v117, v117
    v_exp_f32 v118, v118
    v_exp_f32 v119, v119
    v_exp_f32 v120, v120
    v_exp_f32 v121, v121
    v_exp_f32 v122, v122
    v_exp_f32 v123, v123
    v_exp_f32 v124, v124
    v_exp_f32 v125, v125
    v_exp_f32 v126, v126
    v_exp_f32 v127, v127
    v_smfmac_f32_32x32x32_bf16 v[48:63], a[88:91], v[112:119], v7
    s_nop 0
    v_smfmac_f32_32x32x32_bf16 v[48:63], a[92:95], v[120:127], v7
    s_nop 7
    v_mfma_f32_32x32x16_bf16 v[112:127], a[96:99], v[16:19], v[144:159]
    v_mfma_f32_32x32x16_bf16 v[112:127], a[100:103], v[20:23], v[112:127]
    s_nop 11
    v_exp_f32 v112, v112
    v_exp_f32 v113, v113
    v_exp_f32 v114, v114
    v_exp_f32 v115, v115
    v_exp_f32 v116, v116
    v_exp_f32 v117, v117
    v_exp_f32 v118, v118
    v_exp_f32 v119, v119
    v_exp_f32 v120, v120
    v_exp_f32 v121, v121
    v_exp_f32 v122, v122
    v_exp_f32 v123, v123
    v_exp_f32 v124, v124
    v_exp_f32 v125, v125
    v_exp_f32 v126, v126
    v_exp_f32 v127, v127
    v_smfmac_f32_32x32x32_bf16 v[48:63], a[104:107], v[112:119], v7
    s_nop 0
    v_smfmac_f32_32x32x32_bf16 v[48:63], a[108:111], v[120:127], v7
    s_nop 7
    v_mfma_f32_32x32x16_bf16 v[112:127], a[112:115], v[16:19], v[144:159]
    v_mfma_f32_32x32x16_bf16 v[112:127], a[116:119], v[20:23], v[112:127]
    s_nop 11
    v_exp_f32 v112, v112
    v_exp_f32 v113, v113
    v_exp_f32 v114, v114
    v_exp_f32 v115, v115
    v_exp_f32 v116, v116
    v_exp_f32 v117, v117
    v_exp_f32 v118, v118
    v_exp_f32 v119, v119
    v_exp_f32 v120, v120
    v_exp_f32 v121, v121
    v_exp_f32 v122, v122
    v_exp_f32 v123, v123
    v_exp_f32 v124, v124
    v_exp_f32 v125, v125
    v_exp_f32 v126, v126
    v_exp_f32 v127, v127
    v_smfmac_f32_32x32x32_bf16 v[48:63], a[120:123], v[112:119], v7
    s_nop 0
    v_smfmac_f32_32x32x32_bf16 v[48:63], a[124:127], v[120:127], v7
    s_nop 7
    v_mfma_f32_32x32x16_bf16 v[112:127], a[128:131], v[16:19], v[144:159]
    v_mfma_f32_32x32x16_bf16 v[112:127], a[132:135], v[20:23], v[112:127]
    s_nop 11
    v_exp_f32 v112, v112
    v_exp_f32 v113, v113
    v_exp_f32 v114, v114
    v_exp_f32 v115, v115
    v_exp_f32 v116, v116
    v_exp_f32 v117, v117
    v_exp_f32 v118, v118
    v_exp_f32 v119, v119
    v_exp_f32 v120, v120
    v_exp_f32 v121, v121
    v_exp_f32 v122, v122
    v_exp_f32 v123, v123
    v_exp_f32 v124, v124
    v_exp_f32 v125, v125
    v_exp_f32 v126, v126
    v_exp_f32 v127, v127
    v_smfmac_f32_32x32x32_bf16 v[48:63], a[136:139], v[112:119], v7
    s_nop 0
    v_smfmac_f32_32x32x32_bf16 v[48:63], a[140:143], v[120:127], v7
    s_nop 7
    v_mfma_f32_32x32x16_bf16 v[112:127], a[144:147], v[16:19], v[144:159]
    v_mfma_f32_32x32x16_bf16 v[112:127], a[148:151], v[20:23], v[112:127]
    s_nop 11
    v_exp_f32 v112, v112
    v_exp_f32 v113, v113
    v_exp_f32 v114, v114
    v_exp_f32 v115, v115
    v_exp_f32 v116, v116
    v_exp_f32 v117, v117
    v_exp_f32 v118, v118
    v_exp_f32 v119, v119
    v_exp_f32 v120, v120
    v_exp_f32 v121, v121
    v_exp_f32 v122, v122
    v_exp_f32 v123, v123
    v_exp_f32 v124, v124
    v_exp_f32 v125, v125
    v_exp_f32 v126, v126
    v_exp_f32 v127, v127
    v_smfmac_f32_32x32x32_bf16 v[48:63], a[152:155], v[112:119], v7
    s_nop 0
    v_smfmac_f32_32x32x32_bf16 v[48:63], a[156:159], v[120:127], v7
    s_nop 7
    v_mfma_f32_32x32x16_bf16 v[112:127], a[160:163], v[16:19], v[144:159]
    v_mfma_f32_32x32x16_bf16 v[112:127], a[164:167], v[20:23], v[112:127]
    s_nop 11
    v_exp_f32 v112, v112
    v_exp_f32 v113, v113
    v_exp_f32 v114, v114
    v_exp_f32 v115, v115
    v_exp_f32 v116, v116
    v_exp_f32 v117, v117
    v_exp_f32 v118, v118
    v_exp_f32 v119, v119
    v_exp_f32 v120, v120
    v_exp_f32 v121, v121
    v_exp_f32 v122, v122
    v_exp_f32 v123, v123
    v_exp_f32 v124, v124
    v_exp_f32 v125, v125
    v_exp_f32 v126, v126
    v_exp_f32 v127, v127
    v_smfmac_f32_32x32x32_bf16 v[48:63], a[168:171], v[112:119], v7
    s_nop 0
    v_smfmac_f32_32x32x32_bf16 v[48:63], a[172:175], v[120:127], v7
    s_nop 7
    v_mfma_f32_32x32x16_bf16 v[112:127], a[176:179], v[16:19], v[144:159]
    v_mfma_f32_32x32x16_bf16 v[112:127], a[180:183], v[20:23], v[112:127]
    s_nop 11
    v_exp_f32 v112, v112
    v_exp_f32 v113, v113
    v_exp_f32 v114, v114
    v_exp_f32 v115, v115
    v_exp_f32 v116, v116
    v_exp_f32 v117, v117
    v_exp_f32 v118, v118
    v_exp_f32 v119, v119
    v_exp_f32 v120, v120
    v_exp_f32 v121, v121
    v_exp_f32 v122, v122
    v_exp_f32 v123, v123
    v_exp_f32 v124, v124
    v_exp_f32 v125, v125
    v_exp_f32 v126, v126
    v_exp_f32 v127, v127
    v_smfmac_f32_32x32x32_bf16 v[48:63], a[184:187], v[112:119], v7
    s_nop 0
    v_smfmac_f32_32x32x32_bf16 v[48:63], a[188:191], v[120:127], v7
    s_nop 7
    v_mfma_f32_32x32x16_bf16 v[112:127], a[192:195], v[16:19], v[144:159]
    v_mfma_f32_32x32x16_bf16 v[112:127], a[196:199], v[20:23], v[112:127]
    s_nop 11
    v_exp_f32 v112, v112
    v_exp_f32 v113, v113
    v_exp_f32 v114, v114
    v_exp_f32 v115, v115
    v_exp_f32 v116, v116
    v_exp_f32 v117, v117
    v_exp_f32 v118, v118
    v_exp_f32 v119, v119
    v_exp_f32 v120, v120
    v_exp_f32 v121, v121
    v_exp_f32 v122, v122
    v_exp_f32 v123, v123
    v_exp_f32 v124, v124
    v_exp_f32 v125, v125
    v_exp_f32 v126, v126
    v_exp_f32 v127, v127
    v_smfmac_f32_32x32x32_bf16 v[48:63], a[200:203], v[112:119], v7
    s_nop 0
    v_smfmac_f32_32x32x32_bf16 v[48:63], a[204:207], v[120:127], v7
    s_nop 7
    v_mfma_f32_32x32x16_bf16 v[112:127], a[208:211], v[16:19], v[144:159]
    v_mfma_f32_32x32x16_bf16 v[112:127], a[212:215], v[20:23], v[112:127]
    s_nop 11
    v_exp_f32 v112, v112
    v_exp_f32 v113, v113
    v_exp_f32 v114, v114
    v_exp_f32 v115, v115
    v_exp_f32 v116, v116
    v_exp_f32 v117, v117
    v_exp_f32 v118, v118
    v_exp_f32 v119, v119
    v_exp_f32 v120, v120
    v_exp_f32 v121, v121
    v_exp_f32 v122, v122
    v_exp_f32 v123, v123
    v_exp_f32 v124, v124
    v_exp_f32 v125, v125
    v_exp_f32 v126, v126
    v_exp_f32 v127, v127
    v_smfmac_f32_32x32x32_bf16 v[48:63], a[216:219], v[112:119], v7
    s_nop 0
    v_smfmac_f32_32x32x32_bf16 v[48:63], a[220:223], v[120:127], v7
    s_nop 7
    v_mfma_f32_32x32x16_bf16 v[112:127], a[224:227], v[16:19], v[144:159]
    v_mfma_f32_32x32x16_bf16 v[112:127], a[228:231], v[20:23], v[112:127]
    s_nop 11
    v_exp_f32 v112, v112
    v_exp_f32 v113, v113
    v_exp_f32 v114, v114
    v_exp_f32 v115, v115
    v_exp_f32 v116, v116
    v_exp_f32 v117, v117
    v_exp_f32 v118, v118
    v_exp_f32 v119, v119
    v_exp_f32 v120, v120
    v_exp_f32 v121, v121
    v_exp_f32 v122, v122
    v_exp_f32 v123, v123
    v_exp_f32 v124, v124
    v_exp_f32 v125, v125
    v_exp_f32 v126, v126
    v_exp_f32 v127, v127
    v_smfmac_f32_32x32x32_bf16 v[48:63], a[232:235], v[112:119], v7
    s_nop 0
    v_smfmac_f32_32x32x32_bf16 v[48:63], a[236:239], v[120:127], v7
    s_nop 7
    v_mfma_f32_32x32x16_bf16 v[112:127], a[240:243], v[16:19], v[144:159]
    v_mfma_f32_32x32x16_bf16 v[112:127], a[244:247], v[20:23], v[112:127]
    s_nop 11
    v_exp_f32 v112, v112
    v_exp_f32 v113, v113
    v_exp_f32 v114, v114
    v_exp_f32 v115, v115
    v_exp_f32 v116, v116
    v_exp_f32 v117, v117
    v_exp_f32 v118, v118
    v_exp_f32 v119, v119
    v_exp_f32 v120, v120
    v_exp_f32 v121, v121
    v_exp_f32 v122, v122
    v_exp_f32 v123, v123
    v_exp_f32 v124, v124
    v_exp_f32 v125, v125
    v_exp_f32 v126, v126
    v_exp_f32 v127, v127
    v_smfmac_f32_32x32x32_bf16 v[48:63], a[248:251], v[112:119], v7
    s_nop 0
    v_smfmac_f32_32x32x32_bf16 v[48:63], a[252:255], v[120:127], v7
    s_nop 7
    s_nop 7
    v_sub_f32 v144, 0, v129
    v_mov_b32 v64, 0
    v_sub_f32 v145, 0, v129
    v_mov_b32 v65, 0
    v_sub_f32 v146, 0, v129
    v_mov_b32 v66, 0
    v_sub_f32 v147, 0, v129
    v_mov_b32 v67, 0
    v_sub_f32 v148, 0, v129
    v_mov_b32 v68, 0
    v_sub_f32 v149, 0, v129
    v_mov_b32 v69, 0
    v_sub_f32 v150, 0, v129
    v_mov_b32 v70, 0
    v_sub_f32 v151, 0, v129
    v_mov_b32 v71, 0
    v_sub_f32 v152, 0, v129
    v_mov_b32 v72, 0
    v_sub_f32 v153, 0, v129
    v_mov_b32 v73, 0
    v_sub_f32 v154, 0, v129
    v_mov_b32 v74, 0
    v_sub_f32 v155, 0, v129
    v_mov_b32 v75, 0
    v_sub_f32 v156, 0, v129
    v_mov_b32 v76, 0
    v_sub_f32 v157, 0, v129
    v_mov_b32 v77, 0
    v_sub_f32 v158, 0, v129
    v_mov_b32 v78, 0
    v_sub_f32 v159, 0, v129
    v_mov_b32 v79, 0
    s_nop 0
    v_mfma_f32_32x32x16_bf16 v[112:127], a[0:3], v[24:27], v[144:159]
    v_mfma_f32_32x32x16_bf16 v[112:127], a[4:7], v[28:31], v[112:127]
    s_nop 11
    v_exp_f32 v112, v112
    v_exp_f32 v113, v113
    v_exp_f32 v114, v114
    v_exp_f32 v115, v115
    v_exp_f32 v116, v116
    v_exp_f32 v117, v117
    v_exp_f32 v118, v118
    v_exp_f32 v119, v119
    v_exp_f32 v120, v120
    v_exp_f32 v121, v121
    v_exp_f32 v122, v122
    v_exp_f32 v123, v123
    v_exp_f32 v124, v124
    v_exp_f32 v125, v125
    v_exp_f32 v126, v126
    v_exp_f32 v127, v127
    v_smfmac_f32_32x32x32_bf16 v[64:79], a[8:11], v[112:119], v7
    s_nop 0
    v_smfmac_f32_32x32x32_bf16 v[64:79], a[12:15], v[120:127], v7
    s_nop 7
    v_mfma_f32_32x32x16_bf16 v[112:127], a[16:19], v[24:27], v[144:159]
    v_mfma_f32_32x32x16_bf16 v[112:127], a[20:23], v[28:31], v[112:127]
    s_nop 11
    v_exp_f32 v112, v112
    v_exp_f32 v113, v113
    v_exp_f32 v114, v114
    v_exp_f32 v115, v115
    v_exp_f32 v116, v116
    v_exp_f32 v117, v117
    v_exp_f32 v118, v118
    v_exp_f32 v119, v119
    v_exp_f32 v120, v120
    v_exp_f32 v121, v121
    v_exp_f32 v122, v122
    v_exp_f32 v123, v123
    v_exp_f32 v124, v124
    v_exp_f32 v125, v125
    v_exp_f32 v126, v126
    v_exp_f32 v127, v127
    v_smfmac_f32_32x32x32_bf16 v[64:79], a[24:27], v[112:119], v7
    s_nop 0
    v_smfmac_f32_32x32x32_bf16 v[64:79], a[28:31], v[120:127], v7
    s_nop 7
    v_mfma_f32_32x32x16_bf16 v[112:127], a[32:35], v[24:27], v[144:159]
    v_mfma_f32_32x32x16_bf16 v[112:127], a[36:39], v[28:31], v[112:127]
    s_nop 11
    v_exp_f32 v112, v112
    v_exp_f32 v113, v113
    v_exp_f32 v114, v114
    v_exp_f32 v115, v115
    v_exp_f32 v116, v116
    v_exp_f32 v117, v117
    v_exp_f32 v118, v118
    v_exp_f32 v119, v119
    v_exp_f32 v120, v120
    v_exp_f32 v121, v121
    v_exp_f32 v122, v122
    v_exp_f32 v123, v123
    v_exp_f32 v124, v124
    v_exp_f32 v125, v125
    v_exp_f32 v126, v126
    v_exp_f32 v127, v127
    v_smfmac_f32_32x32x32_bf16 v[64:79], a[40:43], v[112:119], v7
    s_nop 0
    v_smfmac_f32_32x32x32_bf16 v[64:79], a[44:47], v[120:127], v7
    s_nop 7
    v_mfma_f32_32x32x16_bf16 v[112:127], a[48:51], v[24:27], v[144:159]
    v_mfma_f32_32x32x16_bf16 v[112:127], a[52:55], v[28:31], v[112:127]
    s_nop 11
    v_exp_f32 v112, v112
    v_exp_f32 v113, v113
    v_exp_f32 v114, v114
    v_exp_f32 v115, v115
    v_exp_f32 v116, v116
    v_exp_f32 v117, v117
    v_exp_f32 v118, v118
    v_exp_f32 v119, v119
    v_exp_f32 v120, v120
    v_exp_f32 v121, v121
    v_exp_f32 v122, v122
    v_exp_f32 v123, v123
    v_exp_f32 v124, v124
    v_exp_f32 v125, v125
    v_exp_f32 v126, v126
    v_exp_f32 v127, v127
    v_smfmac_f32_32x32x32_bf16 v[64:79], a[56:59], v[112:119], v7
    s_nop 0
    v_smfmac_f32_32x32x32_bf16 v[64:79], a[60:63], v[120:127], v7
    s_nop 7
    v_mfma_f32_32x32x16_bf16 v[112:127], a[64:67], v[24:27], v[144:159]
    v_mfma_f32_32x32x16_bf16 v[112:127], a[68:71], v[28:31], v[112:127]
    s_nop 11
    v_exp_f32 v112, v112
    v_exp_f32 v113, v113
    v_exp_f32 v114, v114
    v_exp_f32 v115, v115
    v_exp_f32 v116, v116
    v_exp_f32 v117, v117
    v_exp_f32 v118, v118
    v_exp_f32 v119, v119
    v_exp_f32 v120, v120
    v_exp_f32 v121, v121
    v_exp_f32 v122, v122
    v_exp_f32 v123, v123
    v_exp_f32 v124, v124
    v_exp_f32 v125, v125
    v_exp_f32 v126, v126
    v_exp_f32 v127, v127
    v_smfmac_f32_32x32x32_bf16 v[64:79], a[72:75], v[112:119], v7
    s_nop 0
    v_smfmac_f32_32x32x32_bf16 v[64:79], a[76:79], v[120:127], v7
    s_nop 7
    v_mfma_f32_32x32x16_bf16 v[112:127], a[80:83], v[24:27], v[144:159]
    v_mfma_f32_32x32x16_bf16 v[112:127], a[84:87], v[28:31], v[112:127]
    s_nop 11
    v_exp_f32 v112, v112
    v_exp_f32 v113, v113
    v_exp_f32 v114, v114
    v_exp_f32 v115, v115
    v_exp_f32 v116, v116
    v_exp_f32 v117, v117
    v_exp_f32 v118, v118
    v_exp_f32 v119, v119
    v_exp_f32 v120, v120
    v_exp_f32 v121, v121
    v_exp_f32 v122, v122
    v_exp_f32 v123, v123
    v_exp_f32 v124, v124
    v_exp_f32 v125, v125
    v_exp_f32 v126, v126
    v_exp_f32 v127, v127
    v_smfmac_f32_32x32x32_bf16 v[64:79], a[88:91], v[112:119], v7
    s_nop 0
    v_smfmac_f32_32x32x32_bf16 v[64:79], a[92:95], v[120:127], v7
    s_nop 7
    v_mfma_f32_32x32x16_bf16 v[112:127], a[96:99], v[24:27], v[144:159]
    v_mfma_f32_32x32x16_bf16 v[112:127], a[100:103], v[28:31], v[112:127]
    s_nop 11
    v_exp_f32 v112, v112
    v_exp_f32 v113, v113
    v_exp_f32 v114, v114
    v_exp_f32 v115, v115
    v_exp_f32 v116, v116
    v_exp_f32 v117, v117
    v_exp_f32 v118, v118
    v_exp_f32 v119, v119
    v_exp_f32 v120, v120
    v_exp_f32 v121, v121
    v_exp_f32 v122, v122
    v_exp_f32 v123, v123
    v_exp_f32 v124, v124
    v_exp_f32 v125, v125
    v_exp_f32 v126, v126
    v_exp_f32 v127, v127
    v_smfmac_f32_32x32x32_bf16 v[64:79], a[104:107], v[112:119], v7
    s_nop 0
    v_smfmac_f32_32x32x32_bf16 v[64:79], a[108:111], v[120:127], v7
    s_nop 7
    v_mfma_f32_32x32x16_bf16 v[112:127], a[112:115], v[24:27], v[144:159]
    v_mfma_f32_32x32x16_bf16 v[112:127], a[116:119], v[28:31], v[112:127]
    s_nop 11
    v_exp_f32 v112, v112
    v_exp_f32 v113, v113
    v_exp_f32 v114, v114
    v_exp_f32 v115, v115
    v_exp_f32 v116, v116
    v_exp_f32 v117, v117
    v_exp_f32 v118, v118
    v_exp_f32 v119, v119
    v_exp_f32 v120, v120
    v_exp_f32 v121, v121
    v_exp_f32 v122, v122
    v_exp_f32 v123, v123
    v_exp_f32 v124, v124
    v_exp_f32 v125, v125
    v_exp_f32 v126, v126
    v_exp_f32 v127, v127
    v_smfmac_f32_32x32x32_bf16 v[64:79], a[120:123], v[112:119], v7
    s_nop 0
    v_smfmac_f32_32x32x32_bf16 v[64:79], a[124:127], v[120:127], v7
    s_nop 7
    v_mfma_f32_32x32x16_bf16 v[112:127], a[128:131], v[24:27], v[144:159]
    v_mfma_f32_32x32x16_bf16 v[112:127], a[132:135], v[28:31], v[112:127]
    s_nop 11
    v_exp_f32 v112, v112
    v_exp_f32 v113, v113
    v_exp_f32 v114, v114
    v_exp_f32 v115, v115
    v_exp_f32 v116, v116
    v_exp_f32 v117, v117
    v_exp_f32 v118, v118
    v_exp_f32 v119, v119
    v_exp_f32 v120, v120
    v_exp_f32 v121, v121
    v_exp_f32 v122, v122
    v_exp_f32 v123, v123
    v_exp_f32 v124, v124
    v_exp_f32 v125, v125
    v_exp_f32 v126, v126
    v_exp_f32 v127, v127
    v_smfmac_f32_32x32x32_bf16 v[64:79], a[136:139], v[112:119], v7
    s_nop 0
    v_smfmac_f32_32x32x32_bf16 v[64:79], a[140:143], v[120:127], v7
    s_nop 7
    v_mfma_f32_32x32x16_bf16 v[112:127], a[144:147], v[24:27], v[144:159]
    v_mfma_f32_32x32x16_bf16 v[112:127], a[148:151], v[28:31], v[112:127]
    s_nop 11
    v_exp_f32 v112, v112
    v_exp_f32 v113, v113
    v_exp_f32 v114, v114
    v_exp_f32 v115, v115
    v_exp_f32 v116, v116
    v_exp_f32 v117, v117
    v_exp_f32 v118, v118
    v_exp_f32 v119, v119
    v_exp_f32 v120, v120
    v_exp_f32 v121, v121
    v_exp_f32 v122, v122
    v_exp_f32 v123, v123
    v_exp_f32 v124, v124
    v_exp_f32 v125, v125
    v_exp_f32 v126, v126
    v_exp_f32 v127, v127
    v_smfmac_f32_32x32x32_bf16 v[64:79], a[152:155], v[112:119], v7
    s_nop 0
    v_smfmac_f32_32x32x32_bf16 v[64:79], a[156:159], v[120:127], v7
    s_nop 7
    v_mfma_f32_32x32x16_bf16 v[112:127], a[160:163], v[24:27], v[144:159]
    v_mfma_f32_32x32x16_bf16 v[112:127], a[164:167], v[28:31], v[112:127]
    s_nop 11
    v_exp_f32 v112, v112
    v_exp_f32 v113, v113
    v_exp_f32 v114, v114
    v_exp_f32 v115, v115
    v_exp_f32 v116, v116
    v_exp_f32 v117, v117
    v_exp_f32 v118, v118
    v_exp_f32 v119, v119
    v_exp_f32 v120, v120
    v_exp_f32 v121, v121
    v_exp_f32 v122, v122
    v_exp_f32 v123, v123
    v_exp_f32 v124, v124
    v_exp_f32 v125, v125
    v_exp_f32 v126, v126
    v_exp_f32 v127, v127
    v_smfmac_f32_32x32x32_bf16 v[64:79], a[168:171], v[112:119], v7
    s_nop 0
    v_smfmac_f32_32x32x32_bf16 v[64:79], a[172:175], v[120:127], v7
    s_nop 7
    v_mfma_f32_32x32x16_bf16 v[112:127], a[176:179], v[24:27], v[144:159]
    v_mfma_f32_32x32x16_bf16 v[112:127], a[180:183], v[28:31], v[112:127]
    s_nop 11
    v_exp_f32 v112, v112
    v_exp_f32 v113, v113
    v_exp_f32 v114, v114
    v_exp_f32 v115, v115
    v_exp_f32 v116, v116
    v_exp_f32 v117, v117
    v_exp_f32 v118, v118
    v_exp_f32 v119, v119
    v_exp_f32 v120, v120
    v_exp_f32 v121, v121
    v_exp_f32 v122, v122
    v_exp_f32 v123, v123
    v_exp_f32 v124, v124
    v_exp_f32 v125, v125
    v_exp_f32 v126, v126
    v_exp_f32 v127, v127
    v_smfmac_f32_32x32x32_bf16 v[64:79], a[184:187], v[112:119], v7
    s_nop 0
    v_smfmac_f32_32x32x32_bf16 v[64:79], a[188:191], v[120:127], v7
    s_nop 7
    v_mfma_f32_32x32x16_bf16 v[112:127], a[192:195], v[24:27], v[144:159]
    v_mfma_f32_32x32x16_bf16 v[112:127], a[196:199], v[28:31], v[112:127]
    s_nop 11
    v_exp_f32 v112, v112
    v_exp_f32 v113, v113
    v_exp_f32 v114, v114
    v_exp_f32 v115, v115
    v_exp_f32 v116, v116
    v_exp_f32 v117, v117
    v_exp_f32 v118, v118
    v_exp_f32 v119, v119
    v_exp_f32 v120, v120
    v_exp_f32 v121, v121
    v_exp_f32 v122, v122
    v_exp_f32 v123, v123
    v_exp_f32 v124, v124
    v_exp_f32 v125, v125
    v_exp_f32 v126, v126
    v_exp_f32 v127, v127
    v_smfmac_f32_32x32x32_bf16 v[64:79], a[200:203], v[112:119], v7
    s_nop 0
    v_smfmac_f32_32x32x32_bf16 v[64:79], a[204:207], v[120:127], v7
    s_nop 7
    v_mfma_f32_32x32x16_bf16 v[112:127], a[208:211], v[24:27], v[144:159]
    v_mfma_f32_32x32x16_bf16 v[112:127], a[212:215], v[28:31], v[112:127]
    s_nop 11
    v_exp_f32 v112, v112
    v_exp_f32 v113, v113
    v_exp_f32 v114, v114
    v_exp_f32 v115, v115
    v_exp_f32 v116, v116
    v_exp_f32 v117, v117
    v_exp_f32 v118, v118
    v_exp_f32 v119, v119
    v_exp_f32 v120, v120
    v_exp_f32 v121, v121
    v_exp_f32 v122, v122
    v_exp_f32 v123, v123
    v_exp_f32 v124, v124
    v_exp_f32 v125, v125
    v_exp_f32 v126, v126
    v_exp_f32 v127, v127
    v_smfmac_f32_32x32x32_bf16 v[64:79], a[216:219], v[112:119], v7
    s_nop 0
    v_smfmac_f32_32x32x32_bf16 v[64:79], a[220:223], v[120:127], v7
    s_nop 7
    v_mfma_f32_32x32x16_bf16 v[112:127], a[224:227], v[24:27], v[144:159]
    v_mfma_f32_32x32x16_bf16 v[112:127], a[228:231], v[28:31], v[112:127]
    s_nop 11
    v_exp_f32 v112, v112
    v_exp_f32 v113, v113
    v_exp_f32 v114, v114
    v_exp_f32 v115, v115
    v_exp_f32 v116, v116
    v_exp_f32 v117, v117
    v_exp_f32 v118, v118
    v_exp_f32 v119, v119
    v_exp_f32 v120, v120
    v_exp_f32 v121, v121
    v_exp_f32 v122, v122
    v_exp_f32 v123, v123
    v_exp_f32 v124, v124
    v_exp_f32 v125, v125
    v_exp_f32 v126, v126
    v_exp_f32 v127, v127
    v_smfmac_f32_32x32x32_bf16 v[64:79], a[232:235], v[112:119], v7
    s_nop 0
    v_smfmac_f32_32x32x32_bf16 v[64:79], a[236:239], v[120:127], v7
    s_nop 7
    v_mfma_f32_32x32x16_bf16 v[112:127], a[240:243], v[24:27], v[144:159]
    v_mfma_f32_32x32x16_bf16 v[112:127], a[244:247], v[28:31], v[112:127]
    s_nop 11
    v_exp_f32 v112, v112
    v_exp_f32 v113, v113
    v_exp_f32 v114, v114
    v_exp_f32 v115, v115
    v_exp_f32 v116, v116
    v_exp_f32 v117, v117
    v_exp_f32 v118, v118
    v_exp_f32 v119, v119
    v_exp_f32 v120, v120
    v_exp_f32 v121, v121
    v_exp_f32 v122, v122
    v_exp_f32 v123, v123
    v_exp_f32 v124, v124
    v_exp_f32 v125, v125
    v_exp_f32 v126, v126
    v_exp_f32 v127, v127
    v_smfmac_f32_32x32x32_bf16 v[64:79], a[248:251], v[112:119], v7
    s_nop 0
    v_smfmac_f32_32x32x32_bf16 v[64:79], a[252:255], v[120:127], v7
    s_nop 7
    s_nop 7
    v_sub_f32 v144, 0, v130
    v_mov_b32 v80, 0
    v_sub_f32 v145, 0, v130
    v_mov_b32 v81, 0
    v_sub_f32 v146, 0, v130
    v_mov_b32 v82, 0
    v_sub_f32 v147, 0, v130
    v_mov_b32 v83, 0
    v_sub_f32 v148, 0, v130
    v_mov_b32 v84, 0
    v_sub_f32 v149, 0, v130
    v_mov_b32 v85, 0
    v_sub_f32 v150, 0, v130
    v_mov_b32 v86, 0
    v_sub_f32 v151, 0, v130
    v_mov_b32 v87, 0
    v_sub_f32 v152, 0, v130
    v_mov_b32 v88, 0
    v_sub_f32 v153, 0, v130
    v_mov_b32 v89, 0
    v_sub_f32 v154, 0, v130
    v_mov_b32 v90, 0
    v_sub_f32 v155, 0, v130
    v_mov_b32 v91, 0
    v_sub_f32 v156, 0, v130
    v_mov_b32 v92, 0
    v_sub_f32 v157, 0, v130
    v_mov_b32 v93, 0
    v_sub_f32 v158, 0, v130
    v_mov_b32 v94, 0
    v_sub_f32 v159, 0, v130
    v_mov_b32 v95, 0
    s_nop 0
    v_mfma_f32_32x32x16_bf16 v[112:127], a[0:3], v[32:35], v[144:159]
    v_mfma_f32_32x32x16_bf16 v[112:127], a[4:7], v[36:39], v[112:127]
    s_nop 11
    v_exp_f32 v112, v112
    v_exp_f32 v113, v113
    v_exp_f32 v114, v114
    v_exp_f32 v115, v115
    v_exp_f32 v116, v116
    v_exp_f32 v117, v117
    v_exp_f32 v118, v118
    v_exp_f32 v119, v119
    v_exp_f32 v120, v120
    v_exp_f32 v121, v121
    v_exp_f32 v122, v122
    v_exp_f32 v123, v123
    v_exp_f32 v124, v124
    v_exp_f32 v125, v125
    v_exp_f32 v126, v126
    v_exp_f32 v127, v127
    v_smfmac_f32_32x32x32_bf16 v[80:95], a[8:11], v[112:119], v7
    s_nop 0
    v_smfmac_f32_32x32x32_bf16 v[80:95], a[12:15], v[120:127], v7
    s_nop 7
    v_mfma_f32_32x32x16_bf16 v[112:127], a[16:19], v[32:35], v[144:159]
    v_mfma_f32_32x32x16_bf16 v[112:127], a[20:23], v[36:39], v[112:127]
    s_nop 11
    v_exp_f32 v112, v112
    v_exp_f32 v113, v113
    v_exp_f32 v114, v114
    v_exp_f32 v115, v115
    v_exp_f32 v116, v116
    v_exp_f32 v117, v117
    v_exp_f32 v118, v118
    v_exp_f32 v119, v119
    v_exp_f32 v120, v120
    v_exp_f32 v121, v121
    v_exp_f32 v122, v122
    v_exp_f32 v123, v123
    v_exp_f32 v124, v124
    v_exp_f32 v125, v125
    v_exp_f32 v126, v126
    v_exp_f32 v127, v127
    v_smfmac_f32_32x32x32_bf16 v[80:95], a[24:27], v[112:119], v7
    s_nop 0
    v_smfmac_f32_32x32x32_bf16 v[80:95], a[28:31], v[120:127], v7
    s_nop 7
    v_mfma_f32_32x32x16_bf16 v[112:127], a[32:35], v[32:35], v[144:159]
    v_mfma_f32_32x32x16_bf16 v[112:127], a[36:39], v[36:39], v[112:127]
    s_nop 11
    v_exp_f32 v112, v112
    v_exp_f32 v113, v113
    v_exp_f32 v114, v114
    v_exp_f32 v115, v115
    v_exp_f32 v116, v116
    v_exp_f32 v117, v117
    v_exp_f32 v118, v118
    v_exp_f32 v119, v119
    v_exp_f32 v120, v120
    v_exp_f32 v121, v121
    v_exp_f32 v122, v122
    v_exp_f32 v123, v123
    v_exp_f32 v124, v124
    v_exp_f32 v125, v125
    v_exp_f32 v126, v126
    v_exp_f32 v127, v127
    v_smfmac_f32_32x32x32_bf16 v[80:95], a[40:43], v[112:119], v7
    s_nop 0
    v_smfmac_f32_32x32x32_bf16 v[80:95], a[44:47], v[120:127], v7
    s_nop 7
    v_mfma_f32_32x32x16_bf16 v[112:127], a[48:51], v[32:35], v[144:159]
    v_mfma_f32_32x32x16_bf16 v[112:127], a[52:55], v[36:39], v[112:127]
    s_nop 11
    v_exp_f32 v112, v112
    v_exp_f32 v113, v113
    v_exp_f32 v114, v114
    v_exp_f32 v115, v115
    v_exp_f32 v116, v116
    v_exp_f32 v117, v117
    v_exp_f32 v118, v118
    v_exp_f32 v119, v119
    v_exp_f32 v120, v120
    v_exp_f32 v121, v121
    v_exp_f32 v122, v122
    v_exp_f32 v123, v123
    v_exp_f32 v124, v124
    v_exp_f32 v125, v125
    v_exp_f32 v126, v126
    v_exp_f32 v127, v127
    v_smfmac_f32_32x32x32_bf16 v[80:95], a[56:59], v[112:119], v7
    s_nop 0
    v_smfmac_f32_32x32x32_bf16 v[80:95], a[60:63], v[120:127], v7
    s_nop 7
    v_mfma_f32_32x32x16_bf16 v[112:127], a[64:67], v[32:35], v[144:159]
    v_mfma_f32_32x32x16_bf16 v[112:127], a[68:71], v[36:39], v[112:127]
    s_nop 11
    v_exp_f32 v112, v112
    v_exp_f32 v113, v113
    v_exp_f32 v114, v114
    v_exp_f32 v115, v115
    v_exp_f32 v116, v116
    v_exp_f32 v117, v117
    v_exp_f32 v118, v118
    v_exp_f32 v119, v119
    v_exp_f32 v120, v120
    v_exp_f32 v121, v121
    v_exp_f32 v122, v122
    v_exp_f32 v123, v123
    v_exp_f32 v124, v124
    v_exp_f32 v125, v125
    v_exp_f32 v126, v126
    v_exp_f32 v127, v127
    v_smfmac_f32_32x32x32_bf16 v[80:95], a[72:75], v[112:119], v7
    s_nop 0
    v_smfmac_f32_32x32x32_bf16 v[80:95], a[76:79], v[120:127], v7
    s_nop 7
    v_mfma_f32_32x32x16_bf16 v[112:127], a[80:83], v[32:35], v[144:159]
    v_mfma_f32_32x32x16_bf16 v[112:127], a[84:87], v[36:39], v[112:127]
    s_nop 11
    v_exp_f32 v112, v112
    v_exp_f32 v113, v113
    v_exp_f32 v114, v114
    v_exp_f32 v115, v115
    v_exp_f32 v116, v116
    v_exp_f32 v117, v117
    v_exp_f32 v118, v118
    v_exp_f32 v119, v119
    v_exp_f32 v120, v120
    v_exp_f32 v121, v121
    v_exp_f32 v122, v122
    v_exp_f32 v123, v123
    v_exp_f32 v124, v124
    v_exp_f32 v125, v125
    v_exp_f32 v126, v126
    v_exp_f32 v127, v127
    v_smfmac_f32_32x32x32_bf16 v[80:95], a[88:91], v[112:119], v7
    s_nop 0
    v_smfmac_f32_32x32x32_bf16 v[80:95], a[92:95], v[120:127], v7
    s_nop 7
    v_mfma_f32_32x32x16_bf16 v[112:127], a[96:99], v[32:35], v[144:159]
    v_mfma_f32_32x32x16_bf16 v[112:127], a[100:103], v[36:39], v[112:127]
    s_nop 11
    v_exp_f32 v112, v112
    v_exp_f32 v113, v113
    v_exp_f32 v114, v114
    v_exp_f32 v115, v115
    v_exp_f32 v116, v116
    v_exp_f32 v117, v117
    v_exp_f32 v118, v118
    v_exp_f32 v119, v119
    v_exp_f32 v120, v120
    v_exp_f32 v121, v121
    v_exp_f32 v122, v122
    v_exp_f32 v123, v123
    v_exp_f32 v124, v124
    v_exp_f32 v125, v125
    v_exp_f32 v126, v126
    v_exp_f32 v127, v127
    v_smfmac_f32_32x32x32_bf16 v[80:95], a[104:107], v[112:119], v7
    s_nop 0
    v_smfmac_f32_32x32x32_bf16 v[80:95], a[108:111], v[120:127], v7
    s_nop 7
    v_mfma_f32_32x32x16_bf16 v[112:127], a[112:115], v[32:35], v[144:159]
    v_mfma_f32_32x32x16_bf16 v[112:127], a[116:119], v[36:39], v[112:127]
    s_nop 11
    v_exp_f32 v112, v112
    v_exp_f32 v113, v113
    v_exp_f32 v114, v114
    v_exp_f32 v115, v115
    v_exp_f32 v116, v116
    v_exp_f32 v117, v117
    v_exp_f32 v118, v118
    v_exp_f32 v119, v119
    v_exp_f32 v120, v120
    v_exp_f32 v121, v121
    v_exp_f32 v122, v122
    v_exp_f32 v123, v123
    v_exp_f32 v124, v124
    v_exp_f32 v125, v125
    v_exp_f32 v126, v126
    v_exp_f32 v127, v127
    v_smfmac_f32_32x32x32_bf16 v[80:95], a[120:123], v[112:119], v7
    s_nop 0
    v_smfmac_f32_32x32x32_bf16 v[80:95], a[124:127], v[120:127], v7
    s_nop 7
    v_mfma_f32_32x32x16_bf16 v[112:127], a[128:131], v[32:35], v[144:159]
    v_mfma_f32_32x32x16_bf16 v[112:127], a[132:135], v[36:39], v[112:127]
    s_nop 11
    v_exp_f32 v112, v112
    v_exp_f32 v113, v113
    v_exp_f32 v114, v114
    v_exp_f32 v115, v115
    v_exp_f32 v116, v116
    v_exp_f32 v117, v117
    v_exp_f32 v118, v118
    v_exp_f32 v119, v119
    v_exp_f32 v120, v120
    v_exp_f32 v121, v121
    v_exp_f32 v122, v122
    v_exp_f32 v123, v123
    v_exp_f32 v124, v124
    v_exp_f32 v125, v125
    v_exp_f32 v126, v126
    v_exp_f32 v127, v127
    v_smfmac_f32_32x32x32_bf16 v[80:95], a[136:139], v[112:119], v7
    s_nop 0
    v_smfmac_f32_32x32x32_bf16 v[80:95], a[140:143], v[120:127], v7
    s_nop 7
    v_mfma_f32_32x32x16_bf16 v[112:127], a[144:147], v[32:35], v[144:159]
    v_mfma_f32_32x32x16_bf16 v[112:127], a[148:151], v[36:39], v[112:127]
    s_nop 11
    v_exp_f32 v112, v112
    v_exp_f32 v113, v113
    v_exp_f32 v114, v114
    v_exp_f32 v115, v115
    v_exp_f32 v116, v116
    v_exp_f32 v117, v117
    v_exp_f32 v118, v118
    v_exp_f32 v119, v119
    v_exp_f32 v120, v120
    v_exp_f32 v121, v121
    v_exp_f32 v122, v122
    v_exp_f32 v123, v123
    v_exp_f32 v124, v124
    v_exp_f32 v125, v125
    v_exp_f32 v126, v126
    v_exp_f32 v127, v127
    v_smfmac_f32_32x32x32_bf16 v[80:95], a[152:155], v[112:119], v7
    s_nop 0
    v_smfmac_f32_32x32x32_bf16 v[80:95], a[156:159], v[120:127], v7
    s_nop 7
    v_mfma_f32_32x32x16_bf16 v[112:127], a[160:163], v[32:35], v[144:159]
    v_mfma_f32_32x32x16_bf16 v[112:127], a[164:167], v[36:39], v[112:127]
    s_nop 11
    v_exp_f32 v112, v112
    v_exp_f32 v113, v113
    v_exp_f32 v114, v114
    v_exp_f32 v115, v115
    v_exp_f32 v116, v116
    v_exp_f32 v117, v117
    v_exp_f32 v118, v118
    v_exp_f32 v119, v119
    v_exp_f32 v120, v120
    v_exp_f32 v121, v121
    v_exp_f32 v122, v122
    v_exp_f32 v123, v123
    v_exp_f32 v124, v124
    v_exp_f32 v125, v125
    v_exp_f32 v126, v126
    v_exp_f32 v127, v127
    v_smfmac_f32_32x32x32_bf16 v[80:95], a[168:171], v[112:119], v7
    s_nop 0
    v_smfmac_f32_32x32x32_bf16 v[80:95], a[172:175], v[120:127], v7
    s_nop 7
    v_mfma_f32_32x32x16_bf16 v[112:127], a[176:179], v[32:35], v[144:159]
    v_mfma_f32_32x32x16_bf16 v[112:127], a[180:183], v[36:39], v[112:127]
    s_nop 11
    v_exp_f32 v112, v112
    v_exp_f32 v113, v113
    v_exp_f32 v114, v114
    v_exp_f32 v115, v115
    v_exp_f32 v116, v116
    v_exp_f32 v117, v117
    v_exp_f32 v118, v118
    v_exp_f32 v119, v119
    v_exp_f32 v120, v120
    v_exp_f32 v121, v121
    v_exp_f32 v122, v122
    v_exp_f32 v123, v123
    v_exp_f32 v124, v124
    v_exp_f32 v125, v125
    v_exp_f32 v126, v126
    v_exp_f32 v127, v127
    v_smfmac_f32_32x32x32_bf16 v[80:95], a[184:187], v[112:119], v7
    s_nop 0
    v_smfmac_f32_32x32x32_bf16 v[80:95], a[188:191], v[120:127], v7
    s_nop 7
    v_mfma_f32_32x32x16_bf16 v[112:127], a[192:195], v[32:35], v[144:159]
    v_mfma_f32_32x32x16_bf16 v[112:127], a[196:199], v[36:39], v[112:127]
    s_nop 11
    v_exp_f32 v112, v112
    v_exp_f32 v113, v113
    v_exp_f32 v114, v114
    v_exp_f32 v115, v115
    v_exp_f32 v116, v116
    v_exp_f32 v117, v117
    v_exp_f32 v118, v118
    v_exp_f32 v119, v119
    v_exp_f32 v120, v120
    v_exp_f32 v121, v121
    v_exp_f32 v122, v122
    v_exp_f32 v123, v123
    v_exp_f32 v124, v124
    v_exp_f32 v125, v125
    v_exp_f32 v126, v126
    v_exp_f32 v127, v127
    v_smfmac_f32_32x32x32_bf16 v[80:95], a[200:203], v[112:119], v7
    s_nop 0
    v_smfmac_f32_32x32x32_bf16 v[80:95], a[204:207], v[120:127], v7
    s_nop 7
    v_mfma_f32_32x32x16_bf16 v[112:127], a[208:211], v[32:35], v[144:159]
    v_mfma_f32_32x32x16_bf16 v[112:127], a[212:215], v[36:39], v[112:127]
    s_nop 11
    v_exp_f32 v112, v112
    v_exp_f32 v113, v113
    v_exp_f32 v114, v114
    v_exp_f32 v115, v115
    v_exp_f32 v116, v116
    v_exp_f32 v117, v117
    v_exp_f32 v118, v118
    v_exp_f32 v119, v119
    v_exp_f32 v120, v120
    v_exp_f32 v121, v121
    v_exp_f32 v122, v122
    v_exp_f32 v123, v123
    v_exp_f32 v124, v124
    v_exp_f32 v125, v125
    v_exp_f32 v126, v126
    v_exp_f32 v127, v127
    v_smfmac_f32_32x32x32_bf16 v[80:95], a[216:219], v[112:119], v7
    s_nop 0
    v_smfmac_f32_32x32x32_bf16 v[80:95], a[220:223], v[120:127], v7
    s_nop 7
    v_mfma_f32_32x32x16_bf16 v[112:127], a[224:227], v[32:35], v[144:159]
    v_mfma_f32_32x32x16_bf16 v[112:127], a[228:231], v[36:39], v[112:127]
    s_nop 11
    v_exp_f32 v112, v112
    v_exp_f32 v113, v113
    v_exp_f32 v114, v114
    v_exp_f32 v115, v115
    v_exp_f32 v116, v116
    v_exp_f32 v117, v117
    v_exp_f32 v118, v118
    v_exp_f32 v119, v119
    v_exp_f32 v120, v120
    v_exp_f32 v121, v121
    v_exp_f32 v122, v122
    v_exp_f32 v123, v123
    v_exp_f32 v124, v124
    v_exp_f32 v125, v125
    v_exp_f32 v126, v126
    v_exp_f32 v127, v127
    v_smfmac_f32_32x32x32_bf16 v[80:95], a[232:235], v[112:119], v7
    s_nop 0
    v_smfmac_f32_32x32x32_bf16 v[80:95], a[236:239], v[120:127], v7
    s_nop 7
    v_mfma_f32_32x32x16_bf16 v[112:127], a[240:243], v[32:35], v[144:159]
    v_mfma_f32_32x32x16_bf16 v[112:127], a[244:247], v[36:39], v[112:127]
    s_nop 11
    v_exp_f32 v112, v112
    v_exp_f32 v113, v113
    v_exp_f32 v114, v114
    v_exp_f32 v115, v115
    v_exp_f32 v116, v116
    v_exp_f32 v117, v117
    v_exp_f32 v118, v118
    v_exp_f32 v119, v119
    v_exp_f32 v120, v120
    v_exp_f32 v121, v121
    v_exp_f32 v122, v122
    v_exp_f32 v123, v123
    v_exp_f32 v124, v124
    v_exp_f32 v125, v125
    v_exp_f32 v126, v126
    v_exp_f32 v127, v127
    v_smfmac_f32_32x32x32_bf16 v[80:95], a[248:251], v[112:119], v7
    s_nop 0
    v_smfmac_f32_32x32x32_bf16 v[80:95], a[252:255], v[120:127], v7
    s_nop 7
    s_nop 7
    v_sub_f32 v144, 0, v131
    v_mov_b32 v96, 0
    v_sub_f32 v145, 0, v131
    v_mov_b32 v97, 0
    v_sub_f32 v146, 0, v131
    v_mov_b32 v98, 0
    v_sub_f32 v147, 0, v131
    v_mov_b32 v99, 0
    v_sub_f32 v148, 0, v131
    v_mov_b32 v100, 0
    v_sub_f32 v149, 0, v131
    v_mov_b32 v101, 0
    v_sub_f32 v150, 0, v131
    v_mov_b32 v102, 0
    v_sub_f32 v151, 0, v131
    v_mov_b32 v103, 0
    v_sub_f32 v152, 0, v131
    v_mov_b32 v104, 0
    v_sub_f32 v153, 0, v131
    v_mov_b32 v105, 0
    v_sub_f32 v154, 0, v131
    v_mov_b32 v106, 0
    v_sub_f32 v155, 0, v131
    v_mov_b32 v107, 0
    v_sub_f32 v156, 0, v131
    v_mov_b32 v108, 0
    v_sub_f32 v157, 0, v131
    v_mov_b32 v109, 0
    v_sub_f32 v158, 0, v131
    v_mov_b32 v110, 0
    v_sub_f32 v159, 0, v131
    v_mov_b32 v111, 0
    s_nop 0
    v_mfma_f32_32x32x16_bf16 v[112:127], a[0:3], v[40:43], v[144:159]
    v_mfma_f32_32x32x16_bf16 v[112:127], a[4:7], v[44:47], v[112:127]
    s_nop 11
    v_exp_f32 v112, v112
    v_exp_f32 v113, v113
    v_exp_f32 v114, v114
    v_exp_f32 v115, v115
    v_exp_f32 v116, v116
    v_exp_f32 v117, v117
    v_exp_f32 v118, v118
    v_exp_f32 v119, v119
    v_exp_f32 v120, v120
    v_exp_f32 v121, v121
    v_exp_f32 v122, v122
    v_exp_f32 v123, v123
    v_exp_f32 v124, v124
    v_exp_f32 v125, v125
    v_exp_f32 v126, v126
    v_exp_f32 v127, v127
    v_smfmac_f32_32x32x32_bf16 v[96:111], a[8:11], v[112:119], v7
    s_nop 0
    v_smfmac_f32_32x32x32_bf16 v[96:111], a[12:15], v[120:127], v7
    s_nop 7
    v_mfma_f32_32x32x16_bf16 v[112:127], a[16:19], v[40:43], v[144:159]
    v_mfma_f32_32x32x16_bf16 v[112:127], a[20:23], v[44:47], v[112:127]
    s_nop 11
    v_exp_f32 v112, v112
    v_exp_f32 v113, v113
    v_exp_f32 v114, v114
    v_exp_f32 v115, v115
    v_exp_f32 v116, v116
    v_exp_f32 v117, v117
    v_exp_f32 v118, v118
    v_exp_f32 v119, v119
    v_exp_f32 v120, v120
    v_exp_f32 v121, v121
    v_exp_f32 v122, v122
    v_exp_f32 v123, v123
    v_exp_f32 v124, v124
    v_exp_f32 v125, v125
    v_exp_f32 v126, v126
    v_exp_f32 v127, v127
    v_smfmac_f32_32x32x32_bf16 v[96:111], a[24:27], v[112:119], v7
    s_nop 0
    v_smfmac_f32_32x32x32_bf16 v[96:111], a[28:31], v[120:127], v7
    s_nop 7
    v_mfma_f32_32x32x16_bf16 v[112:127], a[32:35], v[40:43], v[144:159]
    v_mfma_f32_32x32x16_bf16 v[112:127], a[36:39], v[44:47], v[112:127]
    s_nop 11
    v_exp_f32 v112, v112
    v_exp_f32 v113, v113
    v_exp_f32 v114, v114
    v_exp_f32 v115, v115
    v_exp_f32 v116, v116
    v_exp_f32 v117, v117
    v_exp_f32 v118, v118
    v_exp_f32 v119, v119
    v_exp_f32 v120, v120
    v_exp_f32 v121, v121
    v_exp_f32 v122, v122
    v_exp_f32 v123, v123
    v_exp_f32 v124, v124
    v_exp_f32 v125, v125
    v_exp_f32 v126, v126
    v_exp_f32 v127, v127
    v_smfmac_f32_32x32x32_bf16 v[96:111], a[40:43], v[112:119], v7
    s_nop 0
    v_smfmac_f32_32x32x32_bf16 v[96:111], a[44:47], v[120:127], v7
    s_nop 7
    v_mfma_f32_32x32x16_bf16 v[112:127], a[48:51], v[40:43], v[144:159]
    v_mfma_f32_32x32x16_bf16 v[112:127], a[52:55], v[44:47], v[112:127]
    s_nop 11
    v_exp_f32 v112, v112
    v_exp_f32 v113, v113
    v_exp_f32 v114, v114
    v_exp_f32 v115, v115
    v_exp_f32 v116, v116
    v_exp_f32 v117, v117
    v_exp_f32 v118, v118
    v_exp_f32 v119, v119
    v_exp_f32 v120, v120
    v_exp_f32 v121, v121
    v_exp_f32 v122, v122
    v_exp_f32 v123, v123
    v_exp_f32 v124, v124
    v_exp_f32 v125, v125
    v_exp_f32 v126, v126
    v_exp_f32 v127, v127
    v_smfmac_f32_32x32x32_bf16 v[96:111], a[56:59], v[112:119], v7
    s_nop 0
    v_smfmac_f32_32x32x32_bf16 v[96:111], a[60:63], v[120:127], v7
    s_nop 7
    v_mfma_f32_32x32x16_bf16 v[112:127], a[64:67], v[40:43], v[144:159]
    v_mfma_f32_32x32x16_bf16 v[112:127], a[68:71], v[44:47], v[112:127]
    s_nop 11
    v_exp_f32 v112, v112
    v_exp_f32 v113, v113
    v_exp_f32 v114, v114
    v_exp_f32 v115, v115
    v_exp_f32 v116, v116
    v_exp_f32 v117, v117
    v_exp_f32 v118, v118
    v_exp_f32 v119, v119
    v_exp_f32 v120, v120
    v_exp_f32 v121, v121
    v_exp_f32 v122, v122
    v_exp_f32 v123, v123
    v_exp_f32 v124, v124
    v_exp_f32 v125, v125
    v_exp_f32 v126, v126
    v_exp_f32 v127, v127
    v_smfmac_f32_32x32x32_bf16 v[96:111], a[72:75], v[112:119], v7
    s_nop 0
    v_smfmac_f32_32x32x32_bf16 v[96:111], a[76:79], v[120:127], v7
    s_nop 7
    v_mfma_f32_32x32x16_bf16 v[112:127], a[80:83], v[40:43], v[144:159]
    v_mfma_f32_32x32x16_bf16 v[112:127], a[84:87], v[44:47], v[112:127]
    s_nop 11
    v_exp_f32 v112, v112
    v_exp_f32 v113, v113
    v_exp_f32 v114, v114
    v_exp_f32 v115, v115
    v_exp_f32 v116, v116
    v_exp_f32 v117, v117
    v_exp_f32 v118, v118
    v_exp_f32 v119, v119
    v_exp_f32 v120, v120
    v_exp_f32 v121, v121
    v_exp_f32 v122, v122
    v_exp_f32 v123, v123
    v_exp_f32 v124, v124
    v_exp_f32 v125, v125
    v_exp_f32 v126, v126
    v_exp_f32 v127, v127
    v_smfmac_f32_32x32x32_bf16 v[96:111], a[88:91], v[112:119], v7
    s_nop 0
    v_smfmac_f32_32x32x32_bf16 v[96:111], a[92:95], v[120:127], v7
    s_nop 7
    v_mfma_f32_32x32x16_bf16 v[112:127], a[96:99], v[40:43], v[144:159]
    v_mfma_f32_32x32x16_bf16 v[112:127], a[100:103], v[44:47], v[112:127]
    s_nop 11
    v_exp_f32 v112, v112
    v_exp_f32 v113, v113
    v_exp_f32 v114, v114
    v_exp_f32 v115, v115
    v_exp_f32 v116, v116
    v_exp_f32 v117, v117
    v_exp_f32 v118, v118
    v_exp_f32 v119, v119
    v_exp_f32 v120, v120
    v_exp_f32 v121, v121
    v_exp_f32 v122, v122
    v_exp_f32 v123, v123
    v_exp_f32 v124, v124
    v_exp_f32 v125, v125
    v_exp_f32 v126, v126
    v_exp_f32 v127, v127
    v_smfmac_f32_32x32x32_bf16 v[96:111], a[104:107], v[112:119], v7
    s_nop 0
    v_smfmac_f32_32x32x32_bf16 v[96:111], a[108:111], v[120:127], v7
    s_nop 7
    v_mfma_f32_32x32x16_bf16 v[112:127], a[112:115], v[40:43], v[144:159]
    v_mfma_f32_32x32x16_bf16 v[112:127], a[116:119], v[44:47], v[112:127]
    s_nop 11
    v_exp_f32 v112, v112
    v_exp_f32 v113, v113
    v_exp_f32 v114, v114
    v_exp_f32 v115, v115
    v_exp_f32 v116, v116
    v_exp_f32 v117, v117
    v_exp_f32 v118, v118
    v_exp_f32 v119, v119
    v_exp_f32 v120, v120
    v_exp_f32 v121, v121
    v_exp_f32 v122, v122
    v_exp_f32 v123, v123
    v_exp_f32 v124, v124
    v_exp_f32 v125, v125
    v_exp_f32 v126, v126
    v_exp_f32 v127, v127
    v_smfmac_f32_32x32x32_bf16 v[96:111], a[120:123], v[112:119], v7
    s_nop 0
    v_smfmac_f32_32x32x32_bf16 v[96:111], a[124:127], v[120:127], v7
    s_nop 7
    v_mfma_f32_32x32x16_bf16 v[112:127], a[128:131], v[40:43], v[144:159]
    v_mfma_f32_32x32x16_bf16 v[112:127], a[132:135], v[44:47], v[112:127]
    s_nop 11
    v_exp_f32 v112, v112
    v_exp_f32 v113, v113
    v_exp_f32 v114, v114
    v_exp_f32 v115, v115
    v_exp_f32 v116, v116
    v_exp_f32 v117, v117
    v_exp_f32 v118, v118
    v_exp_f32 v119, v119
    v_exp_f32 v120, v120
    v_exp_f32 v121, v121
    v_exp_f32 v122, v122
    v_exp_f32 v123, v123
    v_exp_f32 v124, v124
    v_exp_f32 v125, v125
    v_exp_f32 v126, v126
    v_exp_f32 v127, v127
    v_smfmac_f32_32x32x32_bf16 v[96:111], a[136:139], v[112:119], v7
    s_nop 0
    v_smfmac_f32_32x32x32_bf16 v[96:111], a[140:143], v[120:127], v7
    s_nop 7
    v_mfma_f32_32x32x16_bf16 v[112:127], a[144:147], v[40:43], v[144:159]
    v_mfma_f32_32x32x16_bf16 v[112:127], a[148:151], v[44:47], v[112:127]
    s_nop 11
    v_exp_f32 v112, v112
    v_exp_f32 v113, v113
    v_exp_f32 v114, v114
    v_exp_f32 v115, v115
    v_exp_f32 v116, v116
    v_exp_f32 v117, v117
    v_exp_f32 v118, v118
    v_exp_f32 v119, v119
    v_exp_f32 v120, v120
    v_exp_f32 v121, v121
    v_exp_f32 v122, v122
    v_exp_f32 v123, v123
    v_exp_f32 v124, v124
    v_exp_f32 v125, v125
    v_exp_f32 v126, v126
    v_exp_f32 v127, v127
    v_smfmac_f32_32x32x32_bf16 v[96:111], a[152:155], v[112:119], v7
    s_nop 0
    v_smfmac_f32_32x32x32_bf16 v[96:111], a[156:159], v[120:127], v7
    s_nop 7
    v_mfma_f32_32x32x16_bf16 v[112:127], a[160:163], v[40:43], v[144:159]
    v_mfma_f32_32x32x16_bf16 v[112:127], a[164:167], v[44:47], v[112:127]
    s_nop 11
    v_exp_f32 v112, v112
    v_exp_f32 v113, v113
    v_exp_f32 v114, v114
    v_exp_f32 v115, v115
    v_exp_f32 v116, v116
    v_exp_f32 v117, v117
    v_exp_f32 v118, v118
    v_exp_f32 v119, v119
    v_exp_f32 v120, v120
    v_exp_f32 v121, v121
    v_exp_f32 v122, v122
    v_exp_f32 v123, v123
    v_exp_f32 v124, v124
    v_exp_f32 v125, v125
    v_exp_f32 v126, v126
    v_exp_f32 v127, v127
    v_smfmac_f32_32x32x32_bf16 v[96:111], a[168:171], v[112:119], v7
    s_nop 0
    v_smfmac_f32_32x32x32_bf16 v[96:111], a[172:175], v[120:127], v7
    s_nop 7
    v_mfma_f32_32x32x16_bf16 v[112:127], a[176:179], v[40:43], v[144:159]
    v_mfma_f32_32x32x16_bf16 v[112:127], a[180:183], v[44:47], v[112:127]
    s_nop 11
    v_exp_f32 v112, v112
    v_exp_f32 v113, v113
    v_exp_f32 v114, v114
    v_exp_f32 v115, v115
    v_exp_f32 v116, v116
    v_exp_f32 v117, v117
    v_exp_f32 v118, v118
    v_exp_f32 v119, v119
    v_exp_f32 v120, v120
    v_exp_f32 v121, v121
    v_exp_f32 v122, v122
    v_exp_f32 v123, v123
    v_exp_f32 v124, v124
    v_exp_f32 v125, v125
    v_exp_f32 v126, v126
    v_exp_f32 v127, v127
    v_smfmac_f32_32x32x32_bf16 v[96:111], a[184:187], v[112:119], v7
    s_nop 0
    v_smfmac_f32_32x32x32_bf16 v[96:111], a[188:191], v[120:127], v7
    s_nop 7
    v_mfma_f32_32x32x16_bf16 v[112:127], a[192:195], v[40:43], v[144:159]
    v_mfma_f32_32x32x16_bf16 v[112:127], a[196:199], v[44:47], v[112:127]
    s_nop 11
    v_exp_f32 v112, v112
    v_exp_f32 v113, v113
    v_exp_f32 v114, v114
    v_exp_f32 v115, v115
    v_exp_f32 v116, v116
    v_exp_f32 v117, v117
    v_exp_f32 v118, v118
    v_exp_f32 v119, v119
    v_exp_f32 v120, v120
    v_exp_f32 v121, v121
    v_exp_f32 v122, v122
    v_exp_f32 v123, v123
    v_exp_f32 v124, v124
    v_exp_f32 v125, v125
    v_exp_f32 v126, v126
    v_exp_f32 v127, v127
    v_smfmac_f32_32x32x32_bf16 v[96:111], a[200:203], v[112:119], v7
    s_nop 0
    v_smfmac_f32_32x32x32_bf16 v[96:111], a[204:207], v[120:127], v7
    s_nop 7
    v_mfma_f32_32x32x16_bf16 v[112:127], a[208:211], v[40:43], v[144:159]
    v_mfma_f32_32x32x16_bf16 v[112:127], a[212:215], v[44:47], v[112:127]
    s_nop 11
    v_exp_f32 v112, v112
    v_exp_f32 v113, v113
    v_exp_f32 v114, v114
    v_exp_f32 v115, v115
    v_exp_f32 v116, v116
    v_exp_f32 v117, v117
    v_exp_f32 v118, v118
    v_exp_f32 v119, v119
    v_exp_f32 v120, v120
    v_exp_f32 v121, v121
    v_exp_f32 v122, v122
    v_exp_f32 v123, v123
    v_exp_f32 v124, v124
    v_exp_f32 v125, v125
    v_exp_f32 v126, v126
    v_exp_f32 v127, v127
    v_smfmac_f32_32x32x32_bf16 v[96:111], a[216:219], v[112:119], v7
    s_nop 0
    v_smfmac_f32_32x32x32_bf16 v[96:111], a[220:223], v[120:127], v7
    s_nop 7
    v_mfma_f32_32x32x16_bf16 v[112:127], a[224:227], v[40:43], v[144:159]
    v_mfma_f32_32x32x16_bf16 v[112:127], a[228:231], v[44:47], v[112:127]
    s_nop 11
    v_exp_f32 v112, v112
    v_exp_f32 v113, v113
    v_exp_f32 v114, v114
    v_exp_f32 v115, v115
    v_exp_f32 v116, v116
    v_exp_f32 v117, v117
    v_exp_f32 v118, v118
    v_exp_f32 v119, v119
    v_exp_f32 v120, v120
    v_exp_f32 v121, v121
    v_exp_f32 v122, v122
    v_exp_f32 v123, v123
    v_exp_f32 v124, v124
    v_exp_f32 v125, v125
    v_exp_f32 v126, v126
    v_exp_f32 v127, v127
    v_smfmac_f32_32x32x32_bf16 v[96:111], a[232:235], v[112:119], v7
    s_nop 0
    v_smfmac_f32_32x32x32_bf16 v[96:111], a[236:239], v[120:127], v7
    s_nop 7
    v_mfma_f32_32x32x16_bf16 v[112:127], a[240:243], v[40:43], v[144:159]
    v_mfma_f32_32x32x16_bf16 v[112:127], a[244:247], v[44:47], v[112:127]
    s_nop 11
    v_exp_f32 v112, v112
    v_exp_f32 v113, v113
    v_exp_f32 v114, v114
    v_exp_f32 v115, v115
    v_exp_f32 v116, v116
    v_exp_f32 v117, v117
    v_exp_f32 v118, v118
    v_exp_f32 v119, v119
    v_exp_f32 v120, v120
    v_exp_f32 v121, v121
    v_exp_f32 v122, v122
    v_exp_f32 v123, v123
    v_exp_f32 v124, v124
    v_exp_f32 v125, v125
    v_exp_f32 v126, v126
    v_exp_f32 v127, v127
    v_smfmac_f32_32x32x32_bf16 v[96:111], a[248:251], v[112:119], v7
    s_nop 0
    v_smfmac_f32_32x32x32_bf16 v[96:111], a[252:255], v[120:127], v7
    s_nop 7
    s_nop 7
    ds_write_b128 v9, v[48:51] offset:0
    ds_write_b128 v9, v[52:55] offset:1024
    ds_write_b128 v9, v[56:59] offset:2048
    ds_write_b128 v9, v[60:63] offset:3072
    ds_write_b128 v10, v[64:67] offset:4096
    ds_write_b128 v10, v[68:71] offset:5120
    ds_write_b128 v10, v[72:75] offset:6144
    ds_write_b128 v10, v[76:79] offset:7168
    ds_write_b128 v11, v[80:83] offset:8192
    ds_write_b128 v11, v[84:87] offset:9216
    ds_write_b128 v11, v[88:91] offset:10240
    ds_write_b128 v11, v[92:95] offset:11264
    s_add_u32 m0, s72, 0
    s_nop 0
    buffer_load_dwordx4 a[0:3], v2, s[12:15], m0 offen offset:0 sc1
    s_add_u32 m0, s72, 0
    s_nop 0
    buffer_load_dwordx4 a[4:7], v2, s[12:15], m0 offen offset:1024 sc1
    s_add_u32 m0, s72, 0
    s_nop 0
    buffer_load_dwordx4 a[8:11], v2, s[12:15], m0 offen offset:2048 sc1
    s_add_u32 m0, s72, 0
    s_nop 0
    buffer_load_dwordx4 a[12:15], v2, s[12:15], m0 offen offset:3072 sc1
    s_waitcnt vmcnt(0) lgkmcnt(0)
    s_barrier
    ds_read_b128 v[48:51], v12 offset:0
    ds_read_b128 v[52:55], v12 offset:1024
    ds_read_b128 v[56:59], v12 offset:2048
    ds_read_b128 v[60:63], v12 offset:3072
    ds_read_b128 v[64:67], v12 offset:4096
    ds_read_b128 v[68:71], v12 offset:5120
    ds_read_b128 v[72:75], v12 offset:6144
    ds_read_b128 v[76:79], v12 offset:7168
    ds_read_b128 v[80:83], v12 offset:8192
    ds_read_b128 v[84:87], v12 offset:9216
    ds_read_b128 v[88:91], v12 offset:10240
    ds_read_b128 v[92:95], v12 offset:11264
    s_branch L_combine
L_end:
    s_endpgm
.section .rodata,"a"
.p2align 6
.amdhsa_kernel sequential_preLN__mha_block__dense_activation_squared_relu__prompt_kernel
  .amdhsa_next_free_vgpr 512
  .amdhsa_next_free_sgpr 102
  .amdhsa_accum_offset 256
  .amdhsa_group_segment_fixed_size 0
  .amdhsa_kernarg_size 88
  .amdhsa_user_sgpr_count 2
  .amdhsa_user_sgpr_kernarg_segment_ptr 1
  .amdhsa_system_sgpr_workgroup_id_x 1
.end_amdhsa_kernel
```
